```python
import torch

def _softmax(x, axis=-1):
    return torch.softmax(x, dim=axis)

def _gelu(x):
    return torch.nn.functional.gelu(x, approximate='tanh')

def _silu(x):
    return torch.nn.functional.silu(x)

def _sigmoid(x):
    return torch.sigmoid(x)

def _layernorm(x, axis=-1, eps=1e-05):
    m = x.mean(dim=axis, keepdim=True)
    v = x.var(dim=axis, keepdim=True, unbiased=False)
    return (x - m) / torch.sqrt(v + eps)

def _scatter_add(tgt, idx, src, axis=0):
    return tgt.clone().index_add_(axis, idx, src)

def _segment_sum(src, seg, n):
    out = torch.zeros((n,) + src.shape[1:], dtype=src.dtype)
    return out.index_add_(0, seg, src)

def _pad(x, pw):
    flat = tuple((v for pair in reversed(pw) for v in pair))
    return torch.nn.functional.pad(x, flat)
kernel_name = 'adaLN_cond__linear_kernel_hedgehog__dense_activation_squared_relu__prompt'

def setup_inputs():

    _w = lambda a: (lambda t: t.to(torch.bfloat16) if t.is_floating_point() else t)(torch.as_tensor(a))

    def _A_setup():
        B, S, D, H = (1, 2048, 640, 32)
        Dh = D // H
        return {'x': _w((lambda *s: torch.randn(*s, dtype=torch.bfloat16) * 0.05)(B, S, D)), 'wqkv': _w((lambda *s: torch.randn(*s, dtype=torch.bfloat16) * 0.4)(D, 3 * D)), 'w_phi': _w((lambda *s: torch.randn(*s, dtype=torch.bfloat16) * 0.4)(H, Dh, Dh) * Dh ** (-0.5)), 'wo': _w((lambda *s: torch.randn(*s, dtype=torch.bfloat16) * 0.05)(D, D))}
    _A_in = _A_setup()

    def _B_setup():
        B, S, D, F = (1, 2048, 640, 1728)
        return {'x': _w((lambda *s: torch.randn(*s, dtype=torch.bfloat16) * 0.05)(B, S, D)), 'w1': _w((lambda *s: torch.randn(*s, dtype=torch.bfloat16) * 0.05)(D, F)), 'b1': _w((lambda *s: torch.randn(*s, dtype=torch.bfloat16) * 0.4)(F)), 'w2': _w((lambda *s: torch.randn(*s, dtype=torch.bfloat16) * 0.05)(F, D)), 'b2': _w((lambda *s: torch.randn(*s, dtype=torch.bfloat16) * 1.6)(D))}
    _B_in = _B_setup()
    return {'A_x': _A_in['x'], 'A_wqkv': _A_in['wqkv'], 'A_w_phi': _A_in['w_phi'], 'A_wo': _A_in['wo'], 'B_x': _B_in['x'], 'B_w1': _B_in['w1'], 'B_b1': _B_in['b1'], 'B_w2': _B_in['w2'], 'B_b2': _B_in['b2'], 'c': _w((lambda *s: torch.randn(*s, dtype=torch.bfloat16) * 0.1)(1, 640) * 8.0), 'w_mod': _w((lambda *s: torch.randn(*s, dtype=torch.bfloat16) * 0.1)(640, 6 * 640) * 640 ** (-0.5) * 8.0)}

def reference(A_x, A_wqkv, A_w_phi, A_wo, B_x, B_w1, B_b1, B_w2, B_b2, c, w_mod):

    def _A_ref(x, wqkv, w_phi, wo):
        B, S, D = x.shape
        H = 32
        Dh = D // H
        qkv = (lambda x, *d: x.permute(*d))((x @ wqkv).reshape(B, S, 3, H, Dh), 2, 0, 3, 1, 4)
        q, k, v = (qkv[0], qkv[1], qkv[2])
        pq = torch.einsum('bhsd,hdf->bhsf', q, w_phi)
        pk = torch.einsum('bhsd,hdf->bhsf', k, w_phi)
        phi_q = torch.concatenate([_softmax(pq, axis=-1), _softmax(-pq, axis=-1)], axis=-1)
        phi_k = torch.concatenate([_softmax(pk, axis=-1), _softmax(-pk, axis=-1)], axis=-1)
        kv = torch.einsum('bhsf,bhsd->bhfd', phi_k, v)
        z = torch.einsum('bhsf->bhf', phi_k)
        num = torch.einsum('bhqf,bhfd->bhqd', phi_q, kv)
        den = torch.einsum('bhqf,bhf->bhq', phi_q, z)[..., None] + 1e-06
        o = num / den
        return (lambda x, *d: x.permute(*d))(o, 0, 2, 1, 3).reshape(B, S, D) @ wo

    def _B_ref(x, w1, b1, w2, b2):
        h = torch.einsum('bsd,df->bsf', x, w1) + b1
        zero = torch.zeros_like(h)
        r = torch.where(h > zero, h, zero)
        h = r * r
        out = torch.einsum('bsf,fd->bsd', h, w2) + b2
        return out
    x = A_x
    mod = (_silu(c) @ w_mod).reshape(c.shape[0], 6, 1, -1)
    sa, ca, ga, sb, cb, gb = (mod[:, 0].clone(), mod[:, 1].clone(), mod[:, 2].clone(), mod[:, 3].clone(), mod[:, 4].clone(), mod[:, 5].clone())
    h = _layernorm(x, axis=-1) * (1 + ca) + sa
    x = x + ga * _A_ref(h, A_wqkv, A_w_phi, A_wo)
    h = _layernorm(x, axis=-1) * (1 + cb) + sb
    x = x + gb * _B_ref(h, B_w1, B_b1, B_w2, B_b2)
    return x
```

```asm
; @launch grid=(256,1,1) block=(256,1,1) lds=163840
.amdgcn_target "amdgcn-amd-amdhsa--gfx950"
.text
.globl adaLN_cond__linear_kernel_hedgehog__dense_activation_squared_relu__prompt_kernel
.p2align 8
.type adaLN_cond__linear_kernel_hedgehog__dense_activation_squared_relu__prompt_kernel,@function
adaLN_cond__linear_kernel_hedgehog__dense_activation_squared_relu__prompt_kernel:
    s_cmp_ge_u32 s2, 256
    s_cbranch_scc1 L_END
    s_load_dwordx16 s[64:79], s[0:1], 0
    s_load_dwordx8 s[80:87], s[0:1], 64
    s_load_dwordx4 s[88:91], s[0:1], 96
    v_and_b32 v1, 63, v0
    v_lshrrev_b32 v2, 6, v0
    s_and_b32 s60, s2, 7
    s_lshr_b32 s61, s2, 3
    v_readfirstlane_b32 s59, v2
    s_lshr_b32 s57, s61, 3
    s_lshr_b32 s3, s60, 1
    s_lshl_b32 s3, s3, 2
    s_add_u32 s57, s57, s3
    s_and_b32 s58, s61, 7
    s_and_b32 s3, s60, 1
    s_lshl_b32 s3, s3, 3
    s_add_u32 s58, s58, s3
    s_cmp_lg_u32 s59, 0
    s_cbranch_scc1 L_TC18
    s_call_b64 s[100:101], L_PAD0
L_TC18:
    s_cmp_lg_u32 s59, 1
    s_cbranch_scc1 L_TC22
    s_call_b64 s[100:101], L_PAD1
L_TC22:
    s_cmp_lg_u32 s59, 2
    s_cbranch_scc1 L_TC26
    s_call_b64 s[100:101], L_PAD2
L_TC26:
    s_cmp_lg_u32 s59, 3
    s_cbranch_scc1 L_TC30
    s_call_b64 s[100:101], L_PAD3
L_TC30:
    s_waitcnt lgkmcnt(0)
    s_add_u32 s92, s90, 234881024
    s_addc_u32 s93, s91, 0
    s_load_dword s56, s[92:93], 0
    s_mov_b32 s36, s82
    s_mov_b32 s37, s83
    s_mov_b32 s38, 1280
    s_mov_b32 s39, 0x00020000
    s_mov_b32 s40, s84
    s_mov_b32 s41, s85
    s_mov_b32 s42, 4915200
    s_mov_b32 s43, 0x00020000
    s_mov_b32 s8, s66
    s_mov_b32 s9, s67
    s_mov_b32 s10, 2457600
    s_mov_b32 s11, 0x00020000
    s_mov_b32 s4, s64
    s_mov_b32 s5, s65
    s_mov_b32 s6, 2621440
    s_mov_b32 s7, 0x00020000
    s_branch L_PSK0
L_PAD0:
    s_setpc_b64 s[100:101]
L_PSK0:
    s_mov_b32 s12, s68
    s_mov_b32 s13, s69
    s_mov_b32 s14, 25600
    s_mov_b32 s15, 0x00020000
    s_add_u32 s48, s90, 234881024
    s_addc_u32 s49, s91, 0
    s_mov_b32 s50, 33554432
    s_mov_b32 s51, 0x00020000
    s_mov_b32 s16, s70
    s_mov_b32 s17, s71
    s_mov_b32 s18, 819200
    s_mov_b32 s19, 0x00020000
    s_mov_b32 s20, s74
    s_mov_b32 s21, s75
    s_mov_b32 s22, 2211840
    s_mov_b32 s23, 0x00020000
    s_mov_b32 s24, s76
    s_mov_b32 s25, s77
    s_mov_b32 s26, 3456
    s_mov_b32 s27, 0x00020000
    s_mov_b32 s28, s78
    s_mov_b32 s29, s79
    s_mov_b32 s30, 2211840
    s_mov_b32 s31, 0x00020000
    s_mov_b32 s32, s80
    s_mov_b32 s33, s81
    s_mov_b32 s34, 1280
    s_mov_b32 s35, 0x00020000
    s_mov_b32 s44, s86
    s_mov_b32 s45, s87
    s_mov_b32 s46, 2621440
    s_mov_b32 s47, 0x00020000
    s_mov_b32 s52, s88
    s_mov_b32 s53, s89
    s_mov_b32 s54, 256
    s_mov_b32 s55, 0x00020000
    s_mov_b32 s68, 0x3fb8aa3b
    s_mov_b32 s69, 0x3fb8aa3b
    s_and_b32 s63, s61, 3
    s_lshr_b32 s70, s61, 2
    s_lshl_b32 s71, s60, 2
    s_add_u32 s62, s70, s71
    s_add_u32 s72, s60, 32
    s_cmp_lt_u32 s61, 16
    s_cselect_b32 s62, s62, s72
    s_lshl_b32 s65, s62, 4
    s_add_u32 s64, s65, 640
    s_cmp_lt_u32 s61, 20
    s_cselect_b32 s66, 1, 3
    v_and_b32 v8, 7, v0
    v_lshrrev_b32 v9, 3, v0
    s_lshl_b32 s70, s57, 7
    s_lshl_b32 s71, s58, 3
    s_add_u32 s70, s70, s71
    v_add_u32 v4, s70, v8
    s_movk_i32 s71, 1280
    v_mul_lo_u32 v4, v4, s71
    v_lshl_add_u32 v4, v9, 4, v4
    v_cmp_gt_u32 vcc, 16, v9
    v_mov_b32 v5, 2147418112
    v_add_u32 v6, 1024, v4
    v_cndmask_b32 v5, v5, v6, vcc
    buffer_load_dwordx4 v[12:15], v4, s[4:7], 0 offen nt
    buffer_load_dwordx4 v[16:19], v4, s[4:7], 0 offen offset:512 nt
    buffer_load_dwordx4 v[20:23], v5, s[4:7], 0 offen nt
    v_lshlrev_b32 v2, 3, v0
    buffer_load_dwordx2 v[10:11], v2, s[36:39], 0 offen
    s_cmp_eq_u32 s66, 1
    s_cbranch_scc1 L_A_T1
    s_and_b32 s70, s59, 1
    s_lshl_b32 s71, s70, 6
    v_add_u32 v4, s71, v1
    v_min_u32 v4, 99, v4
    v_lshlrev_b32 v4, 4, v4
    s_mul_i32 s72, s58, 1600
    s_lshl_b32 s70, s70, 10
    s_add_u32 m0, s70, 153600
    s_nop 0
    buffer_load_dwordx4 v4, s[12:15], s72 offen lds
    s_cmp_lg_u32 s59, 0
    s_cbranch_scc1 L_TC133
    s_call_b64 s[100:101], L_PAD4
L_TC133:
    s_cmp_lg_u32 s59, 1
    s_cbranch_scc1 L_TC137
    s_call_b64 s[100:101], L_PAD5
L_TC137:
    s_cmp_lg_u32 s59, 2
    s_cbranch_scc1 L_TC141
    s_call_b64 s[100:101], L_PAD6
L_TC141:
    s_cmp_lg_u32 s59, 3
    s_cbranch_scc1 L_TC145
    s_call_b64 s[100:101], L_PAD7
L_TC145:
    s_waitcnt vmcnt(2)
    v_lshlrev_b32 v104, 16, v12
    v_and_b32 v105, 0xffff0000, v12
    v_lshlrev_b32 v106, 16, v13
    v_and_b32 v107, 0xffff0000, v13
    v_lshlrev_b32 v108, 16, v14
    v_and_b32 v109, 0xffff0000, v14
    v_lshlrev_b32 v110, 16, v15
    v_and_b32 v111, 0xffff0000, v15
    v_lshlrev_b32 v112, 16, v16
    v_and_b32 v113, 0xffff0000, v16
    v_lshlrev_b32 v114, 16, v17
    v_and_b32 v115, 0xffff0000, v17
    v_lshlrev_b32 v116, 16, v18
    v_and_b32 v117, 0xffff0000, v18
    v_lshlrev_b32 v118, 16, v19
    v_and_b32 v119, 0xffff0000, v19
    v_lshlrev_b32 v120, 16, v20
    v_and_b32 v121, 0xffff0000, v20
    v_lshlrev_b32 v122, 16, v21
    v_and_b32 v123, 0xffff0000, v21
    v_lshlrev_b32 v124, 16, v22
    v_and_b32 v125, 0xffff0000, v22
    v_lshlrev_b32 v126, 16, v23
    v_and_b32 v127, 0xffff0000, v23
    v_pk_add_f32 v[30:31], v[104:105], v[106:107]
    v_pk_mul_f32 v[32:33], v[104:105], v[104:105]
    v_pk_fma_f32 v[32:33], v[106:107], v[106:107], v[32:33]
    v_pk_add_f32 v[30:31], v[30:31], v[108:109]
    v_pk_fma_f32 v[32:33], v[108:109], v[108:109], v[32:33]
    v_pk_add_f32 v[30:31], v[30:31], v[110:111]
    v_pk_fma_f32 v[32:33], v[110:111], v[110:111], v[32:33]
    v_pk_add_f32 v[30:31], v[30:31], v[112:113]
    v_pk_fma_f32 v[32:33], v[112:113], v[112:113], v[32:33]
    v_pk_add_f32 v[30:31], v[30:31], v[114:115]
    v_pk_fma_f32 v[32:33], v[114:115], v[114:115], v[32:33]
    v_pk_add_f32 v[30:31], v[30:31], v[116:117]
    v_pk_fma_f32 v[32:33], v[116:117], v[116:117], v[32:33]
    v_pk_add_f32 v[30:31], v[30:31], v[118:119]
    v_pk_fma_f32 v[32:33], v[118:119], v[118:119], v[32:33]
    v_pk_add_f32 v[30:31], v[30:31], v[120:121]
    v_pk_fma_f32 v[32:33], v[120:121], v[120:121], v[32:33]
    v_pk_add_f32 v[30:31], v[30:31], v[122:123]
    v_pk_fma_f32 v[32:33], v[122:123], v[122:123], v[32:33]
    v_pk_add_f32 v[30:31], v[30:31], v[124:125]
    v_pk_fma_f32 v[32:33], v[124:125], v[124:125], v[32:33]
    v_pk_add_f32 v[30:31], v[30:31], v[126:127]
    v_pk_fma_f32 v[32:33], v[126:127], v[126:127], v[32:33]
    v_add_f32 v30, v30, v31
    v_add_f32 v31, v32, v33
    s_waitcnt vmcnt(1)
    v_lshlrev_b32 v24, 16, v10
    v_and_b32 v25, 0xffff0000, v10
    v_lshlrev_b32 v26, 16, v11
    v_and_b32 v27, 0xffff0000, v11
    v_mul_f32 v36, s68, v24
    v_mul_f32 v37, s68, v25
    v_mul_f32 v38, s68, v26
    v_mul_f32 v39, s68, v27
    v_add_f32_dpp v30, v30, v30 row_ror:8 row_mask:0xf bank_mask:0xf
    v_add_f32_dpp v31, v31, v31 row_ror:8 row_mask:0xf bank_mask:0xf
    v_exp_f32 v36, -v36
    v_exp_f32 v37, -v37
    v_exp_f32 v38, -v38
    v_exp_f32 v39, -v39
    v_mov_b32 v32, v30
    v_mov_b32 v33, v31
    v_add_f32 v36, 1.0, v36
    v_add_f32 v37, 1.0, v37
    v_permlane16_swap_b32 v32, v30
    v_permlane16_swap_b32 v33, v31
    v_add_f32 v30, v30, v32
    v_add_f32 v31, v31, v33
    v_mov_b32 v32, v30
    v_mov_b32 v33, v31
    v_add_f32 v38, 1.0, v38
    v_add_f32 v39, 1.0, v39
    v_permlane32_swap_b32 v32, v30
    v_permlane32_swap_b32 v33, v31
    v_add_f32 v30, v30, v32
    v_add_f32 v31, v31, v33
    v_rcp_f32 v36, v36
    v_rcp_f32 v37, v37
    v_rcp_f32 v38, v38
    v_rcp_f32 v39, v39
    s_lshl_b32 s70, s59, 6
    v_lshl_add_u32 v6, v8, 3, s70
    v_add_u32 v6, 59904, v6
    ds_write_b64 v6, v[30:31]
    v_mul_f32 v24, v24, v36
    v_mul_f32 v25, v25, v37
    v_mul_f32 v26, v26, v38
    v_mul_f32 v27, v27, v39
    v_cvt_pk_bf16_f32 v24, v24, v25
    v_cvt_pk_bf16_f32 v25, v26, v27
    v_add_u32 v2, 57344, v2
    ds_write_b64 v2, v[24:25]
    v_mov_b32 v28, 0
    v_mov_b32 v29, 0
    v_mov_b32 v30, 0
    v_mov_b32 v31, 0
    v_min_u32 v26, 47, v1
    v_lshlrev_b32 v26, 4, v26
    v_add_u32 v26, 155648, v26
    ds_write_b128 v26, v[28:31]
    v_lshlrev_b32 v2, 3, v8
    v_add_u32 v2, 59904, v2
    s_waitcnt lgkmcnt(0)
    s_barrier
    ds_read_b64 v[32:33], v2 offset:0
    ds_read_b64 v[34:35], v2 offset:64
    ds_read_b64 v[36:37], v2 offset:128
    ds_read_b64 v[38:39], v2 offset:192
    s_lshl_b32 s70, s57, 2
    s_lshr_b32 s71, s58, 2
    s_add_u32 s70, s70, s71
    s_mul_i32 s70, s70, 40960
    s_and_b32 s71, s58, 3
    s_lshl_b32 s71, s71, 7
    s_add_u32 s70, s70, s71
    s_add_u32 s70, s70, 3891200
    v_lshrrev_b32 v4, 1, v9
    v_lshlrev_b32 v4, 10, v4
    v_and_b32 v5, 1, v9
    v_lshlrev_b32 v5, 9, v5
    v_lshlrev_b32 v6, 4, v8
    v_add3_u32 v4, v4, v5, v6
    v_cmp_gt_u32 vcc, 16, v9
    v_mov_b32 v5, 2147418112
    v_add_u32 v6, 32768, v4
    v_cndmask_b32 v5, v5, v6, vcc
    v_add_u32 v6, 16384, v4
    s_waitcnt lgkmcnt(0)
    v_pk_add_f32 v[32:33], v[32:33], v[34:35]
    v_pk_add_f32 v[36:37], v[36:37], v[38:39]
    v_pk_add_f32 v[32:33], v[32:33], v[36:37]
    v_mul_f32 v32, 0x3acccccd, v32
    v_mul_f32 v33, 0x3acccccd, v33
    v_fma_f32 v33, -v32, v32, v33
    v_max_f32 v33, 0, v33
    v_add_f32 v33, 0x3727c5ac, v33
    v_rsq_f32 v34, v33
    s_nop 0
    v_mul_f32 v36, v32, v34
    v_sub_f32 v36, 0, v36
    v_mov_b32 v35, v34
    v_mov_b32 v37, v36
    v_pk_fma_f32 v[104:105], v[104:105], v[34:35], v[36:37]
    v_pk_fma_f32 v[106:107], v[106:107], v[34:35], v[36:37]
    v_pk_fma_f32 v[108:109], v[108:109], v[34:35], v[36:37]
    v_pk_fma_f32 v[110:111], v[110:111], v[34:35], v[36:37]
    v_pk_fma_f32 v[112:113], v[112:113], v[34:35], v[36:37]
    v_pk_fma_f32 v[114:115], v[114:115], v[34:35], v[36:37]
    v_pk_fma_f32 v[116:117], v[116:117], v[34:35], v[36:37]
    v_pk_fma_f32 v[118:119], v[118:119], v[34:35], v[36:37]
    v_pk_fma_f32 v[120:121], v[120:121], v[34:35], v[36:37]
    v_pk_fma_f32 v[122:123], v[122:123], v[34:35], v[36:37]
    v_pk_fma_f32 v[124:125], v[124:125], v[34:35], v[36:37]
    v_pk_fma_f32 v[126:127], v[126:127], v[34:35], v[36:37]
    v_cvt_pk_bf16_f32 v12, v104, v105
    v_cvt_pk_bf16_f32 v13, v106, v107
    v_cvt_pk_bf16_f32 v14, v108, v109
    v_cvt_pk_bf16_f32 v15, v110, v111
    v_cvt_pk_bf16_f32 v16, v112, v113
    v_cvt_pk_bf16_f32 v17, v114, v115
    v_cvt_pk_bf16_f32 v18, v116, v117
    v_cvt_pk_bf16_f32 v19, v118, v119
    v_cvt_pk_bf16_f32 v20, v120, v121
    v_cvt_pk_bf16_f32 v21, v122, v123
    v_cvt_pk_bf16_f32 v22, v124, v125
    v_cvt_pk_bf16_f32 v23, v126, v127
    buffer_store_dwordx4 v[12:15], v4, s[48:51], s70 offen sc1
    buffer_store_dwordx4 v[16:19], v6, s[48:51], s70 offen sc1
    buffer_store_dwordx4 v[20:23], v5, s[48:51], s70 offen sc1
    v_lshrrev_b32 v2, 4, v1
    s_mul_i32 s70, s59, 320
    v_lshlrev_b32 v5, 3, v2
    v_add_u32 v5, s70, v5
    v_add_u32 v5, 57344, v5
    ds_read_b64 v[32:33], v5 offset:0
    ds_read_b64 v[34:35], v5 offset:32
    ds_read_b64 a[204:205], v5 offset:0
    ds_read_b64 a[206:207], v5 offset:32
    ds_read_b64 v[36:37], v5 offset:64
    ds_read_b64 v[38:39], v5 offset:96
    ds_read_b64 a[208:209], v5 offset:64
    ds_read_b64 a[210:211], v5 offset:96
    ds_read_b64 v[40:41], v5 offset:128
    ds_read_b64 v[42:43], v5 offset:160
    ds_read_b64 a[212:213], v5 offset:128
    ds_read_b64 a[214:215], v5 offset:160
    ds_read_b64 v[44:45], v5 offset:192
    ds_read_b64 v[46:47], v5 offset:224
    ds_read_b64 a[216:217], v5 offset:192
    ds_read_b64 a[218:219], v5 offset:224
    ds_read_b64 v[48:49], v5 offset:256
    ds_read_b64 v[50:51], v5 offset:288
    ds_read_b64 a[220:221], v5 offset:256
    ds_read_b64 a[222:223], v5 offset:288
    s_mul_i32 s70, s58, 153600
    s_add_u32 s74, s70, 1433600
    s_sub_u32 s70, s59, 1
    s_lshl_b32 s70, s70, 12
    s_add_u32 s73, s74, s70
    s_mov_b32 s75, s70
    s_min_u32 s83, s2, 215
    s_mul_i32 s84, s83, 10240
    s_mul_i32 s85, s83, 1280
    s_add_u32 s85, s85, 18833408
    s_cmp_lt_u32 s2, 216
    s_cselect_b32 s86, 0, 2147418112
    v_add_u32 v2, 0, v0
    v_mul_u32_u24 v3, 13108, v2
    v_lshrrev_b32 v3, 20, v3
    v_mul_u32_u24 v4, 80, v3
    v_sub_u32 v4, v2, v4
    v_mul_u32_u24 v5, 6554, v4
    v_lshrrev_b32 v5, 16, v5
    v_mul_u32_u24 v6, 10, v5
    v_sub_u32 v6, v4, v6
    v_mul_u32_u24 v5, 1280, v5
    v_mul_u32_u24 v7, 160, v3
    v_lshlrev_b32 v6, 4, v6
    v_add3_u32 v9, v5, v7, v6
    s_mov_b32 s70, 276480
    v_mul_lo_u32 v3, v3, s70
    v_lshl_add_u32 v10, v4, 4, v3
    v_or_b32 v10, s86, v10
    v_accvgpr_write_b32 a184, v9
    v_accvgpr_write_b32 a187, v10
    v_add_u32 v2, 256, v0
    v_mul_u32_u24 v3, 13108, v2
    v_lshrrev_b32 v3, 20, v3
    v_mul_u32_u24 v4, 80, v3
    v_sub_u32 v4, v2, v4
    v_mul_u32_u24 v5, 6554, v4
    v_lshrrev_b32 v5, 16, v5
    v_mul_u32_u24 v6, 10, v5
    v_sub_u32 v6, v4, v6
    v_mul_u32_u24 v5, 1280, v5
    v_mul_u32_u24 v7, 160, v3
    v_lshlrev_b32 v6, 4, v6
    v_add3_u32 v9, v5, v7, v6
    s_mov_b32 s70, 276480
    v_mul_lo_u32 v3, v3, s70
    v_lshl_add_u32 v10, v4, 4, v3
    v_or_b32 v10, s86, v10
    v_accvgpr_write_b32 a185, v9
    v_accvgpr_write_b32 a188, v10
    v_add_u32 v2, 512, v0
    v_mul_u32_u24 v3, 13108, v2
    v_lshrrev_b32 v3, 20, v3
    v_mul_u32_u24 v4, 80, v3
    v_sub_u32 v4, v2, v4
    v_mul_u32_u24 v5, 6554, v4
    v_lshrrev_b32 v5, 16, v5
    v_mul_u32_u24 v6, 10, v5
    v_sub_u32 v6, v4, v6
    v_mul_u32_u24 v5, 1280, v5
    v_mul_u32_u24 v7, 160, v3
    v_lshlrev_b32 v6, 4, v6
    v_add3_u32 v9, v5, v7, v6
    s_mov_b32 s70, 276480
    v_mul_lo_u32 v3, v3, s70
    v_lshl_add_u32 v10, v4, 4, v3
    v_or_b32 v10, s86, v10
    v_cmp_gt_u32 vcc, 640, v2
    v_mov_b32 v7, 2147418112
    s_nop 0
    v_cndmask_b32 v9, v7, v9, vcc
    v_cndmask_b32 v10, v7, v10, vcc
    v_accvgpr_write_b32 a186, v9
    v_accvgpr_write_b32 a189, v10
    v_and_b32 v2, 31, v1
    v_and_b32 v3, 1, v2
    v_lshrrev_b32 v4, 1, v2
    v_lshlrev_b32 v3, 8, v3
    v_lshl_add_u32 v3, v4, 4, v3
    s_lshl_b32 s70, s59, 9
    v_add_u32 v3, s70, v3
    v_add_u32 v5, 158464, v3
    v_lshlrev_b32 v2, 4, v2
    v_add_u32 v6, 158464, v2
    v_add_u32 v2, s70, v2
    v_add_u32 v7, 156416, v2
    v_accvgpr_write_b32 a191, v5
    v_accvgpr_write_b32 a192, v6
    v_accvgpr_write_b32 a193, v7
    v_lshrrev_b32 v2, 5, v1
    v_lshlrev_b32 v2, 8, v2
    v_add_u32 v2, s70, v2
    v_add_u32 v2, 156416, v2
    v_accvgpr_write_b32 a234, v2
    v_and_b32 v2, 31, v0
    v_lshrrev_b32 v3, 5, v0
    v_mul_u32_u24 v3, 2560, v3
    v_lshl_add_u32 v4, v2, 4, v3
    v_accvgpr_write_b32 a190, v4
    s_mul_i32 s87, s58, 20480
    s_add_u32 s87, s87, 57344
    s_lshl_b32 s70, s59, 3
    s_lshl_b32 s71, s70, 10
    s_add_u32 s88, s71, 122880
    s_add_u32 s89, s88, s74
    s_add_u32 s70, s70, 4
    s_min_u32 s70, s70, 26
    s_lshl_b32 s71, s70, 10
    s_add_u32 s90, s71, 122880
    s_add_u32 s91, s90, s74
    v_and_b32 v2, 31, v1
    s_lshl_b32 s70, s59, 5
    v_add_u32 v2, s70, v2
    v_lshrrev_b32 v3, 5, v1
    v_lshl_add_u32 v2, v3, 7, v2
    v_mul_u32_u24 v4, 80, v2
    v_mul_u32_u24 v5, 48, v2
    v_add_u32 v5, 20480, v5
    v_accvgpr_write_b32 a235, v4
    v_accvgpr_write_b32 a236, v5
    s_lshr_b32 s70, s59, 1
    s_and_b32 s71, s59, 1
    v_lshrrev_b32 v2, 5, v1
    v_bfe_u32 v3, v1, 2, 2
    v_lshl_add_u32 v2, v2, 3, v3
    v_bfe_u32 v4, v1, 4, 1
    v_and_b32 v5, 3, v1
    v_lshl_add_u32 v6, v4, 2, v5
    v_and_b32 v7, 1, v6
    v_lshrrev_b32 v6, 1, v6
    v_lshrrev_b32 v8, 1, v6
    v_lshlrev_b32 v8, 2, v8
    v_lshl_add_u32 v8, v7, 1, v8
    v_and_b32 v6, 1, v6
    v_add_u32 v8, v8, v6
    v_mul_u32_u24 v9, 80, v2
    v_lshl_add_u32 v9, v8, 3, v9
    s_mul_i32 s76, s70, 10240
    s_lshl_b32 s77, s71, 6
    s_add_u32 s76, s76, s77
    v_add_u32 v9, s76, v9
    v_mul_u32_u24 v10, 48, v2
    v_lshl_add_u32 v10, v4, 5, v10
    v_lshl_add_u32 v10, v5, 3, v10
    s_mul_i32 s76, s70, 6144
    s_add_u32 s76, s76, 20480
    v_add_u32 v10, s76, v10
    v_and_b32 v2, 31, v1
    v_lshrrev_b32 v3, 5, v1
    v_mul_u32_u24 v4, 80, v2
    v_lshl_add_u32 v4, v3, 4, v4
    s_mul_i32 s76, s70, 1680
    s_lshl_b32 s77, s71, 6
    s_add_u32 s76, s76, s77
    v_add_u32 v4, s76, v4
    v_mov_b32 v5, 2147418112
    v_cmp_gt_u32 vcc, 21, v2
    s_nop 1
    v_cndmask_b32 v4, v5, v4, vcc
    v_add_u32 v6, 32, v4
    v_mul_u32_u24 v7, s71, v3
    v_cmp_eq_u32 vcc, 0, v7
    s_nop 1
    v_cndmask_b32 v4, v5, v4, vcc
    s_cmp_eq_u32 s71, 0
    s_cselect_b32 s76, 0, 2147418112
    v_or_b32 v6, s76, v6
    s_lshl_b32 s76, s58, 4
    s_add_u32 s76, s76, s57
    s_mul_i32 s76, s76, 3584
    s_add_u32 s93, s76, 516096
    v_accvgpr_write_b32 a237, v9
    v_accvgpr_write_b32 a238, v10
    v_accvgpr_write_b32 a239, v4
    v_accvgpr_write_b32 a240, v6
    v_and_b32 v2, 31, v1
    v_subrev_u32 v3, 8, v2
    v_cmp_gt_u32 vcc, 24, v2
    s_nop 1
    v_cndmask_b32 v2, v3, v2, vcc
    v_lshrrev_b32 v3, 5, v1
    v_mul_u32_u24 v3, 384, v3
    v_lshl_add_u32 v2, v2, 4, v3
    v_add_u32 v2, 122880, v2
    s_min_u32 s92, s61, 19
    s_mul_i32 s76, s60, 20
    s_add_u32 s92, s92, s76
    s_lshl_b32 s95, s92, 5
    s_add_u32 s95, s95, 2560
    v_lshrrev_b32 v4, 1, v1
    s_mul_i32 s70, s59, 160
    v_add_u32 v4, s70, v4
    s_movk_i32 s71, 7680
    v_mul_lo_u32 v4, v4, s71
    v_and_b32 v3, 1, v1
    v_lshl_add_u32 v4, v3, 4, v4
    s_mul_i32 s82, s59, 5120
    v_lshrrev_b32 v5, 4, v1
    v_bfe_u32 v3, v1, 2, 2
    v_lshl_add_u32 v5, v5, 2, v3
    v_lshlrev_b32 v5, 5, v5
    v_and_b32 v3, 3, v1
    v_lshl_add_u32 v5, v3, 3, v5
    v_add_u32 v5, s82, v5
    v_add_u32 v5, 102400, v5
    v_accvgpr_write_b32 a241, v2
    v_accvgpr_write_b32 a242, v4
    v_accvgpr_write_b32 a250, v5
    v_min_u32 v2, 209, v0
    v_lshlrev_b32 v3, 4, v2
    v_cmp_lt_u32 vcc, 104, v2
    v_mov_b32 v4, 240
    s_nop 0
    v_cndmask_b32 v4, 0, v4, vcc
    v_add_u32 v4, v3, v4
    v_add_u32 v4, 158464, v4
    v_accvgpr_write_b32 a243, v3
    v_accvgpr_write_b32 a244, v4
    v_lshrrev_b32 v2, 5, v1
    v_bfe_u32 v3, v1, 2, 1
    v_bfe_u32 v4, v1, 3, 2
    v_and_b32 v5, 3, v1
    v_add_u32 v6, v4, v3
    v_lshl_add_u32 v6, v6, 2, v5
    v_cmp_eq_u32 vcc, 0, v3
    v_mov_b32 v7, 4
    s_nop 0
    v_cndmask_b32 v7, 0, v7, vcc
    v_cmp_eq_u32 vcc, 0, v4
    v_mov_b32 v8, 5
    s_nop 0
    v_cndmask_b32 v7, v8, v7, vcc
    v_lshl_add_u32 v7, v7, 2, v5
    v_mul_u32_u24 v8, 1920, v3
    v_add_u32 v8, 158464, v8
    v_mul_u32_u24 v6, 80, v6
    v_mul_u32_u24 v7, 80, v7
    v_add_u32 v6, v6, v8
    v_add_u32 v7, v7, v8
    v_mov_b32 v9, 155648
    v_cmp_eq_u32 vcc, v2, v3
    s_nop 1
    v_cndmask_b32 v6, v9, v6, vcc
    v_cndmask_b32 v7, v9, v7, vcc
    v_accvgpr_write_b32 a245, v6
    v_accvgpr_write_b32 a246, v7
    v_and_b32 v2, 15, v1
    v_bfe_u32 v3, v1, 4, 1
    v_lshrrev_b32 v4, 5, v1
    v_mul_u32_u24 v5, 20480, v3
    v_lshl_add_u32 v5, v2, 4, v5
    v_mul_u32_u24 v6, 768, v4
    v_add_u32 v6, v6, v5
    v_lshl_add_u32 v7, v4, 3, v5
    v_add_u32 v7, 512, v7
    s_lshl_b32 s70, s57, 3
    s_lshl_b32 s71, s59, 1
    s_add_u32 s70, s70, s71
    s_mul_i32 s70, s70, 20480
    s_mul_i32 s71, s58, 1280
    s_add_u32 s70, s70, s71
    s_add_u32 s94, s70, 6512640
    v_accvgpr_write_b32 a247, v6
    v_accvgpr_write_b32 a248, v7
    v_mul_u32_u24 v2, 4682, v1
    v_lshrrev_b32 v2, 16, v2
    v_mul_u32_u24 v3, 14, v2
    v_sub_u32 v3, v1, v3
    v_mul_u32_u24 v2, 3456, v2
    v_lshl_add_u32 v2, v3, 7, v2
    v_cmp_gt_u32 vcc, 56, v1
    v_mov_b32 v4, 2147418112
    s_nop 0
    v_cndmask_b32 v5, v4, v2, vcc
    v_add_u32 v2, 13824, v2
    v_cmp_gt_u32 vcc, 14, v1
    s_nop 1
    v_cndmask_b32 v2, v4, v2, vcc
    v_mul_u32_u24 v6, 13108, v1
    v_lshrrev_b32 v6, 16, v6
    v_mul_u32_u24 v3, 5, v6
    v_sub_u32 v3, v1, v3
    v_mul_u32_u24 v6, 7680, v6
    v_lshl_add_u32 v6, v3, 7, v6
    v_cmp_gt_u32 vcc, 25, v1
    s_nop 1
    v_cndmask_b32 v6, v4, v6, vcc
    v_accvgpr_write_b32 a251, v5
    v_accvgpr_write_b32 a252, v2
    v_accvgpr_write_b32 a253, v6
    s_waitcnt vmcnt(0)
    s_waitcnt lgkmcnt(0)
    s_barrier
    s_waitcnt lgkmcnt(0)
    s_add_u32 s56, s56, 0x9e3779b9
    s_cmp_lg_u32 s59, 0
    s_cbranch_scc1 L_SF632
    s_lshl_b32 s70, s57, 7
    s_lshl_b32 s71, s58, 2
    s_add_u32 s70, s70, s71
    s_add_u32 s70, s70, 10240
    v_mov_b32 v248, s56
    v_mov_b32 v249, 0
    s_mov_b64 exec, 1
    buffer_store_dword v248, v249, s[48:51], s70 offen sc1
    s_mov_b64 exec, -1
L_SF632:
    s_mul_i32 s72, s60, 12
    s_add_u32 s72, s72, s61
    s_sub_u32 s72, s72, 20
    s_min_u32 s77, s72, 79
    s_lshl_b32 s77, s77, 3
    s_mul_i32 s78, s77, 160
    s_add_u32 s78, s78, 21045248
    s_cmp_lt_u32 s72, 80
    s_cselect_b32 s79, 0, 2147418112
    v_add_u32 v2, 0, v0
    v_mul_u32_u24 v3, 13108, v2
    v_lshrrev_b32 v3, 20, v3
    v_mul_u32_u24 v4, 80, v3
    v_sub_u32 v4, v2, v4
    v_mul_u32_u24 v5, 6554, v4
    v_lshrrev_b32 v5, 16, v5
    v_mul_u32_u24 v6, 10, v5
    v_sub_u32 v6, v4, v6
    v_add_u32 v5, s77, v5
    v_and_b32 v7, 0xffe0, v5
    v_bfe_u32 v8, v5, 2, 2
    v_lshl_add_u32 v7, v8, 3, v7
    v_bfe_u32 v8, v5, 4, 1
    v_lshl_add_u32 v7, v8, 2, v7
    v_and_b32 v8, 3, v5
    v_add_u32 v7, v7, v8
    v_mul_u32_u24 v7, 1280, v7
    v_mul_u32_u24 v8, 160, v3
    v_lshlrev_b32 v6, 4, v6
    v_add3_u32 v7, v7, v8, v6
    s_mov_b32 s70, 102400
    v_mul_lo_u32 v3, v3, s70
    v_lshl_add_u32 v46, v4, 4, v3
    v_or_b32 v46, s79, v46
    buffer_load_dwordx4 v[88:91], v7, s[16:19], 0 offen
    v_add_u32 v2, 256, v0
    v_mul_u32_u24 v3, 13108, v2
    v_lshrrev_b32 v3, 20, v3
    v_mul_u32_u24 v4, 80, v3
    v_sub_u32 v4, v2, v4
    v_mul_u32_u24 v5, 6554, v4
    v_lshrrev_b32 v5, 16, v5
    v_mul_u32_u24 v6, 10, v5
    v_sub_u32 v6, v4, v6
    v_add_u32 v5, s77, v5
    v_and_b32 v7, 0xffe0, v5
    v_bfe_u32 v8, v5, 2, 2
    v_lshl_add_u32 v7, v8, 3, v7
    v_bfe_u32 v8, v5, 4, 1
    v_lshl_add_u32 v7, v8, 2, v7
    v_and_b32 v8, 3, v5
    v_add_u32 v7, v7, v8
    v_mul_u32_u24 v7, 1280, v7
    v_mul_u32_u24 v8, 160, v3
    v_lshlrev_b32 v6, 4, v6
    v_add3_u32 v7, v7, v8, v6
    s_mov_b32 s70, 102400
    v_mul_lo_u32 v3, v3, s70
    v_lshl_add_u32 v47, v4, 4, v3
    v_or_b32 v47, s79, v47
    buffer_load_dwordx4 v[92:95], v7, s[16:19], 0 offen
    v_add_u32 v2, 512, v0
    v_mul_u32_u24 v3, 13108, v2
    v_lshrrev_b32 v3, 20, v3
    v_mul_u32_u24 v4, 80, v3
    v_sub_u32 v4, v2, v4
    v_mul_u32_u24 v5, 6554, v4
    v_lshrrev_b32 v5, 16, v5
    v_mul_u32_u24 v6, 10, v5
    v_sub_u32 v6, v4, v6
    v_add_u32 v5, s77, v5
    v_and_b32 v7, 0xffe0, v5
    v_bfe_u32 v8, v5, 2, 2
    v_lshl_add_u32 v7, v8, 3, v7
    v_bfe_u32 v8, v5, 4, 1
    v_lshl_add_u32 v7, v8, 2, v7
    v_and_b32 v8, 3, v5
    v_add_u32 v7, v7, v8
    v_mul_u32_u24 v7, 1280, v7
    v_mul_u32_u24 v8, 160, v3
    s_branch L_PSK1
L_PAD1:
    s_setpc_b64 s[100:101]
L_PSK1:
    v_lshlrev_b32 v6, 4, v6
    v_add3_u32 v7, v7, v8, v6
    s_mov_b32 s70, 102400
    v_mul_lo_u32 v3, v3, s70
    v_lshl_add_u32 v48, v4, 4, v3
    v_or_b32 v48, s79, v48
    v_cmp_gt_u32 vcc, 640, v2
    v_mov_b32 v8, 2147418112
    s_nop 0
    v_cndmask_b32 v7, v8, v7, vcc
    v_cndmask_b32 v48, v8, v48, vcc
    buffer_load_dwordx4 v[96:99], v7, s[16:19], 0 offen
    s_waitcnt vmcnt(2)
    buffer_store_dwordx4 v[88:91], v46, s[48:51], s78 offen sc1
    s_waitcnt vmcnt(2)
    buffer_store_dwordx4 v[92:95], v47, s[48:51], s78 offen sc1
    s_waitcnt vmcnt(2)
    buffer_store_dwordx4 v[96:99], v48, s[48:51], s78 offen sc1
    s_branch L_A_DONE
L_A_T1:
    s_lshl_b32 s70, s63, 2
    s_add_u32 s70, s70, s59
    s_mul_i32 s71, s70, 80
    s_mul_i32 s72, s62, 61440
    s_add_u32 s71, s71, s72
    s_lshl_b32 s74, s59, 12
    v_add_u32 v4, 0, v1
    v_min_u32 v4, 239, v4
    v_mul_u32_u24 v5, 4370, v4
    v_lshrrev_b32 v5, 16, v5
    v_mul_u32_u24 v6, 15, v5
    v_sub_u32 v4, v4, v6
    v_mul_u32_u24 v6, 13, v4
    v_lshrrev_b32 v6, 6, v6
    v_mul_u32_u24 v7, 5, v6
    v_sub_u32 v4, v4, v7
    v_mul_u32_u24 v5, 3840, v5
    v_mul_u32_u24 v6, 1280, v6
    v_lshlrev_b32 v4, 4, v4
    v_add3_u32 v4, v4, v5, v6
    s_add_u32 m0, s74, 40960
    s_nop 0
    buffer_load_dwordx4 v4, s[8:11], s71 offen nt lds
    v_add_u32 v4, 64, v1
    v_min_u32 v4, 239, v4
    v_mul_u32_u24 v5, 4370, v4
    v_lshrrev_b32 v5, 16, v5
    v_mul_u32_u24 v6, 15, v5
    v_sub_u32 v4, v4, v6
    v_mul_u32_u24 v6, 13, v4
    v_lshrrev_b32 v6, 6, v6
    v_mul_u32_u24 v7, 5, v6
    v_sub_u32 v4, v4, v7
    v_mul_u32_u24 v5, 3840, v5
    v_mul_u32_u24 v6, 1280, v6
    v_lshlrev_b32 v4, 4, v4
    v_add3_u32 v4, v4, v5, v6
    s_add_u32 m0, s74, 41984
    s_nop 0
    buffer_load_dwordx4 v4, s[8:11], s71 offen nt lds
    v_add_u32 v4, 128, v1
    v_min_u32 v4, 239, v4
    v_mul_u32_u24 v5, 4370, v4
    v_lshrrev_b32 v5, 16, v5
    v_mul_u32_u24 v6, 15, v5
    v_sub_u32 v4, v4, v6
    v_mul_u32_u24 v6, 13, v4
    v_lshrrev_b32 v6, 6, v6
    v_mul_u32_u24 v7, 5, v6
    v_sub_u32 v4, v4, v7
    v_mul_u32_u24 v5, 3840, v5
    v_mul_u32_u24 v6, 1280, v6
    v_lshlrev_b32 v4, 4, v4
    v_add3_u32 v4, v4, v5, v6
    s_add_u32 m0, s74, 43008
    s_nop 0
    buffer_load_dwordx4 v4, s[8:11], s71 offen nt lds
    v_add_u32 v4, 192, v1
    v_min_u32 v4, 239, v4
    v_mul_u32_u24 v5, 4370, v4
    v_lshrrev_b32 v5, 16, v5
    v_mul_u32_u24 v6, 15, v5
    v_sub_u32 v4, v4, v6
    v_mul_u32_u24 v6, 13, v4
    v_lshrrev_b32 v6, 6, v6
    v_mul_u32_u24 v7, 5, v6
    v_sub_u32 v4, v4, v7
    v_mul_u32_u24 v5, 3840, v5
    v_mul_u32_u24 v6, 1280, v6
    v_lshlrev_b32 v4, 4, v4
    v_add3_u32 v4, v4, v5, v6
    s_add_u32 m0, s74, 44032
    s_nop 0
    buffer_load_dwordx4 v4, s[8:11], s71 offen nt lds
    s_and_b32 s70, s59, 1
    s_lshl_b32 s71, s70, 6
    v_add_u32 v4, s71, v1
    v_min_u32 v4, 99, v4
    v_lshlrev_b32 v4, 4, v4
    s_mul_i32 s72, s58, 1600
    s_lshl_b32 s70, s70, 10
    s_add_u32 m0, s70, 153600
    s_nop 0
    buffer_load_dwordx4 v4, s[12:15], s72 offen lds
    v_lshrrev_b32 v3, 2, v1
    s_mul_i32 s70, s59, 160
    v_add_u32 v3, s70, v3
    s_movk_i32 s71, 7680
    v_mul_lo_u32 v3, v3, s71
    s_lshl_b32 s72, s64, 1
    s_lshl_b32 s73, s65, 1
    v_and_b32 v4, 2, v1
    v_cmp_eq_u32 vcc, 0, v4
    v_mov_b32 v5, s73
    v_mov_b32 v6, s72
    v_cndmask_b32 v5, v5, v6, vcc
    v_and_b32 v4, 1, v1
    v_lshlrev_b32 v4, 4, v4
    v_add3_u32 v3, v3, v5, v4
    s_mul_i32 s74, s59, 10240
    s_mov_b32 s75, 0
    s_add_u32 m0, s74, 0
    s_nop 0
    buffer_load_dwordx4 v3, s[40:43], s75 offen  lds
    s_add_u32 m0, s74, 1024
    s_add_u32 s75, s75, 122880
    buffer_load_dwordx4 v3, s[40:43], s75 offen  lds
    s_add_u32 m0, s74, 2048
    s_add_u32 s75, s75, 122880
    buffer_load_dwordx4 v3, s[40:43], s75 offen  lds
    s_add_u32 m0, s74, 3072
    s_add_u32 s75, s75, 122880
    buffer_load_dwordx4 v3, s[40:43], s75 offen  lds
    s_cmp_lg_u32 s59, 0
    s_cbranch_scc1 L_TC856
    s_call_b64 s[100:101], L_PAD4
L_TC856:
    s_cmp_lg_u32 s59, 1
    s_cbranch_scc1 L_TC860
    s_call_b64 s[100:101], L_PAD5
L_TC860:
    s_cmp_lg_u32 s59, 2
    s_cbranch_scc1 L_TC864
    s_call_b64 s[100:101], L_PAD6
L_TC864:
    s_cmp_lg_u32 s59, 3
    s_cbranch_scc1 L_TC868
    s_call_b64 s[100:101], L_PAD7
L_TC868:
    s_waitcnt vmcnt(10)
    v_lshlrev_b32 v104, 16, v12
    v_and_b32 v105, 0xffff0000, v12
    v_lshlrev_b32 v106, 16, v13
    v_and_b32 v107, 0xffff0000, v13
    v_lshlrev_b32 v108, 16, v14
    v_and_b32 v109, 0xffff0000, v14
    v_lshlrev_b32 v110, 16, v15
    v_and_b32 v111, 0xffff0000, v15
    v_lshlrev_b32 v112, 16, v16
    v_and_b32 v113, 0xffff0000, v16
    v_lshlrev_b32 v114, 16, v17
    v_and_b32 v115, 0xffff0000, v17
    v_lshlrev_b32 v116, 16, v18
    v_and_b32 v117, 0xffff0000, v18
    v_lshlrev_b32 v118, 16, v19
    v_and_b32 v119, 0xffff0000, v19
    v_lshlrev_b32 v120, 16, v20
    v_and_b32 v121, 0xffff0000, v20
    v_lshlrev_b32 v122, 16, v21
    v_and_b32 v123, 0xffff0000, v21
    v_lshlrev_b32 v124, 16, v22
    v_and_b32 v125, 0xffff0000, v22
    v_lshlrev_b32 v126, 16, v23
    v_and_b32 v127, 0xffff0000, v23
    v_pk_add_f32 v[30:31], v[104:105], v[106:107]
    v_pk_mul_f32 v[32:33], v[104:105], v[104:105]
    v_pk_fma_f32 v[32:33], v[106:107], v[106:107], v[32:33]
    v_pk_add_f32 v[30:31], v[30:31], v[108:109]
    v_pk_fma_f32 v[32:33], v[108:109], v[108:109], v[32:33]
    v_pk_add_f32 v[30:31], v[30:31], v[110:111]
    v_pk_fma_f32 v[32:33], v[110:111], v[110:111], v[32:33]
    v_pk_add_f32 v[30:31], v[30:31], v[112:113]
    v_pk_fma_f32 v[32:33], v[112:113], v[112:113], v[32:33]
    v_pk_add_f32 v[30:31], v[30:31], v[114:115]
    v_pk_fma_f32 v[32:33], v[114:115], v[114:115], v[32:33]
    v_pk_add_f32 v[30:31], v[30:31], v[116:117]
    v_pk_fma_f32 v[32:33], v[116:117], v[116:117], v[32:33]
    v_pk_add_f32 v[30:31], v[30:31], v[118:119]
    v_pk_fma_f32 v[32:33], v[118:119], v[118:119], v[32:33]
    v_pk_add_f32 v[30:31], v[30:31], v[120:121]
    v_pk_fma_f32 v[32:33], v[120:121], v[120:121], v[32:33]
    v_pk_add_f32 v[30:31], v[30:31], v[122:123]
    v_pk_fma_f32 v[32:33], v[122:123], v[122:123], v[32:33]
    v_pk_add_f32 v[30:31], v[30:31], v[124:125]
    v_pk_fma_f32 v[32:33], v[124:125], v[124:125], v[32:33]
    v_pk_add_f32 v[30:31], v[30:31], v[126:127]
    v_pk_fma_f32 v[32:33], v[126:127], v[126:127], v[32:33]
    v_add_f32 v30, v30, v31
    v_add_f32 v31, v32, v33
    s_waitcnt vmcnt(9)
    v_lshlrev_b32 v24, 16, v10
    v_and_b32 v25, 0xffff0000, v10
    v_lshlrev_b32 v26, 16, v11
    v_and_b32 v27, 0xffff0000, v11
    v_mul_f32 v36, s68, v24
    v_mul_f32 v37, s68, v25
    v_mul_f32 v38, s68, v26
    v_mul_f32 v39, s68, v27
    v_add_f32_dpp v30, v30, v30 row_ror:8 row_mask:0xf bank_mask:0xf
    v_add_f32_dpp v31, v31, v31 row_ror:8 row_mask:0xf bank_mask:0xf
    v_exp_f32 v36, -v36
    v_exp_f32 v37, -v37
    v_exp_f32 v38, -v38
    v_exp_f32 v39, -v39
    v_mov_b32 v32, v30
    v_mov_b32 v33, v31
    v_add_f32 v36, 1.0, v36
    v_add_f32 v37, 1.0, v37
    v_permlane16_swap_b32 v32, v30
    v_permlane16_swap_b32 v33, v31
    v_add_f32 v30, v30, v32
    v_add_f32 v31, v31, v33
    v_mov_b32 v32, v30
    v_mov_b32 v33, v31
    v_add_f32 v38, 1.0, v38
    v_add_f32 v39, 1.0, v39
    v_permlane32_swap_b32 v32, v30
    v_permlane32_swap_b32 v33, v31
    v_add_f32 v30, v30, v32
    v_add_f32 v31, v31, v33
    v_rcp_f32 v36, v36
    v_rcp_f32 v37, v37
    v_rcp_f32 v38, v38
    v_rcp_f32 v39, v39
    s_lshl_b32 s70, s59, 6
    v_lshl_add_u32 v6, v8, 3, s70
    v_add_u32 v6, 59904, v6
    ds_write_b64 v6, v[30:31]
    v_mul_f32 v24, v24, v36
    v_mul_f32 v25, v25, v37
    v_mul_f32 v26, v26, v38
    v_mul_f32 v27, v27, v39
    v_cvt_pk_bf16_f32 v24, v24, v25
    v_cvt_pk_bf16_f32 v25, v26, v27
    v_add_u32 v2, 57344, v2
    ds_write_b64 v2, v[24:25]
    v_mov_b32 v28, 0
    v_mov_b32 v29, 0
    v_mov_b32 v30, 0
    v_mov_b32 v31, 0
    v_min_u32 v26, 47, v1
    v_lshlrev_b32 v26, 4, v26
    v_add_u32 v26, 155648, v26
    ds_write_b128 v26, v[28:31]
    v_lshlrev_b32 v2, 3, v8
    v_add_u32 v2, 59904, v2
    s_waitcnt lgkmcnt(0)
    s_barrier
    ds_read_b64 v[32:33], v2 offset:0
    ds_read_b64 v[34:35], v2 offset:64
    ds_read_b64 v[36:37], v2 offset:128
    ds_read_b64 v[38:39], v2 offset:192
    s_lshl_b32 s70, s57, 2
    s_lshr_b32 s71, s58, 2
    s_add_u32 s70, s70, s71
    s_mul_i32 s70, s70, 40960
    s_and_b32 s71, s58, 3
    s_lshl_b32 s71, s71, 7
    s_add_u32 s70, s70, s71
    s_add_u32 s70, s70, 3891200
    v_lshrrev_b32 v4, 1, v9
    v_lshlrev_b32 v4, 10, v4
    v_and_b32 v5, 1, v9
    v_lshlrev_b32 v5, 9, v5
    v_lshlrev_b32 v6, 4, v8
    v_add3_u32 v4, v4, v5, v6
    v_cmp_gt_u32 vcc, 16, v9
    v_mov_b32 v5, 2147418112
    v_add_u32 v6, 32768, v4
    v_cndmask_b32 v5, v5, v6, vcc
    v_add_u32 v6, 16384, v4
    s_waitcnt lgkmcnt(0)
    v_pk_add_f32 v[32:33], v[32:33], v[34:35]
    v_pk_add_f32 v[36:37], v[36:37], v[38:39]
    v_pk_add_f32 v[32:33], v[32:33], v[36:37]
    v_mul_f32 v32, 0x3acccccd, v32
    v_mul_f32 v33, 0x3acccccd, v33
    v_fma_f32 v33, -v32, v32, v33
    v_max_f32 v33, 0, v33
    v_add_f32 v33, 0x3727c5ac, v33
    v_rsq_f32 v34, v33
    s_nop 0
    v_mul_f32 v36, v32, v34
    v_sub_f32 v36, 0, v36
    v_mov_b32 v35, v34
    v_mov_b32 v37, v36
    v_pk_fma_f32 v[104:105], v[104:105], v[34:35], v[36:37]
    v_pk_fma_f32 v[106:107], v[106:107], v[34:35], v[36:37]
    v_pk_fma_f32 v[108:109], v[108:109], v[34:35], v[36:37]
    v_pk_fma_f32 v[110:111], v[110:111], v[34:35], v[36:37]
    v_pk_fma_f32 v[112:113], v[112:113], v[34:35], v[36:37]
    v_pk_fma_f32 v[114:115], v[114:115], v[34:35], v[36:37]
    v_pk_fma_f32 v[116:117], v[116:117], v[34:35], v[36:37]
    v_pk_fma_f32 v[118:119], v[118:119], v[34:35], v[36:37]
    v_pk_fma_f32 v[120:121], v[120:121], v[34:35], v[36:37]
    v_pk_fma_f32 v[122:123], v[122:123], v[34:35], v[36:37]
    v_pk_fma_f32 v[124:125], v[124:125], v[34:35], v[36:37]
    v_pk_fma_f32 v[126:127], v[126:127], v[34:35], v[36:37]
    v_cvt_pk_bf16_f32 v12, v104, v105
    v_cvt_pk_bf16_f32 v13, v106, v107
    v_cvt_pk_bf16_f32 v14, v108, v109
    v_cvt_pk_bf16_f32 v15, v110, v111
    v_cvt_pk_bf16_f32 v16, v112, v113
    v_cvt_pk_bf16_f32 v17, v114, v115
    v_cvt_pk_bf16_f32 v18, v116, v117
    v_cvt_pk_bf16_f32 v19, v118, v119
    v_cvt_pk_bf16_f32 v20, v120, v121
    v_cvt_pk_bf16_f32 v21, v122, v123
    v_cvt_pk_bf16_f32 v22, v124, v125
    v_cvt_pk_bf16_f32 v23, v126, v127
    buffer_store_dwordx4 v[12:15], v4, s[48:51], s70 offen sc1
    buffer_store_dwordx4 v[16:19], v6, s[48:51], s70 offen sc1
    buffer_store_dwordx4 v[20:23], v5, s[48:51], s70 offen sc1
    s_add_u32 m0, s74, 4096
    s_add_u32 s75, s75, 122880
    buffer_load_dwordx4 v3, s[40:43], s75 offen  lds
    s_add_u32 m0, s74, 5120
    s_add_u32 s75, s75, 122880
    buffer_load_dwordx4 v3, s[40:43], s75 offen  lds
    s_add_u32 m0, s74, 6144
    s_add_u32 s75, s75, 122880
    buffer_load_dwordx4 v3, s[40:43], s75 offen  lds
    s_add_u32 m0, s74, 7168
    s_add_u32 s75, s75, 122880
    buffer_load_dwordx4 v3, s[40:43], s75 offen  lds
    s_add_u32 m0, s74, 8192
    s_add_u32 s75, s75, 122880
    buffer_load_dwordx4 v3, s[40:43], s75 offen  lds
    s_add_u32 m0, s74, 9216
    s_add_u32 s75, s75, 122880
    buffer_load_dwordx4 v3, s[40:43], s75 offen  lds
    v_lshrrev_b32 v2, 4, v1
    s_mul_i32 s70, s59, 320
    v_lshlrev_b32 v5, 3, v2
    v_add_u32 v5, s70, v5
    v_add_u32 v5, 57344, v5
    ds_read_b64 v[32:33], v5 offset:0
    ds_read_b64 v[34:35], v5 offset:32
    ds_read_b64 a[204:205], v5 offset:0
    ds_read_b64 a[206:207], v5 offset:32
    ds_read_b64 v[36:37], v5 offset:64
    ds_read_b64 v[38:39], v5 offset:96
    ds_read_b64 a[208:209], v5 offset:64
    ds_read_b64 a[210:211], v5 offset:96
    ds_read_b64 v[40:41], v5 offset:128
    ds_read_b64 v[42:43], v5 offset:160
    ds_read_b64 a[212:213], v5 offset:128
    ds_read_b64 a[214:215], v5 offset:160
    ds_read_b64 v[44:45], v5 offset:192
    ds_read_b64 v[46:47], v5 offset:224
    ds_read_b64 a[216:217], v5 offset:192
    ds_read_b64 a[218:219], v5 offset:224
    ds_read_b64 v[48:49], v5 offset:256
    ds_read_b64 v[50:51], v5 offset:288
    ds_read_b64 a[220:221], v5 offset:256
    ds_read_b64 a[222:223], v5 offset:288
    s_mul_i32 s70, s58, 153600
    s_add_u32 s74, s70, 1433600
    s_sub_u32 s70, s59, 1
    s_lshl_b32 s70, s70, 12
    s_add_u32 s73, s74, s70
    s_mov_b32 s75, s70
    s_min_u32 s83, s2, 215
    s_mul_i32 s84, s83, 10240
    s_mul_i32 s85, s83, 1280
    s_add_u32 s85, s85, 18833408
    s_cmp_lt_u32 s2, 216
    s_cselect_b32 s86, 0, 2147418112
    v_add_u32 v2, 0, v0
    v_mul_u32_u24 v3, 13108, v2
    v_lshrrev_b32 v3, 20, v3
    v_mul_u32_u24 v4, 80, v3
    v_sub_u32 v4, v2, v4
    v_mul_u32_u24 v5, 6554, v4
    v_lshrrev_b32 v5, 16, v5
    v_mul_u32_u24 v6, 10, v5
    v_sub_u32 v6, v4, v6
    v_mul_u32_u24 v5, 1280, v5
    v_mul_u32_u24 v7, 160, v3
    v_lshlrev_b32 v6, 4, v6
    v_add3_u32 v9, v5, v7, v6
    s_mov_b32 s70, 276480
    v_mul_lo_u32 v3, v3, s70
    v_lshl_add_u32 v10, v4, 4, v3
    v_or_b32 v10, s86, v10
    v_accvgpr_write_b32 a184, v9
    v_accvgpr_write_b32 a187, v10
    v_add_u32 v2, 256, v0
    v_mul_u32_u24 v3, 13108, v2
    v_lshrrev_b32 v3, 20, v3
    v_mul_u32_u24 v4, 80, v3
    v_sub_u32 v4, v2, v4
    v_mul_u32_u24 v5, 6554, v4
    v_lshrrev_b32 v5, 16, v5
    v_mul_u32_u24 v6, 10, v5
    v_sub_u32 v6, v4, v6
    v_mul_u32_u24 v5, 1280, v5
    v_mul_u32_u24 v7, 160, v3
    v_lshlrev_b32 v6, 4, v6
    v_add3_u32 v9, v5, v7, v6
    s_mov_b32 s70, 276480
    v_mul_lo_u32 v3, v3, s70
    v_lshl_add_u32 v10, v4, 4, v3
    v_or_b32 v10, s86, v10
    v_accvgpr_write_b32 a185, v9
    v_accvgpr_write_b32 a188, v10
    v_add_u32 v2, 512, v0
    v_mul_u32_u24 v3, 13108, v2
    v_lshrrev_b32 v3, 20, v3
    v_mul_u32_u24 v4, 80, v3
    v_sub_u32 v4, v2, v4
    v_mul_u32_u24 v5, 6554, v4
    v_lshrrev_b32 v5, 16, v5
    v_mul_u32_u24 v6, 10, v5
    v_sub_u32 v6, v4, v6
    v_mul_u32_u24 v5, 1280, v5
    v_mul_u32_u24 v7, 160, v3
    v_lshlrev_b32 v6, 4, v6
    v_add3_u32 v9, v5, v7, v6
    s_mov_b32 s70, 276480
    v_mul_lo_u32 v3, v3, s70
    v_lshl_add_u32 v10, v4, 4, v3
    v_or_b32 v10, s86, v10
    v_cmp_gt_u32 vcc, 640, v2
    v_mov_b32 v7, 2147418112
    s_nop 0
    v_cndmask_b32 v9, v7, v9, vcc
    v_cndmask_b32 v10, v7, v10, vcc
    v_accvgpr_write_b32 a186, v9
    v_accvgpr_write_b32 a189, v10
    v_and_b32 v2, 31, v1
    v_and_b32 v3, 1, v2
    v_lshrrev_b32 v4, 1, v2
    v_lshlrev_b32 v3, 8, v3
    v_lshl_add_u32 v3, v4, 4, v3
    s_lshl_b32 s70, s59, 9
    v_add_u32 v3, s70, v3
    v_add_u32 v5, 158464, v3
    v_lshlrev_b32 v2, 4, v2
    v_add_u32 v6, 158464, v2
    v_add_u32 v2, s70, v2
    v_add_u32 v7, 156416, v2
    v_accvgpr_write_b32 a191, v5
    v_accvgpr_write_b32 a192, v6
    v_accvgpr_write_b32 a193, v7
    v_lshrrev_b32 v2, 5, v1
    v_lshlrev_b32 v2, 8, v2
    v_add_u32 v2, s70, v2
    v_add_u32 v2, 156416, v2
    v_accvgpr_write_b32 a234, v2
    v_and_b32 v2, 31, v0
    v_lshrrev_b32 v3, 5, v0
    v_mul_u32_u24 v3, 2560, v3
    v_lshl_add_u32 v4, v2, 4, v3
    v_accvgpr_write_b32 a190, v4
    s_mul_i32 s87, s58, 20480
    s_add_u32 s87, s87, 57344
    s_lshl_b32 s70, s59, 3
    s_lshl_b32 s71, s70, 10
    s_add_u32 s88, s71, 122880
    s_add_u32 s89, s88, s74
    s_add_u32 s70, s70, 4
    s_min_u32 s70, s70, 26
    s_lshl_b32 s71, s70, 10
    s_add_u32 s90, s71, 122880
    s_add_u32 s91, s90, s74
    v_and_b32 v2, 31, v1
    s_lshl_b32 s70, s59, 5
    v_add_u32 v2, s70, v2
    v_lshrrev_b32 v3, 5, v1
    v_lshl_add_u32 v2, v3, 7, v2
    v_mul_u32_u24 v4, 80, v2
    v_mul_u32_u24 v5, 48, v2
    v_add_u32 v5, 20480, v5
    v_accvgpr_write_b32 a235, v4
    v_accvgpr_write_b32 a236, v5
    s_lshr_b32 s70, s59, 1
    s_and_b32 s71, s59, 1
    v_lshrrev_b32 v2, 5, v1
    v_bfe_u32 v3, v1, 2, 2
    v_lshl_add_u32 v2, v2, 3, v3
    v_bfe_u32 v4, v1, 4, 1
    v_and_b32 v5, 3, v1
    v_lshl_add_u32 v6, v4, 2, v5
    v_and_b32 v7, 1, v6
    v_lshrrev_b32 v6, 1, v6
    v_lshrrev_b32 v8, 1, v6
    v_lshlrev_b32 v8, 2, v8
    v_lshl_add_u32 v8, v7, 1, v8
    v_and_b32 v6, 1, v6
    v_add_u32 v8, v8, v6
    v_mul_u32_u24 v9, 80, v2
    v_lshl_add_u32 v9, v8, 3, v9
    s_mul_i32 s76, s70, 10240
    s_lshl_b32 s77, s71, 6
    s_add_u32 s76, s76, s77
    v_add_u32 v9, s76, v9
    v_mul_u32_u24 v10, 48, v2
    v_lshl_add_u32 v10, v4, 5, v10
    v_lshl_add_u32 v10, v5, 3, v10
    s_mul_i32 s76, s70, 6144
    s_add_u32 s76, s76, 20480
    v_add_u32 v10, s76, v10
    v_and_b32 v2, 31, v1
    v_lshrrev_b32 v3, 5, v1
    v_mul_u32_u24 v4, 80, v2
    v_lshl_add_u32 v4, v3, 4, v4
    s_mul_i32 s76, s70, 1680
    s_lshl_b32 s77, s71, 6
    s_add_u32 s76, s76, s77
    v_add_u32 v4, s76, v4
    v_mov_b32 v5, 2147418112
    v_cmp_gt_u32 vcc, 21, v2
    s_nop 1
    v_cndmask_b32 v4, v5, v4, vcc
    v_add_u32 v6, 32, v4
    v_mul_u32_u24 v7, s71, v3
    v_cmp_eq_u32 vcc, 0, v7
    s_nop 1
    v_cndmask_b32 v4, v5, v4, vcc
    s_cmp_eq_u32 s71, 0
    s_cselect_b32 s76, 0, 2147418112
    v_or_b32 v6, s76, v6
    s_lshl_b32 s76, s58, 4
    s_add_u32 s76, s76, s57
    s_mul_i32 s76, s76, 3584
    s_add_u32 s93, s76, 516096
    v_accvgpr_write_b32 a237, v9
    v_accvgpr_write_b32 a238, v10
    v_accvgpr_write_b32 a239, v4
    v_accvgpr_write_b32 a240, v6
    v_and_b32 v2, 31, v1
    v_subrev_u32 v3, 8, v2
    v_cmp_gt_u32 vcc, 24, v2
    s_nop 1
    v_cndmask_b32 v2, v3, v2, vcc
    v_lshrrev_b32 v3, 5, v1
    v_mul_u32_u24 v3, 384, v3
    v_lshl_add_u32 v2, v2, 4, v3
    v_add_u32 v2, 122880, v2
    s_min_u32 s92, s61, 19
    s_mul_i32 s76, s60, 20
    s_add_u32 s92, s92, s76
    s_lshl_b32 s95, s92, 5
    s_add_u32 s95, s95, 2560
    v_lshrrev_b32 v4, 1, v1
    s_mul_i32 s70, s59, 160
    v_add_u32 v4, s70, v4
    s_movk_i32 s71, 7680
    v_mul_lo_u32 v4, v4, s71
    v_and_b32 v3, 1, v1
    v_lshl_add_u32 v4, v3, 4, v4
    s_mul_i32 s82, s59, 5120
    v_lshrrev_b32 v5, 4, v1
    v_bfe_u32 v3, v1, 2, 2
    v_lshl_add_u32 v5, v5, 2, v3
    v_lshlrev_b32 v5, 5, v5
    v_and_b32 v3, 3, v1
    v_lshl_add_u32 v5, v3, 3, v5
    v_add_u32 v5, s82, v5
    v_add_u32 v5, 102400, v5
    v_accvgpr_write_b32 a241, v2
    v_accvgpr_write_b32 a242, v4
    v_accvgpr_write_b32 a250, v5
    v_min_u32 v2, 209, v0
    v_lshlrev_b32 v3, 4, v2
    v_cmp_lt_u32 vcc, 104, v2
    v_mov_b32 v4, 240
    s_nop 0
    v_cndmask_b32 v4, 0, v4, vcc
    v_add_u32 v4, v3, v4
    v_add_u32 v4, 158464, v4
    v_accvgpr_write_b32 a243, v3
    v_accvgpr_write_b32 a244, v4
    v_lshrrev_b32 v2, 5, v1
    v_bfe_u32 v3, v1, 2, 1
    v_bfe_u32 v4, v1, 3, 2
    v_and_b32 v5, 3, v1
    v_add_u32 v6, v4, v3
    v_lshl_add_u32 v6, v6, 2, v5
    v_cmp_eq_u32 vcc, 0, v3
    v_mov_b32 v7, 4
    s_nop 0
    v_cndmask_b32 v7, 0, v7, vcc
    v_cmp_eq_u32 vcc, 0, v4
    v_mov_b32 v8, 5
    s_nop 0
    v_cndmask_b32 v7, v8, v7, vcc
    v_lshl_add_u32 v7, v7, 2, v5
    v_mul_u32_u24 v8, 1920, v3
    v_add_u32 v8, 158464, v8
    v_mul_u32_u24 v6, 80, v6
    v_mul_u32_u24 v7, 80, v7
    v_add_u32 v6, v6, v8
    v_add_u32 v7, v7, v8
    v_mov_b32 v9, 155648
    v_cmp_eq_u32 vcc, v2, v3
    s_nop 1
    v_cndmask_b32 v6, v9, v6, vcc
    v_cndmask_b32 v7, v9, v7, vcc
    v_accvgpr_write_b32 a245, v6
    v_accvgpr_write_b32 a246, v7
    v_and_b32 v2, 15, v1
    v_bfe_u32 v3, v1, 4, 1
    v_lshrrev_b32 v4, 5, v1
    v_mul_u32_u24 v5, 20480, v3
    v_lshl_add_u32 v5, v2, 4, v5
    v_mul_u32_u24 v6, 768, v4
    v_add_u32 v6, v6, v5
    v_lshl_add_u32 v7, v4, 3, v5
    v_add_u32 v7, 512, v7
    s_lshl_b32 s70, s57, 3
    s_lshl_b32 s71, s59, 1
    s_add_u32 s70, s70, s71
    s_mul_i32 s70, s70, 20480
    s_mul_i32 s71, s58, 1280
    s_add_u32 s70, s70, s71
    s_add_u32 s94, s70, 6512640
    v_accvgpr_write_b32 a247, v6
    v_accvgpr_write_b32 a248, v7
    v_mul_u32_u24 v2, 4682, v1
    v_lshrrev_b32 v2, 16, v2
    v_mul_u32_u24 v3, 14, v2
    v_sub_u32 v3, v1, v3
    v_mul_u32_u24 v2, 3456, v2
    v_lshl_add_u32 v2, v3, 7, v2
    v_cmp_gt_u32 vcc, 56, v1
    v_mov_b32 v4, 2147418112
    s_nop 0
    v_cndmask_b32 v5, v4, v2, vcc
    v_add_u32 v2, 13824, v2
    v_cmp_gt_u32 vcc, 14, v1
    s_nop 1
    v_cndmask_b32 v2, v4, v2, vcc
    v_mul_u32_u24 v6, 13108, v1
    v_lshrrev_b32 v6, 16, v6
    v_mul_u32_u24 v3, 5, v6
    v_sub_u32 v3, v1, v3
    v_mul_u32_u24 v6, 7680, v6
    v_lshl_add_u32 v6, v3, 7, v6
    v_cmp_gt_u32 vcc, 25, v1
    s_nop 1
    v_cndmask_b32 v6, v4, v6, vcc
    v_accvgpr_write_b32 a251, v5
    v_accvgpr_write_b32 a252, v2
    v_accvgpr_write_b32 a253, v6
    v_lshrrev_b32 v2, 4, v1
    v_bfe_u32 v3, v1, 2, 2
    v_and_b32 v4, 3, v1
    v_lshl_add_u32 v6, v2, 2, v3
    v_lshlrev_b32 v6, 6, v6
    v_lshl_add_u32 v6, v4, 3, v6
    s_mul_i32 s71, s59, 10240
    v_add_u32 v11, s71, v6
    v_lshrrev_b32 v2, 5, v1
    v_bfe_u32 v3, v1, 2, 2
    v_lshl_add_u32 v2, v2, 3, v3
    v_mul_u32_u24 v2, 240, v2
    s_lshl_b32 s70, s59, 12
    v_add_u32 v2, s70, v2
    v_add_u32 v2, 40960, v2
    v_bfe_u32 v3, v1, 4, 1
    v_and_b32 v4, 3, v1
    v_lshl_add_u32 v3, v3, 2, v4
    v_and_b32 v4, 1, v3
    v_mul_u32_u24 v4, 40, v4
    v_add_u32 v2, v2, v4
    s_branch L_PSK2
L_PAD2:
    s_setpc_b64 s[100:101]
L_PSK2:
    v_lshrrev_b32 v3, 1, v3
    v_mov_b32 v7, 80
    v_cmp_eq_u32 vcc, 1, v3
    v_mov_b32 v8, 88
    s_nop 0
    v_cndmask_b32 v7, v7, v8, vcc
    v_cmp_eq_u32 vcc, 2, v3
    v_mov_b32 v8, 96
    s_nop 0
    v_cndmask_b32 v7, v7, v8, vcc
    v_cmp_eq_u32 vcc, 3, v3
    v_mov_b32 v8, 104
    s_nop 0
    v_cndmask_b32 v7, v7, v8, vcc
    v_add_u32 v100, v2, v7
    v_mov_b32 v7, 112
    v_cmp_eq_u32 vcc, 1, v3
    v_mov_b32 v8, 160
    s_nop 0
    v_cndmask_b32 v7, v7, v8, vcc
    v_cmp_eq_u32 vcc, 2, v3
    v_mov_b32 v8, 168
    s_nop 0
    v_cndmask_b32 v7, v7, v8, vcc
    v_cmp_eq_u32 vcc, 3, v3
    v_mov_b32 v8, 176
    s_nop 0
    v_cndmask_b32 v7, v7, v8, vcc
    v_add_u32 v101, v2, v7
    v_mov_b32 v7, 184
    v_cmp_eq_u32 vcc, 1, v3
    v_mov_b32 v8, 192
    s_nop 0
    v_cndmask_b32 v7, v7, v8, vcc
    v_cmp_eq_u32 vcc, 2, v3
    v_mov_b32 v8, 0
    s_nop 0
    v_cndmask_b32 v7, v7, v8, vcc
    v_cmp_eq_u32 vcc, 3, v3
    v_mov_b32 v8, 8
    s_nop 0
    v_cndmask_b32 v7, v7, v8, vcc
    v_add_u32 v102, v2, v7
    v_mov_b32 v7, 16
    v_cmp_eq_u32 vcc, 1, v3
    v_mov_b32 v8, 24
    s_nop 0
    v_cndmask_b32 v7, v7, v8, vcc
    v_cmp_eq_u32 vcc, 2, v3
    v_mov_b32 v8, 32
    s_nop 0
    v_cndmask_b32 v7, v7, v8, vcc
    v_cmp_eq_u32 vcc, 3, v3
    v_mov_b32 v8, 32
    s_nop 0
    v_cndmask_b32 v7, v7, v8, vcc
    v_add_u32 v103, v2, v7
    s_lshl_b32 s70, s63, 2
    s_add_u32 s70, s70, s59
    s_mul_i32 s71, s70, 153600
    s_add_u32 s71, s71, 1433600
    s_mul_i32 s77, s62, 3072
    s_add_u32 s77, s77, s71
    s_mul_i32 s78, s62, 768
    s_add_u32 s78, s78, s71
    s_add_u32 s78, s78, 122880
    s_mul_i32 s79, s70, 40
    s_add_u32 s79, s79, s62
    s_lshl_b32 s79, s79, 9
    s_add_u32 s79, s79, 57344
    v_lshlrev_b32 v7, 4, v1
    v_and_b32 v8, 31, v1
    v_lshrrev_b32 v9, 5, v1
    v_mul_u32_u24 v9, 384, v9
    v_lshl_add_u32 v9, v8, 4, v9
    v_cmp_gt_u32 vcc, 24, v8
    v_mov_b32 v10, 2147418112
    s_nop 0
    v_cndmask_b32 v9, v10, v9, vcc
    v_lshlrev_b32 v8, 2, v8
    v_cmp_gt_u32 vcc, 32, v1
    s_nop 1
    v_cndmask_b32 v8, v10, v8, vcc
    s_waitcnt vmcnt(0)
    ds_read_b64_tr_b16 v[56:57], v11 offset:0
    ds_read_b64_tr_b16 v[58:59], v11 offset:1024
    ds_read_b64_tr_b16 v[60:61], v11 offset:32
    ds_read_b64_tr_b16 v[62:63], v11 offset:1056
    ds_read_b64_tr_b16 v[64:65], v11 offset:2048
    ds_read_b64_tr_b16 v[66:67], v11 offset:3072
    ds_read_b64_tr_b16 v[68:69], v11 offset:2080
    ds_read_b64_tr_b16 v[70:71], v11 offset:3104
    ds_read_b64_tr_b16 v[72:73], v11 offset:4096
    ds_read_b64_tr_b16 v[74:75], v11 offset:5120
    ds_read_b64_tr_b16 v[76:77], v11 offset:4128
    ds_read_b64_tr_b16 v[78:79], v11 offset:5152
    ds_read_b64_tr_b16 v[80:81], v11 offset:6144
    ds_read_b64_tr_b16 v[82:83], v11 offset:7168
    ds_read_b64_tr_b16 v[84:85], v11 offset:6176
    ds_read_b64_tr_b16 v[86:87], v11 offset:7200
    ds_read_b64_tr_b16 v[88:89], v11 offset:8192
    ds_read_b64_tr_b16 v[90:91], v11 offset:9216
    ds_read_b64_tr_b16 v[92:93], v11 offset:8224
    ds_read_b64_tr_b16 v[94:95], v11 offset:9248
    s_waitcnt lgkmcnt(15)
    v_mfma_f32_16x16x32_bf16 v[120:123], v[32:35], v[56:59], 0
    v_mfma_f32_16x16x32_bf16 v[124:127], v[32:35], v[60:63], 0
    s_waitcnt lgkmcnt(12)
    v_mfma_f32_16x16x32_bf16 v[120:123], v[36:39], v[64:67], v[120:123]
    v_mfma_f32_16x16x32_bf16 v[124:127], v[36:39], v[68:71], v[124:127]
    s_waitcnt lgkmcnt(8)
    v_mfma_f32_16x16x32_bf16 v[120:123], v[40:43], v[72:75], v[120:123]
    v_mfma_f32_16x16x32_bf16 v[124:127], v[40:43], v[76:79], v[124:127]
    s_waitcnt lgkmcnt(4)
    v_mfma_f32_16x16x32_bf16 v[120:123], v[44:47], v[80:83], v[120:123]
    v_mfma_f32_16x16x32_bf16 v[124:127], v[44:47], v[84:87], v[124:127]
    s_waitcnt lgkmcnt(0)
    v_mfma_f32_16x16x32_bf16 v[120:123], v[48:51], v[88:91], v[120:123]
    v_mfma_f32_16x16x32_bf16 v[124:127], v[48:51], v[92:95], v[124:127]
    s_lshl_b32 s70, s59, 7
    v_and_b32 v3, 15, v1
    v_lshl_add_u32 v3, v3, 2, s70
    v_add_u32 v3, 59392, v3
    s_nop 2
    ds_write_b32 v3, v120
    ds_write_b32 v3, v124 offset:64
    v_lshrrev_b32 v3, 5, v1
    v_lshlrev_b32 v3, 5, v3
    v_add_u32 v3, 59392, v3
    s_waitcnt lgkmcnt(0)
    s_barrier
    s_waitcnt lgkmcnt(0)
    s_add_u32 s56, s56, 0x9e3779b9
    s_cmp_lg_u32 s59, 0
    s_cbranch_scc1 L_SF1507
    s_lshl_b32 s70, s57, 7
    s_lshl_b32 s71, s58, 2
    s_add_u32 s70, s70, s71
    s_add_u32 s70, s70, 10240
    v_mov_b32 v248, s56
    v_mov_b32 v249, 0
    s_mov_b64 exec, 1
    buffer_store_dword v248, v249, s[48:51], s70 offen sc1
    s_mov_b64 exec, -1
L_SF1507:
    ds_read_b128 v[136:139], v3 offset:0
    ds_read_b128 v[140:143], v3 offset:16
    ds_read_b128 v[144:147], v3 offset:64
    ds_read_b128 v[148:151], v3 offset:80
    ds_read_b128 v[152:155], v3 offset:128
    ds_read_b128 v[156:159], v3 offset:144
    ds_read_b128 v[160:163], v3 offset:192
    ds_read_b128 v[164:167], v3 offset:208
    ds_read_b128 v[168:171], v3 offset:256
    ds_read_b128 v[172:175], v3 offset:272
    ds_read_b128 v[176:179], v3 offset:320
    ds_read_b128 v[180:183], v3 offset:336
    ds_read_b128 v[184:187], v3 offset:384
    ds_read_b128 v[188:191], v3 offset:400
    ds_read_b128 v[192:195], v3 offset:448
    ds_read_b128 v[196:199], v3 offset:464
    ds_read_b64_tr_b16 v[44:45], v100
    ds_read_b64_tr_b16 v[46:47], v100 offset:960
    ds_read_b64_tr_b16 v[48:49], v101
    ds_read_b64_tr_b16 v[50:51], v101 offset:960
    ds_read_b64_tr_b16 v[52:53], v102
    ds_read_b64_tr_b16 v[54:55], v102 offset:960
    ds_read_b64_tr_b16 v[56:57], v103
    ds_read_b64_tr_b16 v[58:59], v103 offset:960
    s_waitcnt lgkmcnt(8)
    v_pk_add_f32 v[136:137], v[136:137], v[152:153]
    v_pk_add_f32 v[168:169], v[168:169], v[184:185]
    v_pk_add_f32 v[136:137], v[136:137], v[168:169]
    v_pk_add_f32 v[138:139], v[138:139], v[154:155]
    v_pk_add_f32 v[170:171], v[170:171], v[186:187]
    v_pk_add_f32 v[138:139], v[138:139], v[170:171]
    v_pk_add_f32 v[140:141], v[140:141], v[156:157]
    v_pk_add_f32 v[172:173], v[172:173], v[188:189]
    v_pk_add_f32 v[140:141], v[140:141], v[172:173]
    v_pk_add_f32 v[142:143], v[142:143], v[158:159]
    v_pk_add_f32 v[174:175], v[174:175], v[190:191]
    v_pk_add_f32 v[142:143], v[142:143], v[174:175]
    v_pk_add_f32 v[144:145], v[144:145], v[160:161]
    v_pk_add_f32 v[176:177], v[176:177], v[192:193]
    v_pk_add_f32 v[144:145], v[144:145], v[176:177]
    v_pk_add_f32 v[146:147], v[146:147], v[162:163]
    v_pk_add_f32 v[178:179], v[178:179], v[194:195]
    v_pk_add_f32 v[146:147], v[146:147], v[178:179]
    v_pk_add_f32 v[148:149], v[148:149], v[164:165]
    v_pk_add_f32 v[180:181], v[180:181], v[196:197]
    v_pk_add_f32 v[148:149], v[148:149], v[180:181]
    v_pk_add_f32 v[150:151], v[150:151], v[166:167]
    v_pk_add_f32 v[182:183], v[182:183], v[198:199]
    v_pk_add_f32 v[150:151], v[150:151], v[182:183]
    v_cvt_pk_bf16_f32 v152, v136, v137
    v_cvt_pk_bf16_f32 v153, v138, v139
    v_cvt_pk_bf16_f32 v154, v140, v141
    v_cvt_pk_bf16_f32 v155, v142, v143
    v_cvt_pk_bf16_f32 v156, v144, v145
    v_cvt_pk_bf16_f32 v157, v146, v147
    v_cvt_pk_bf16_f32 v158, v148, v149
    v_cvt_pk_bf16_f32 v159, v150, v151
    v_lshlrev_b32 v136, 16, v152
    v_and_b32 v137, 0xffff0000, v152
    v_lshlrev_b32 v138, 16, v153
    v_and_b32 v139, 0xffff0000, v153
    v_lshlrev_b32 v140, 16, v154
    v_and_b32 v141, 0xffff0000, v154
    v_lshlrev_b32 v142, 16, v155
    v_and_b32 v143, 0xffff0000, v155
    v_lshlrev_b32 v144, 16, v156
    v_and_b32 v145, 0xffff0000, v156
    v_lshlrev_b32 v146, 16, v157
    v_and_b32 v147, 0xffff0000, v157
    v_lshlrev_b32 v148, 16, v158
    v_and_b32 v149, 0xffff0000, v158
    v_lshlrev_b32 v150, 16, v159
    v_and_b32 v151, 0xffff0000, v159
    v_add_f32 v136, 1.0, v136
    v_add_f32 v137, 1.0, v137
    v_add_f32 v138, 1.0, v138
    v_add_f32 v139, 1.0, v139
    v_add_f32 v140, 1.0, v140
    v_add_f32 v141, 1.0, v141
    v_add_f32 v142, 1.0, v142
    v_add_f32 v143, 1.0, v143
    v_cvt_pk_bf16_f32 v152, v136, v137
    v_cvt_pk_bf16_f32 v153, v138, v139
    v_cvt_pk_bf16_f32 v154, v140, v141
    v_cvt_pk_bf16_f32 v155, v142, v143
    v_lshlrev_b32 v136, 16, v152
    v_and_b32 v137, 0xffff0000, v152
    v_lshlrev_b32 v138, 16, v153
    v_and_b32 v139, 0xffff0000, v153
    v_lshlrev_b32 v140, 16, v154
    v_and_b32 v141, 0xffff0000, v154
    v_lshlrev_b32 v142, 16, v155
    v_and_b32 v143, 0xffff0000, v155
    s_waitcnt lgkmcnt(0)
    v_lshlrev_b32 v64, 16, v44
    v_and_b32 v65, 0xffff0000, v44
    v_lshlrev_b32 v66, 16, v45
    v_and_b32 v67, 0xffff0000, v45
    v_lshlrev_b32 v68, 16, v46
    v_and_b32 v69, 0xffff0000, v46
    v_lshlrev_b32 v70, 16, v47
    v_and_b32 v71, 0xffff0000, v47
    v_mul_f32 v72, v64, v144
    v_fmac_f32 v72, v65, v145
    v_fmac_f32 v72, v66, v146
    v_fmac_f32 v72, v67, v147
    v_fmac_f32 v72, v68, v148
    v_fmac_f32 v72, v69, v149
    v_fmac_f32 v72, v70, v150
    v_fmac_f32 v72, v71, v151
    v_pk_mul_f32 v[64:65], v[64:65], v[136:137]
    v_pk_mul_f32 v[66:67], v[66:67], v[138:139]
    v_pk_mul_f32 v[68:69], v[68:69], v[140:141]
    v_pk_mul_f32 v[70:71], v[70:71], v[142:143]
    v_cvt_pk_bf16_f32 v76, v64, v65
    v_cvt_pk_bf16_f32 v77, v66, v67
    v_cvt_pk_bf16_f32 v78, v68, v69
    v_cvt_pk_bf16_f32 v79, v70, v71
    buffer_store_dwordx4 v[76:79], v7, s[48:51], s77 offen offset:0 sc1
    v_mov_b32 v73, v72
    s_nop 1
    v_permlane32_swap_b32 v73, v72
    v_add_f32 v92, v72, v73
    v_lshlrev_b32 v64, 16, v48
    v_and_b32 v65, 0xffff0000, v48
    v_lshlrev_b32 v66, 16, v49
    v_and_b32 v67, 0xffff0000, v49
    v_lshlrev_b32 v68, 16, v50
    v_and_b32 v69, 0xffff0000, v50
    v_lshlrev_b32 v70, 16, v51
    v_and_b32 v71, 0xffff0000, v51
    v_mul_f32 v72, v64, v144
    v_fmac_f32 v72, v65, v145
    v_fmac_f32 v72, v66, v146
    v_fmac_f32 v72, v67, v147
    v_fmac_f32 v72, v68, v148
    v_fmac_f32 v72, v69, v149
    v_fmac_f32 v72, v70, v150
    v_fmac_f32 v72, v71, v151
    v_pk_mul_f32 v[64:65], v[64:65], v[136:137]
    v_pk_mul_f32 v[66:67], v[66:67], v[138:139]
    v_pk_mul_f32 v[68:69], v[68:69], v[140:141]
    v_pk_mul_f32 v[70:71], v[70:71], v[142:143]
    v_cvt_pk_bf16_f32 v80, v64, v65
    v_cvt_pk_bf16_f32 v81, v66, v67
    v_cvt_pk_bf16_f32 v82, v68, v69
    v_cvt_pk_bf16_f32 v83, v70, v71
    buffer_store_dwordx4 v[80:83], v7, s[48:51], s77 offen offset:1024 sc1
    v_mov_b32 v73, v72
    s_nop 1
    v_permlane32_swap_b32 v73, v72
    v_add_f32 v93, v72, v73
    v_lshlrev_b32 v64, 16, v52
    v_and_b32 v65, 0xffff0000, v52
    v_lshlrev_b32 v66, 16, v53
    v_and_b32 v67, 0xffff0000, v53
    v_lshlrev_b32 v68, 16, v54
    v_and_b32 v69, 0xffff0000, v54
    v_lshlrev_b32 v70, 16, v55
    v_and_b32 v71, 0xffff0000, v55
    v_mul_f32 v72, v64, v144
    v_fmac_f32 v72, v65, v145
    v_fmac_f32 v72, v66, v146
    v_fmac_f32 v72, v67, v147
    v_fmac_f32 v72, v68, v148
    v_fmac_f32 v72, v69, v149
    v_fmac_f32 v72, v70, v150
    v_fmac_f32 v72, v71, v151
    v_pk_mul_f32 v[64:65], v[64:65], v[136:137]
    v_pk_mul_f32 v[66:67], v[66:67], v[138:139]
    v_pk_mul_f32 v[68:69], v[68:69], v[140:141]
    v_pk_mul_f32 v[70:71], v[70:71], v[142:143]
    v_cvt_pk_bf16_f32 v84, v64, v65
    v_cvt_pk_bf16_f32 v85, v66, v67
    v_cvt_pk_bf16_f32 v86, v68, v69
    v_cvt_pk_bf16_f32 v87, v70, v71
    buffer_store_dwordx4 v[84:87], v7, s[48:51], s77 offen offset:2048 sc1
    v_mov_b32 v73, v72
    s_nop 1
    v_permlane32_swap_b32 v73, v72
    v_add_f32 v94, v72, v73
    v_lshlrev_b32 v64, 16, v56
    v_and_b32 v65, 0xffff0000, v56
    v_lshlrev_b32 v66, 16, v57
    v_and_b32 v67, 0xffff0000, v57
    v_lshlrev_b32 v68, 16, v58
    v_and_b32 v69, 0xffff0000, v58
    v_lshlrev_b32 v70, 16, v59
    v_and_b32 v71, 0xffff0000, v59
    v_mul_f32 v72, v64, v144
    v_fmac_f32 v72, v65, v145
    v_fmac_f32 v72, v66, v146
    v_fmac_f32 v72, v67, v147
    v_fmac_f32 v72, v68, v148
    v_fmac_f32 v72, v69, v149
    v_fmac_f32 v72, v70, v150
    v_fmac_f32 v72, v71, v151
    v_pk_mul_f32 v[64:65], v[64:65], v[136:137]
    v_pk_mul_f32 v[66:67], v[66:67], v[138:139]
    v_pk_mul_f32 v[68:69], v[68:69], v[140:141]
    v_pk_mul_f32 v[70:71], v[70:71], v[142:143]
    v_cvt_pk_bf16_f32 v88, v64, v65
    v_cvt_pk_bf16_f32 v89, v66, v67
    v_cvt_pk_bf16_f32 v90, v68, v69
    v_cvt_pk_bf16_f32 v91, v70, v71
    buffer_store_dwordx4 v[88:91], v9, s[48:51], s78 offen sc1
    v_mov_b32 v73, v72
    s_nop 1
    v_permlane32_swap_b32 v73, v72
    v_add_f32 v95, v72, v73
    buffer_store_dword v92, v8, s[48:51], s79 offen offset:0 sc1
    buffer_store_dword v93, v8, s[48:51], s79 offen offset:128 sc1
    buffer_store_dword v94, v8, s[48:51], s79 offen offset:256 sc1
    buffer_store_dword v95, v8, s[48:51], s79 offen offset:384 sc1
L_A_DONE:
    s_cmp_lg_u32 s59, 1
    s_cbranch_scc1 L_TC1734
    s_call_b64 s[100:101], L_PAD8
L_TC1734:
    s_cmp_lg_u32 s59, 2
    s_cbranch_scc1 L_TC1738
    s_call_b64 s[100:101], L_PAD9
L_TC1738:
    s_cmp_lg_u32 s59, 3
    s_cbranch_scc1 L_TC1742
    s_call_b64 s[100:101], L_PAD10
L_TC1742:
    s_cmp_lg_u32 s59, 0
    s_cbranch_scc1 L_PD1746
    s_lshl_b32 s70, s57, 7
    s_add_u32 s70, s70, 10240
    s_mov_b32 s71, 1048576
    v_min_u32 v248, 15, v1
    v_lshlrev_b32 v248, 2, v248
L_PL1746:
    buffer_load_dword v250, v248, s[48:51], s70 offen sc1
    s_waitcnt vmcnt(0)
    v_cmp_ne_u32 vcc, s56, v250
    s_sub_u32 s71, s71, 1
    s_cmp_eq_u32 s71, 0
    s_cbranch_scc1 L_PT1746
    s_cbranch_vccnz L_PL1746
    s_branch L_PD1746
L_PT1746:
    v_mov_b32 v250, 161
    v_mov_b32 v251, 0
    buffer_store_dword v250, v251, s[52:55], 0 offen
    s_waitcnt vmcnt(0)
L_PD1746:
    s_waitcnt vmcnt(0)
    s_barrier
    s_cmp_eq_u32 s66, 1
    s_cbranch_scc0 L_FT21770
    s_cmp_lg_u32 s59, 0
    s_cbranch_scc1 L_SF1772
    s_lshl_b32 s70, s63, 12
    s_lshl_b32 s71, s62, 2
    s_add_u32 s70, s70, s71
    s_add_u32 s70, s70, 40960
    v_mov_b32 v248, s56
    v_mul_u32_u24 v249, 1024, v1
    s_mov_b64 exec, 15
    buffer_store_dword v248, v249, s[48:51], s70 offen sc1
    s_mov_b64 exec, -1
L_SF1772:
    s_branch L_FT31770
L_FT21770:
    s_cmp_lg_u32 s59, 0
    s_cbranch_scc1 L_SF1786
    s_mul_i32 s70, s60, 12
    s_add_u32 s70, s70, s61
    s_add_u32 s70, s70, 20
    s_lshl_b32 s70, s70, 2
    s_add_u32 s70, s70, 40960
    v_mov_b32 v248, s56
    v_mul_u32_u24 v249, 1024, v1
    s_mov_b64 exec, 65535
    buffer_store_dword v248, v249, s[48:51], s70 offen sc1
    s_mov_b64 exec, -1
L_SF1786:
L_FT31770:
    v_lshlrev_b32 v39, 4, v1
    s_lshl_b32 s70, s57, 2
    s_add_u32 s70, s70, s59
    s_mul_i32 s70, s70, 40960
    s_add_u32 s72, s70, 3891200
    v_mov_b32 v40, v39
    s_cmp_eq_u32 s59, 0
    s_cbranch_scc0 L_XP1806
    v_accvgpr_read_b32 v28, a184
    v_accvgpr_read_b32 v32, a187
    v_accvgpr_read_b32 v29, a185
    v_accvgpr_read_b32 v33, a188
    v_accvgpr_read_b32 v30, a186
    v_accvgpr_read_b32 v34, a189
    v_accvgpr_read_b32 v31, a190
    v_accvgpr_read_b32 v35, a191
    v_accvgpr_read_b32 v36, a192
    v_accvgpr_read_b32 v37, a193
    v_add_u32 v38, 0x10000, v39
    v_lshrrev_b32 v2, 5, v1
    v_bfe_u32 v3, v1, 2, 2
    v_bfe_u32 v4, v1, 4, 1
    v_and_b32 v5, 3, v1
    v_lshl_add_u32 v4, v4, 2, v5
    v_and_b32 v5, 1, v4
    v_lshrrev_b32 v4, 1, v4
    v_mul_u32_u24 v6, 800, v5
    v_mul_u32_u24 v7, 40, v3
    v_lshlrev_b32 v8, 3, v4
    v_add3_u32 v6, v6, v7, v8
    v_add_u32 v6, 153600, v6
    v_mov_b32 v7, 155648
    v_cmp_eq_u32 vcc, v2, v5
    s_nop 1
    v_cndmask_b32 v8, v7, v6, vcc
    v_cmp_eq_u32 vcc, 0, v4
    s_nop 1
    v_cndmask_b32 v9, v7, v8, vcc
    ds_read_b64_tr_b16 a[160:161], v8 offset:0
    ds_read_b64_tr_b16 a[162:163], v8 offset:160
    ds_read_b64_tr_b16 a[164:165], v8 offset:320
    ds_read_b64_tr_b16 a[166:167], v8 offset:480
    ds_read_b64_tr_b16 a[168:169], v8 offset:640
    v_accvgpr_write_b32 a170, 0
    v_accvgpr_write_b32 a171, 0
    ds_read_b64_tr_b16 a[172:173], v9 offset:32
    ds_read_b64_tr_b16 a[174:175], v9 offset:192
    ds_read_b64_tr_b16 a[176:177], v9 offset:352
    ds_read_b64_tr_b16 a[178:179], v9 offset:512
    ds_read_b64_tr_b16 a[180:181], v9 offset:672
    v_accvgpr_write_b32 a182, 0
    v_accvgpr_write_b32 a183, 0
    s_waitcnt lgkmcnt(0)
    s_and_b32 s62, s59, 1
    s_lshr_b32 s63, s59, 1
    s_lshr_b32 s64, s58, 1
    s_lshl_b32 s70, s57, 3
    s_and_b32 s71, s58, 1
    s_lshl_b32 s71, s71, 2
    s_add_u32 s70, s70, s71
    s_lshl_b32 s71, s62, 1
    s_add_u32 s70, s70, s71
    s_add_u32 s65, s70, s63
    s_lshr_b32 s70, s58, 2
    s_mul_i32 s70, s70, 27
    s_and_b32 s71, s58, 3
    s_mul_i32 s83, s71, 7
    s_add_u32 s66, s70, s83
    s_cmp_eq_u32 s71, 3
    s_cselect_b32 s67, 1, 0
    v_and_b32 v2, 15, v1
    s_lshl_b32 s70, s65, 4
    v_add_u32 v2, s70, v2
    v_mul_u32_u24 v2, 1280, v2
    v_lshrrev_b32 v3, 4, v1
    s_mul_i32 s71, s64, 160
    v_lshl_add_u32 v2, v3, 3, v2
    v_add_u32 v4, s71, v2
    v_accvgpr_write_b32 a249, v4
    s_branch L_XQ1806
L_XP1806:
    v_accvgpr_read_b32 v28, a184
    buffer_load_dwordx4 a[0:3], v40, s[48:51], s72 offen offset:0 sc1
    v_accvgpr_read_b32 v32, a187
    buffer_load_dwordx4 a[4:7], v40, s[48:51], s72 offen offset:1024 sc1
    v_accvgpr_read_b32 v29, a185
    buffer_load_dwordx4 a[8:11], v40, s[48:51], s72 offen offset:2048 sc1
    v_accvgpr_read_b32 v33, a188
    buffer_load_dwordx4 a[12:15], v40, s[48:51], s72 offen offset:3072 sc1
    v_add_u32 v40, 4096, v40
    v_accvgpr_read_b32 v30, a186
    buffer_load_dwordx4 a[16:19], v40, s[48:51], s72 offen offset:0 sc1
    v_accvgpr_read_b32 v34, a189
    buffer_load_dwordx4 a[20:23], v40, s[48:51], s72 offen offset:1024 sc1
    v_accvgpr_read_b32 v31, a190
    buffer_load_dwordx4 a[24:27], v40, s[48:51], s72 offen offset:2048 sc1
    v_accvgpr_read_b32 v35, a191
    buffer_load_dwordx4 a[28:31], v40, s[48:51], s72 offen offset:3072 sc1
    v_add_u32 v40, 4096, v40
    v_accvgpr_read_b32 v36, a192
    buffer_load_dwordx4 a[32:35], v40, s[48:51], s72 offen offset:0 sc1
    v_accvgpr_read_b32 v37, a193
    buffer_load_dwordx4 a[36:39], v40, s[48:51], s72 offen offset:1024 sc1
    v_add_u32 v38, 0x10000, v39
    buffer_load_dwordx4 a[40:43], v40, s[48:51], s72 offen offset:2048 sc1
    v_lshrrev_b32 v2, 5, v1
    buffer_load_dwordx4 a[44:47], v40, s[48:51], s72 offen offset:3072 sc1
    v_add_u32 v40, 4096, v40
    v_bfe_u32 v3, v1, 2, 2
    buffer_load_dwordx4 a[48:51], v40, s[48:51], s72 offen offset:0 sc1
    v_bfe_u32 v4, v1, 4, 1
    buffer_load_dwordx4 a[52:55], v40, s[48:51], s72 offen offset:1024 sc1
    v_and_b32 v5, 3, v1
    buffer_load_dwordx4 a[56:59], v40, s[48:51], s72 offen offset:2048 sc1
    v_lshl_add_u32 v4, v4, 2, v5
    buffer_load_dwordx4 a[60:63], v40, s[48:51], s72 offen offset:3072 sc1
    v_add_u32 v40, 4096, v40
    v_and_b32 v5, 1, v4
    buffer_load_dwordx4 a[64:67], v40, s[48:51], s72 offen offset:0 sc1
    v_lshrrev_b32 v4, 1, v4
    buffer_load_dwordx4 a[68:71], v40, s[48:51], s72 offen offset:1024 sc1
    v_mul_u32_u24 v6, 800, v5
    buffer_load_dwordx4 a[72:75], v40, s[48:51], s72 offen offset:2048 sc1
    v_mul_u32_u24 v7, 40, v3
    buffer_load_dwordx4 a[76:79], v40, s[48:51], s72 offen offset:3072 sc1
    v_add_u32 v40, 4096, v40
    v_lshlrev_b32 v8, 3, v4
    buffer_load_dwordx4 a[80:83], v40, s[48:51], s72 offen offset:0 sc1
    v_add3_u32 v6, v6, v7, v8
    buffer_load_dwordx4 a[84:87], v40, s[48:51], s72 offen offset:1024 sc1
    v_add_u32 v6, 153600, v6
    buffer_load_dwordx4 a[88:91], v40, s[48:51], s72 offen offset:2048 sc1
    v_mov_b32 v7, 155648
    buffer_load_dwordx4 a[92:95], v40, s[48:51], s72 offen offset:3072 sc1
    v_add_u32 v40, 4096, v40
    v_cmp_eq_u32 vcc, v2, v5
    buffer_load_dwordx4 a[96:99], v40, s[48:51], s72 offen offset:0 sc1
    s_nop 0
    v_cndmask_b32 v8, v7, v6, vcc
    buffer_load_dwordx4 a[100:103], v40, s[48:51], s72 offen offset:1024 sc1
    v_cmp_eq_u32 vcc, 0, v4
    buffer_load_dwordx4 a[104:107], v40, s[48:51], s72 offen offset:2048 sc1
    s_nop 0
    v_cndmask_b32 v9, v7, v8, vcc
    buffer_load_dwordx4 a[108:111], v40, s[48:51], s72 offen offset:3072 sc1
    v_add_u32 v40, 4096, v40
    ds_read_b64_tr_b16 a[160:161], v8 offset:0
    buffer_load_dwordx4 a[112:115], v40, s[48:51], s72 offen offset:0 sc1
    ds_read_b64_tr_b16 a[162:163], v8 offset:160
    buffer_load_dwordx4 a[116:119], v40, s[48:51], s72 offen offset:1024 sc1
    ds_read_b64_tr_b16 a[164:165], v8 offset:320
    buffer_load_dwordx4 a[120:123], v40, s[48:51], s72 offen offset:2048 sc1
    ds_read_b64_tr_b16 a[166:167], v8 offset:480
    buffer_load_dwordx4 a[124:127], v40, s[48:51], s72 offen offset:3072 sc1
    v_add_u32 v40, 4096, v40
    ds_read_b64_tr_b16 a[168:169], v8 offset:640
    buffer_load_dwordx4 a[128:131], v40, s[48:51], s72 offen offset:0 sc1
    v_accvgpr_write_b32 a170, 0
    buffer_load_dwordx4 a[132:135], v40, s[48:51], s72 offen offset:1024 sc1
    v_accvgpr_write_b32 a171, 0
    buffer_load_dwordx4 a[136:139], v40, s[48:51], s72 offen offset:2048 sc1
    ds_read_b64_tr_b16 a[172:173], v9 offset:32
    buffer_load_dwordx4 a[140:143], v40, s[48:51], s72 offen offset:3072 sc1
    v_add_u32 v40, 4096, v40
    ds_read_b64_tr_b16 a[174:175], v9 offset:192
    buffer_load_dwordx4 a[144:147], v40, s[48:51], s72 offen offset:0 sc1
    ds_read_b64_tr_b16 a[176:177], v9 offset:352
    buffer_load_dwordx4 a[148:151], v40, s[48:51], s72 offen offset:1024 sc1
    ds_read_b64_tr_b16 a[178:179], v9 offset:512
    buffer_load_dwordx4 a[152:155], v40, s[48:51], s72 offen offset:2048 sc1
    ds_read_b64_tr_b16 a[180:181], v9 offset:672
    buffer_load_dwordx4 a[156:159], v40, s[48:51], s72 offen offset:3072 sc1
    v_add_u32 v40, 4096, v40
    v_accvgpr_write_b32 a182, 0
    v_accvgpr_write_b32 a183, 0
    s_waitcnt lgkmcnt(0)
    s_and_b32 s62, s59, 1
    s_lshr_b32 s63, s59, 1
    s_lshr_b32 s64, s58, 1
    s_lshl_b32 s70, s57, 3
    s_and_b32 s71, s58, 1
    s_lshl_b32 s71, s71, 2
    s_add_u32 s70, s70, s71
    s_lshl_b32 s71, s62, 1
    s_add_u32 s70, s70, s71
    s_add_u32 s65, s70, s63
    s_lshr_b32 s70, s58, 2
    s_mul_i32 s70, s70, 27
    s_and_b32 s71, s58, 3
    s_mul_i32 s83, s71, 7
    s_add_u32 s66, s70, s83
    s_cmp_eq_u32 s71, 3
    s_cselect_b32 s67, 1, 0
    v_and_b32 v2, 15, v1
    s_lshl_b32 s70, s65, 4
    v_add_u32 v2, s70, v2
    v_mul_u32_u24 v2, 1280, v2
    v_lshrrev_b32 v3, 4, v1
    s_mul_i32 s71, s64, 160
    v_lshl_add_u32 v2, v3, 3, v2
    v_add_u32 v4, s71, v2
    v_accvgpr_write_b32 a249, v4
    v_accvgpr_read_b32 v2, a253
    s_lshl_b32 s70, s61, 2
    s_add_u32 s70, s70, s59
    s_mul_i32 s70, s70, 38400
    s_mul_i32 s71, s60, 640
    s_add_u32 s70, s70, s71
    s_add_u32 s70, s70, 2560
    buffer_load_dword v246, v2, s[40:43], s70 offen
    s_sub_u32 s71, s70, 38400
    s_cmp_eq_u32 s59, 1
    s_cselect_b32 s70, s71, s70
    buffer_load_dword v247, v2, s[40:43], s70 offen
L_XQ1806:
    s_cmp_lg_u32 s59, 0
    s_cbranch_scc1 L_PD2011
    s_lshr_b32 s70, s58, 2
    s_lshl_b32 s70, s70, 2
    s_lshr_b32 s71, s60, 1
    s_add_u32 s70, s70, s71
    s_lshl_b32 s70, s70, 10
    s_add_u32 s70, s70, 40960
    s_mov_b32 s71, 1048576
    v_min_u32 v248, 33, v1
    v_lshlrev_b32 v248, 4, v248
L_PL2011:
    buffer_load_dwordx4 v[250:253], v248, s[48:51], s70 offen sc1
    s_waitcnt vmcnt(0)
    v_xor_b32 v250, s56, v250
    v_xor_b32 v251, s56, v251
    v_xor_b32 v252, s56, v252
    v_xor_b32 v253, s56, v253
    v_or_b32 v250, v250, v251
    v_or_b32 v252, v252, v253
    v_or_b32 v250, v250, v252
    v_cmp_ne_u32 vcc, 0, v250
    s_sub_u32 s71, s71, 1
    s_cmp_eq_u32 s71, 0
    s_cbranch_scc1 L_PT2011
    s_cbranch_vccnz L_PL2011
    s_branch L_PD2011
L_PT2011:
    v_mov_b32 v250, 160
    v_mov_b32 v251, 0
    buffer_store_dword v250, v251, s[52:55], 0 offen
    s_waitcnt vmcnt(0)
L_PD2011:
    s_barrier
    s_cmp_eq_u32 s59, 0
    s_cbranch_scc0 L_B1W2045
    buffer_load_dwordx4 a[0:3], v39, s[48:51], s72 offen offset:0 sc1
    buffer_load_dwordx4 a[4:7], v39, s[48:51], s72 offen offset:1024 sc1
    buffer_load_dwordx4 a[8:11], v39, s[48:51], s72 offen offset:2048 sc1
    buffer_load_dwordx4 a[12:15], v39, s[48:51], s72 offen offset:3072 sc1
    s_add_u32 s72, s72, 4096
    buffer_load_dwordx4 a[16:19], v39, s[48:51], s72 offen offset:0 sc1
    buffer_load_dwordx4 a[20:23], v39, s[48:51], s72 offen offset:1024 sc1
    buffer_load_dwordx4 a[24:27], v39, s[48:51], s72 offen offset:2048 sc1
    buffer_load_dwordx4 a[28:31], v39, s[48:51], s72 offen offset:3072 sc1
    s_add_u32 s72, s72, 4096
    buffer_load_dwordx4 a[32:35], v39, s[48:51], s72 offen offset:0 sc1
    buffer_load_dwordx4 a[36:39], v39, s[48:51], s72 offen offset:1024 sc1
    buffer_load_dwordx4 a[40:43], v39, s[48:51], s72 offen offset:2048 sc1
    buffer_load_dwordx4 a[44:47], v39, s[48:51], s72 offen offset:3072 sc1
    s_add_u32 s72, s72, 4096
    s_branch L_PSK3
L_PAD3:
    s_setpc_b64 s[100:101]
L_PSK3:
    buffer_load_dwordx4 v[8:11], v31, s[48:51], s87 offen offset:0 sc1
    buffer_load_dwordx4 v[12:15], v31, s[48:51], s87 offen offset:512 sc1
    buffer_load_dwordx4 v[16:19], v31, s[48:51], s87 offen offset:1024 sc1
    buffer_load_dwordx4 v[20:23], v31, s[48:51], s87 offen offset:1536 sc1
    buffer_load_dwordx4 v[24:27], v31, s[48:51], s87 offen offset:2048 sc1
    s_waitcnt vmcnt(13)
    s_barrier
    ds_read_b128 v[40:43], v39 offset:0
    ds_read_b128 v[44:47], v39 offset:1024
    ds_read_b128 v[48:51], v39 offset:2048
    ds_read_b128 v[52:55], v39 offset:3072
    ds_read_b128 v[56:59], v39 offset:4096
    s_waitcnt lgkmcnt(4)
    v_mfma_f32_32x32x16_bf16 v[64:79], v[40:43], a[0:3], 0
    buffer_load_dwordx4 a[48:51], v39, s[48:51], s72 offen offset:0 sc1
    ds_read_b128 v[60:63], v39 offset:5120
    s_waitcnt lgkmcnt(4)
    v_mfma_f32_32x32x16_bf16 v[80:95], v[44:47], a[0:3], 0
    ds_read_b128 v[40:43], v39 offset:6144
    s_waitcnt lgkmcnt(4)
    v_mfma_f32_32x32x16_bf16 v[96:111], v[48:51], a[0:3], 0
    buffer_load_dwordx4 a[52:55], v39, s[48:51], s72 offen offset:1024 sc1
    ds_read_b128 v[44:47], v39 offset:7168
    s_waitcnt lgkmcnt(4)
    v_mfma_f32_32x32x16_bf16 v[64:79], v[52:55], a[4:7], v[64:79]
    ds_read_b128 v[48:51], v39 offset:8192
    s_waitcnt lgkmcnt(4)
    v_mfma_f32_32x32x16_bf16 v[80:95], v[56:59], a[4:7], v[80:95]
    buffer_load_dwordx4 a[56:59], v39, s[48:51], s72 offen offset:2048 sc1
    ds_read_b128 v[52:55], v39 offset:9216
    s_waitcnt lgkmcnt(4)
    v_mfma_f32_32x32x16_bf16 v[96:111], v[60:63], a[4:7], v[96:111]
    ds_read_b128 v[56:59], v39 offset:10240
    s_waitcnt lgkmcnt(4)
    v_mfma_f32_32x32x16_bf16 v[64:79], v[40:43], a[8:11], v[64:79]
    buffer_load_dwordx4 a[60:63], v39, s[48:51], s72 offen offset:3072 sc1
    s_add_u32 s72, s72, 4096
    ds_read_b128 v[60:63], v39 offset:11264
    s_waitcnt lgkmcnt(4)
    v_mfma_f32_32x32x16_bf16 v[80:95], v[44:47], a[8:11], v[80:95]
    s_waitcnt vmcnt(13)
    s_barrier
    ds_read_b128 v[40:43], v39 offset:12288
    s_waitcnt lgkmcnt(4)
    v_mfma_f32_32x32x16_bf16 v[96:111], v[48:51], a[8:11], v[96:111]
    ds_read_b128 v[44:47], v39 offset:13312
    s_waitcnt lgkmcnt(4)
    v_mfma_f32_32x32x16_bf16 v[64:79], v[52:55], a[12:15], v[64:79]
    ds_read_b128 v[48:51], v39 offset:14336
    s_waitcnt lgkmcnt(4)
    v_mfma_f32_32x32x16_bf16 v[80:95], v[56:59], a[12:15], v[80:95]
    ds_read_b128 v[52:55], v39 offset:15360
    s_waitcnt lgkmcnt(4)
    v_mfma_f32_32x32x16_bf16 v[96:111], v[60:63], a[12:15], v[96:111]
    ds_read_b128 v[56:59], v39 offset:16384
    s_waitcnt lgkmcnt(4)
    v_mfma_f32_32x32x16_bf16 v[64:79], v[40:43], a[16:19], v[64:79]
    buffer_load_dwordx4 a[64:67], v39, s[48:51], s72 offen offset:0 sc1
    ds_read_b128 v[60:63], v39 offset:17408
    s_waitcnt lgkmcnt(4)
    v_mfma_f32_32x32x16_bf16 v[80:95], v[44:47], a[16:19], v[80:95]
    ds_read_b128 v[40:43], v39 offset:18432
    s_waitcnt lgkmcnt(4)
    v_mfma_f32_32x32x16_bf16 v[96:111], v[48:51], a[16:19], v[96:111]
    buffer_load_dwordx4 a[68:71], v39, s[48:51], s72 offen offset:1024 sc1
    ds_read_b128 v[44:47], v39 offset:19456
    s_waitcnt lgkmcnt(4)
    v_mfma_f32_32x32x16_bf16 v[64:79], v[52:55], a[20:23], v[64:79]
    ds_read_b128 v[48:51], v39 offset:20480
    s_waitcnt lgkmcnt(4)
    v_mfma_f32_32x32x16_bf16 v[80:95], v[56:59], a[20:23], v[80:95]
    buffer_load_dwordx4 a[72:75], v39, s[48:51], s72 offen offset:2048 sc1
    ds_read_b128 v[52:55], v39 offset:21504
    s_waitcnt vmcnt(7)
    v_pk_add_f32 v[8:9], v[8:9], v[12:13]
    v_pk_add_f32 v[10:11], v[10:11], v[14:15]
    v_pk_add_f32 v[8:9], v[8:9], v[16:17]
    v_pk_add_f32 v[10:11], v[10:11], v[18:19]
    s_waitcnt lgkmcnt(4)
    v_mfma_f32_32x32x16_bf16 v[96:111], v[60:63], a[20:23], v[96:111]
    ds_read_b128 v[56:59], v39 offset:22528
    v_pk_add_f32 v[8:9], v[8:9], v[20:21]
    v_pk_add_f32 v[10:11], v[10:11], v[22:23]
    v_pk_add_f32 v[8:9], v[8:9], v[24:25]
    v_pk_add_f32 v[10:11], v[10:11], v[26:27]
    s_waitcnt lgkmcnt(4)
    v_mfma_f32_32x32x16_bf16 v[64:79], v[40:43], a[24:27], v[64:79]
    buffer_load_dwordx4 a[76:79], v39, s[48:51], s72 offen offset:3072 sc1
    s_add_u32 s72, s72, 4096
    ds_read_b128 v[60:63], v39 offset:23552
    v_mov_b32 v12, v8
    v_mov_b32 v13, v9
    v_mov_b32 v14, v10
    v_mov_b32 v15, v11
    s_waitcnt lgkmcnt(4)
    v_mfma_f32_32x32x16_bf16 v[80:95], v[44:47], a[24:27], v[80:95]
    s_barrier
    ds_read_b128 v[40:43], v39 offset:24576
    v_permlane32_swap_b32 v12, v8
    v_permlane32_swap_b32 v13, v9
    v_permlane32_swap_b32 v14, v10
    v_permlane32_swap_b32 v15, v11
    s_waitcnt lgkmcnt(4)
    v_mfma_f32_32x32x16_bf16 v[96:111], v[48:51], a[24:27], v[96:111]
    ds_read_b128 v[44:47], v39 offset:25600
    v_pk_add_f32 v[8:9], v[8:9], v[12:13]
    v_pk_add_f32 v[10:11], v[10:11], v[14:15]
    ds_write_b128 v35, v[8:11]
    s_waitcnt lgkmcnt(5)
    v_mfma_f32_32x32x16_bf16 v[64:79], v[52:55], a[28:31], v[64:79]
    ds_read_b128 v[48:51], v39 offset:26624
    s_waitcnt lgkmcnt(5)
    v_mfma_f32_32x32x16_bf16 v[80:95], v[56:59], a[28:31], v[80:95]
    ds_read_b128 v[52:55], v39 offset:27648
    s_waitcnt lgkmcnt(5)
    v_mfma_f32_32x32x16_bf16 v[96:111], v[60:63], a[28:31], v[96:111]
    ds_read_b128 v[56:59], v39 offset:28672
    s_waitcnt lgkmcnt(5)
    v_mfma_f32_32x32x16_bf16 v[64:79], v[40:43], a[32:35], v[64:79]
    buffer_load_dwordx4 a[80:83], v39, s[48:51], s72 offen offset:0 sc1
    ds_read_b128 v[60:63], v39 offset:29696
    s_waitcnt lgkmcnt(5)
    v_mfma_f32_32x32x16_bf16 v[80:95], v[44:47], a[32:35], v[80:95]
    ds_read_b128 v[40:43], v39 offset:30720
    s_waitcnt lgkmcnt(4)
    v_mfma_f32_32x32x16_bf16 v[96:111], v[48:51], a[32:35], v[96:111]
    buffer_load_dwordx4 a[84:87], v39, s[48:51], s72 offen offset:1024 sc1
    ds_read_b128 v[44:47], v39 offset:31744
    s_waitcnt lgkmcnt(4)
    v_mfma_f32_32x32x16_bf16 v[64:79], v[52:55], a[36:39], v[64:79]
    ds_read_b128 v[48:51], v39 offset:32768
    s_waitcnt lgkmcnt(4)
    v_mfma_f32_32x32x16_bf16 v[80:95], v[56:59], a[36:39], v[80:95]
    buffer_load_dwordx4 a[88:91], v39, s[48:51], s72 offen offset:2048 sc1
    ds_read_b128 v[52:55], v39 offset:33792
    s_waitcnt lgkmcnt(4)
    v_mfma_f32_32x32x16_bf16 v[96:111], v[60:63], a[36:39], v[96:111]
    ds_read_b128 v[56:59], v39 offset:34816
    s_waitcnt lgkmcnt(4)
    v_mfma_f32_32x32x16_bf16 v[64:79], v[40:43], a[40:43], v[64:79]
    buffer_load_dwordx4 a[92:95], v39, s[48:51], s72 offen offset:3072 sc1
    s_add_u32 s72, s72, 4096
    ds_read_b128 v[60:63], v39 offset:35840
    s_waitcnt lgkmcnt(4)
    v_mfma_f32_32x32x16_bf16 v[80:95], v[44:47], a[40:43], v[80:95]
    s_waitcnt vmcnt(8)
    s_barrier
    ds_read_b128 v[40:43], v39 offset:36864
    s_waitcnt lgkmcnt(4)
    v_mfma_f32_32x32x16_bf16 v[96:111], v[48:51], a[40:43], v[96:111]
    ds_read_b128 v[44:47], v39 offset:37888
    ds_read_b128 v[8:11], v36 offset:0
    ds_read_b128 v[12:15], v36 offset:512
    ds_read_b128 v[16:19], v36 offset:1024
    ds_read_b128 v[20:23], v36 offset:1536
    s_waitcnt lgkmcnt(8)
    v_mfma_f32_32x32x16_bf16 v[64:79], v[52:55], a[44:47], v[64:79]
    ds_read_b128 v[48:51], v39 offset:38912
    s_waitcnt lgkmcnt(8)
    v_mfma_f32_32x32x16_bf16 v[80:95], v[56:59], a[44:47], v[80:95]
    ds_read_b128 v[52:55], v39 offset:39936
    s_waitcnt lgkmcnt(8)
    v_mfma_f32_32x32x16_bf16 v[96:111], v[60:63], a[44:47], v[96:111]
    ds_read_b128 v[56:59], v39 offset:40960
    s_waitcnt lgkmcnt(8)
    v_mfma_f32_32x32x16_bf16 v[64:79], v[40:43], a[48:51], v[64:79]
    buffer_load_dwordx4 a[96:99], v39, s[48:51], s72 offen offset:0 sc1
    ds_read_b128 v[60:63], v39 offset:41984
    s_waitcnt lgkmcnt(8)
    v_mfma_f32_32x32x16_bf16 v[80:95], v[44:47], a[48:51], v[80:95]
    ds_read_b128 v[40:43], v39 offset:43008
    s_waitcnt lgkmcnt(5)
    v_pk_add_f32 v[8:9], v[8:9], v[12:13]
    v_pk_add_f32 v[10:11], v[10:11], v[14:15]
    v_pk_add_f32 v[16:17], v[16:17], v[20:21]
    v_pk_add_f32 v[18:19], v[18:19], v[22:23]
    s_waitcnt lgkmcnt(4)
    v_mfma_f32_32x32x16_bf16 v[96:111], v[48:51], a[48:51], v[96:111]
    buffer_load_dwordx4 a[100:103], v39, s[48:51], s72 offen offset:1024 sc1
    ds_read_b128 v[44:47], v39 offset:44032
    v_pk_add_f32 v[8:9], v[8:9], v[16:17]
    v_pk_add_f32 v[10:11], v[10:11], v[18:19]
    ds_write_b128 v37, v[8:11]
    s_waitcnt lgkmcnt(5)
    v_mfma_f32_32x32x16_bf16 v[64:79], v[52:55], a[52:55], v[64:79]
    ds_read_b128 v[48:51], v39 offset:45056
    s_waitcnt lgkmcnt(5)
    v_mfma_f32_32x32x16_bf16 v[80:95], v[56:59], a[52:55], v[80:95]
    buffer_load_dwordx4 a[104:107], v39, s[48:51], s72 offen offset:2048 sc1
    ds_read_b128 v[52:55], v39 offset:46080
    s_waitcnt lgkmcnt(5)
    v_mfma_f32_32x32x16_bf16 v[96:111], v[60:63], a[52:55], v[96:111]
    ds_read_b128 v[56:59], v39 offset:47104
    s_waitcnt lgkmcnt(5)
    v_mfma_f32_32x32x16_bf16 v[64:79], v[40:43], a[56:59], v[64:79]
    buffer_load_dwordx4 a[108:111], v39, s[48:51], s72 offen offset:3072 sc1
    s_add_u32 s72, s72, 4096
    ds_read_b128 v[60:63], v39 offset:48128
    s_waitcnt lgkmcnt(5)
    v_mfma_f32_32x32x16_bf16 v[80:95], v[44:47], a[56:59], v[80:95]
    s_waitcnt vmcnt(8)
    s_barrier
    ds_read_b128 v[40:43], v39 offset:49152
    s_waitcnt lgkmcnt(4)
    v_mfma_f32_32x32x16_bf16 v[96:111], v[48:51], a[56:59], v[96:111]
    buffer_load_dwordx4 v[208:211], v28, s[28:31], s84 offen
    ds_read_b128 v[44:47], v39 offset:50176
    s_waitcnt lgkmcnt(4)
    v_mfma_f32_32x32x16_bf16 v[64:79], v[52:55], a[60:63], v[64:79]
    ds_read_b128 v[48:51], v39 offset:51200
    s_waitcnt lgkmcnt(4)
    v_mfma_f32_32x32x16_bf16 v[80:95], v[56:59], a[60:63], v[80:95]
    buffer_load_dwordx4 v[212:215], v29, s[28:31], s84 offen
    ds_read_b128 v[52:55], v39 offset:52224
    s_waitcnt lgkmcnt(4)
    v_mfma_f32_32x32x16_bf16 v[96:111], v[60:63], a[60:63], v[96:111]
    ds_read_b128 v[56:59], v39 offset:53248
    s_waitcnt lgkmcnt(4)
    v_mfma_f32_32x32x16_bf16 v[64:79], v[40:43], a[64:67], v[64:79]
    buffer_load_dwordx4 v[216:219], v30, s[28:31], s84 offen
    ds_read_b128 v[60:63], v39 offset:54272
    s_waitcnt lgkmcnt(4)
    v_mfma_f32_32x32x16_bf16 v[80:95], v[44:47], a[64:67], v[80:95]
    ds_read_b128 v[40:43], v39 offset:55296
    s_waitcnt lgkmcnt(4)
    v_mfma_f32_32x32x16_bf16 v[96:111], v[48:51], a[64:67], v[96:111]
    buffer_load_dwordx4 a[112:115], v39, s[48:51], s72 offen offset:0 sc1
    ds_read_b128 v[44:47], v39 offset:56320
    s_waitcnt lgkmcnt(4)
    v_mfma_f32_32x32x16_bf16 v[64:79], v[52:55], a[68:71], v[64:79]
    ds_read_b128 v[48:51], v39 offset:57344
    s_waitcnt lgkmcnt(4)
    v_mfma_f32_32x32x16_bf16 v[80:95], v[56:59], a[68:71], v[80:95]
    buffer_load_dwordx4 a[116:119], v39, s[48:51], s72 offen offset:1024 sc1
    ds_read_b128 v[52:55], v39 offset:58368
    s_waitcnt lgkmcnt(4)
    v_mfma_f32_32x32x16_bf16 v[96:111], v[60:63], a[68:71], v[96:111]
    ds_read_b128 v[56:59], v39 offset:59392
    s_waitcnt lgkmcnt(4)
    v_mfma_f32_32x32x16_bf16 v[64:79], v[40:43], a[72:75], v[64:79]
    buffer_load_dwordx4 a[120:123], v39, s[48:51], s72 offen offset:2048 sc1
    ds_read_b128 v[60:63], v39 offset:60416
    s_waitcnt lgkmcnt(4)
    v_mfma_f32_32x32x16_bf16 v[80:95], v[44:47], a[72:75], v[80:95]
    s_waitcnt vmcnt(10)
    s_barrier
    ds_read_b128 v[40:43], v39 offset:61440
    s_waitcnt lgkmcnt(4)
    v_mfma_f32_32x32x16_bf16 v[96:111], v[48:51], a[72:75], v[96:111]
    buffer_load_dwordx4 a[124:127], v39, s[48:51], s72 offen offset:3072 sc1
    s_add_u32 s72, s72, 4096
    ds_read_b128 v[44:47], v39 offset:62464
    s_waitcnt lgkmcnt(4)
    v_mfma_f32_32x32x16_bf16 v[64:79], v[52:55], a[76:79], v[64:79]
    ds_read_b128 v[48:51], v39 offset:63488
    s_waitcnt lgkmcnt(4)
    v_mfma_f32_32x32x16_bf16 v[80:95], v[56:59], a[76:79], v[80:95]
    ds_read_b128 v[52:55], v39 offset:64512
    s_waitcnt lgkmcnt(4)
    v_mfma_f32_32x32x16_bf16 v[96:111], v[60:63], a[76:79], v[96:111]
    ds_read_b128 v[56:59], v38 offset:0
    s_waitcnt lgkmcnt(4)
    v_mfma_f32_32x32x16_bf16 v[64:79], v[40:43], a[80:83], v[64:79]
    buffer_load_dwordx4 a[128:131], v39, s[48:51], s72 offen offset:0 sc1
    ds_read_b128 v[60:63], v38 offset:1024
    s_waitcnt lgkmcnt(4)
    v_mfma_f32_32x32x16_bf16 v[80:95], v[44:47], a[80:83], v[80:95]
    ds_read_b128 v[40:43], v38 offset:2048
    s_waitcnt lgkmcnt(4)
    v_mfma_f32_32x32x16_bf16 v[96:111], v[48:51], a[80:83], v[96:111]
    buffer_load_dwordx4 a[132:135], v39, s[48:51], s72 offen offset:1024 sc1
    ds_read_b128 v[44:47], v38 offset:3072
    s_waitcnt lgkmcnt(4)
    v_mfma_f32_32x32x16_bf16 v[64:79], v[52:55], a[84:87], v[64:79]
    ds_read_b128 v[48:51], v38 offset:4096
    s_waitcnt lgkmcnt(4)
    v_mfma_f32_32x32x16_bf16 v[80:95], v[56:59], a[84:87], v[80:95]
    buffer_load_dwordx4 a[136:139], v39, s[48:51], s72 offen offset:2048 sc1
    ds_read_b128 v[52:55], v38 offset:5120
    s_waitcnt lgkmcnt(4)
    v_mfma_f32_32x32x16_bf16 v[96:111], v[60:63], a[84:87], v[96:111]
    ds_read_b128 v[56:59], v38 offset:6144
    s_waitcnt lgkmcnt(4)
    v_mfma_f32_32x32x16_bf16 v[64:79], v[40:43], a[88:91], v[64:79]
    buffer_load_dwordx4 a[140:143], v39, s[48:51], s72 offen offset:3072 sc1
    s_add_u32 s72, s72, 4096
    ds_read_b128 v[60:63], v38 offset:7168
    s_waitcnt lgkmcnt(4)
    v_mfma_f32_32x32x16_bf16 v[80:95], v[44:47], a[88:91], v[80:95]
    s_waitcnt vmcnt(11)
    s_barrier
    ds_read_b128 v[40:43], v38 offset:8192
    s_waitcnt lgkmcnt(4)
    v_mfma_f32_32x32x16_bf16 v[96:111], v[48:51], a[88:91], v[96:111]
    ds_read_b128 v[44:47], v38 offset:9216
    s_waitcnt lgkmcnt(4)
    v_mfma_f32_32x32x16_bf16 v[64:79], v[52:55], a[92:95], v[64:79]
    ds_read_b128 v[48:51], v38 offset:10240
    s_waitcnt lgkmcnt(4)
    v_mfma_f32_32x32x16_bf16 v[80:95], v[56:59], a[92:95], v[80:95]
    ds_read_b128 v[52:55], v38 offset:11264
    s_waitcnt lgkmcnt(4)
    v_mfma_f32_32x32x16_bf16 v[96:111], v[60:63], a[92:95], v[96:111]
    ds_read_b128 v[56:59], v38 offset:12288
    s_waitcnt lgkmcnt(4)
    v_mfma_f32_32x32x16_bf16 v[64:79], v[40:43], a[96:99], v[64:79]
    buffer_load_dwordx4 a[144:147], v39, s[48:51], s72 offen offset:0 sc1
    ds_read_b128 v[60:63], v38 offset:13312
    s_waitcnt lgkmcnt(4)
    v_mfma_f32_32x32x16_bf16 v[80:95], v[44:47], a[96:99], v[80:95]
    ds_read_b128 v[40:43], v38 offset:14336
    s_waitcnt lgkmcnt(4)
    v_mfma_f32_32x32x16_bf16 v[96:111], v[48:51], a[96:99], v[96:111]
    buffer_load_dwordx4 a[148:151], v39, s[48:51], s72 offen offset:1024 sc1
    ds_read_b128 v[44:47], v38 offset:15360
    s_waitcnt lgkmcnt(4)
    v_mfma_f32_32x32x16_bf16 v[64:79], v[52:55], a[100:103], v[64:79]
    ds_read_b128 v[48:51], v38 offset:16384
    s_waitcnt lgkmcnt(4)
    v_mfma_f32_32x32x16_bf16 v[80:95], v[56:59], a[100:103], v[80:95]
    buffer_load_dwordx4 a[152:155], v39, s[48:51], s72 offen offset:2048 sc1
    ds_read_b128 v[52:55], v38 offset:17408
    s_waitcnt lgkmcnt(4)
    v_mfma_f32_32x32x16_bf16 v[96:111], v[60:63], a[100:103], v[96:111]
    ds_read_b128 v[56:59], v38 offset:18432
    s_waitcnt lgkmcnt(4)
    v_mfma_f32_32x32x16_bf16 v[64:79], v[40:43], a[104:107], v[64:79]
    buffer_load_dwordx4 a[156:159], v39, s[48:51], s72 offen offset:3072 sc1
    s_add_u32 s72, s72, 4096
    ds_read_b128 v[60:63], v38 offset:19456
    s_waitcnt lgkmcnt(4)
    v_mfma_f32_32x32x16_bf16 v[80:95], v[44:47], a[104:107], v[80:95]
    s_waitcnt vmcnt(8)
    s_barrier
    ds_read_b128 v[40:43], v38 offset:20480
    s_waitcnt lgkmcnt(4)
    v_mfma_f32_32x32x16_bf16 v[96:111], v[48:51], a[104:107], v[96:111]
    ds_read_b128 v[44:47], v38 offset:21504
    s_waitcnt lgkmcnt(4)
    v_mfma_f32_32x32x16_bf16 v[64:79], v[52:55], a[108:111], v[64:79]
    ds_read_b128 v[48:51], v38 offset:22528
    s_waitcnt lgkmcnt(4)
    v_mfma_f32_32x32x16_bf16 v[80:95], v[56:59], a[108:111], v[80:95]
    ds_read_b128 v[52:55], v38 offset:23552
    s_waitcnt lgkmcnt(4)
    v_mfma_f32_32x32x16_bf16 v[96:111], v[60:63], a[108:111], v[96:111]
    ds_read_b128 v[56:59], v38 offset:24576
    s_waitcnt lgkmcnt(4)
    v_mfma_f32_32x32x16_bf16 v[64:79], v[40:43], a[112:115], v[64:79]
    s_mov_b32 m0, s88
    s_nop 0
    buffer_load_dwordx4 v39, s[48:51], s89 offen offset:0 sc1 lds
    ds_read_b128 v[60:63], v38 offset:25600
    s_waitcnt lgkmcnt(4)
    v_mfma_f32_32x32x16_bf16 v[80:95], v[44:47], a[112:115], v[80:95]
    ds_read_b128 v[40:43], v38 offset:26624
    s_waitcnt lgkmcnt(4)
    v_mfma_f32_32x32x16_bf16 v[96:111], v[48:51], a[112:115], v[96:111]
    buffer_load_dwordx4 v39, s[48:51], s89 offen offset:1024 sc1 lds
    ds_read_b128 v[44:47], v38 offset:27648
    s_waitcnt lgkmcnt(4)
    v_mfma_f32_32x32x16_bf16 v[64:79], v[52:55], a[116:119], v[64:79]
    ds_read_b128 v[48:51], v38 offset:28672
    s_waitcnt lgkmcnt(4)
    v_mfma_f32_32x32x16_bf16 v[80:95], v[56:59], a[116:119], v[80:95]
    buffer_load_dwordx4 v39, s[48:51], s89 offen offset:2048 sc1 lds
    ds_read_b128 v[52:55], v38 offset:29696
    s_waitcnt lgkmcnt(4)
    v_mfma_f32_32x32x16_bf16 v[96:111], v[60:63], a[116:119], v[96:111]
    ds_read_b128 v[56:59], v38 offset:30720
    s_waitcnt lgkmcnt(4)
    v_mfma_f32_32x32x16_bf16 v[64:79], v[40:43], a[120:123], v[64:79]
    buffer_load_dwordx4 v39, s[48:51], s89 offen offset:3072 sc1 lds
    ds_read_b128 v[60:63], v38 offset:31744
    s_waitcnt lgkmcnt(4)
    v_mfma_f32_32x32x16_bf16 v[80:95], v[44:47], a[120:123], v[80:95]
    s_waitcnt vmcnt(8)
    s_barrier
    ds_read_b128 v[40:43], v38 offset:32768
    s_waitcnt lgkmcnt(4)
    v_mfma_f32_32x32x16_bf16 v[96:111], v[48:51], a[120:123], v[96:111]
    s_mov_b32 m0, s90
    s_nop 0
    buffer_load_dwordx4 v39, s[48:51], s91 offen offset:0 sc1 lds
    ds_read_b128 v[44:47], v38 offset:33792
    s_waitcnt lgkmcnt(4)
    v_mfma_f32_32x32x16_bf16 v[64:79], v[52:55], a[124:127], v[64:79]
    ds_read_b128 v[48:51], v38 offset:34816
    s_waitcnt lgkmcnt(4)
    v_mfma_f32_32x32x16_bf16 v[80:95], v[56:59], a[124:127], v[80:95]
    buffer_load_dwordx4 v39, s[48:51], s91 offen offset:1024 sc1 lds
    ds_read_b128 v[52:55], v38 offset:35840
    s_waitcnt lgkmcnt(4)
    v_mfma_f32_32x32x16_bf16 v[96:111], v[60:63], a[124:127], v[96:111]
    ds_read_b128 v[56:59], v38 offset:36864
    v_accvgpr_read_b32 v24, a234
    s_waitcnt lgkmcnt(4)
    v_mfma_f32_32x32x16_bf16 v[64:79], v[40:43], a[128:131], v[64:79]
    buffer_load_dwordx4 v39, s[48:51], s91 offen offset:2048 sc1 lds
    ds_read_b128 v[60:63], v38 offset:37888
    s_waitcnt lgkmcnt(4)
    v_mfma_f32_32x32x16_bf16 v[80:95], v[44:47], a[128:131], v[80:95]
    ds_read_b128 v[40:43], v38 offset:38912
    s_waitcnt lgkmcnt(4)
    v_mfma_f32_32x32x16_bf16 v[96:111], v[48:51], a[128:131], v[96:111]
    buffer_load_dwordx4 v39, s[48:51], s91 offen offset:3072 sc1 lds
    ds_read_b128 v[44:47], v38 offset:39936
    s_waitcnt lgkmcnt(4)
    v_mfma_f32_32x32x16_bf16 v[64:79], v[52:55], a[132:135], v[64:79]
    ds_read_b128 v[48:51], v38 offset:40960
    ds_read_b128 v[128:131], v24 offset:0
    s_waitcnt lgkmcnt(5)
    v_mfma_f32_32x32x16_bf16 v[80:95], v[56:59], a[132:135], v[80:95]
    ds_read_b128 v[52:55], v38 offset:41984
    ds_read_b128 v[132:135], v24 offset:16
    s_waitcnt lgkmcnt(6)
    v_mfma_f32_32x32x16_bf16 v[96:111], v[60:63], a[132:135], v[96:111]
    ds_read_b128 v[56:59], v38 offset:43008
    ds_read_b128 v[136:139], v24 offset:32
    s_waitcnt lgkmcnt(7)
    v_mfma_f32_32x32x16_bf16 v[64:79], v[40:43], a[136:139], v[64:79]
    ds_read_b128 v[60:63], v38 offset:44032
    ds_read_b128 v[140:143], v24 offset:48
    s_waitcnt lgkmcnt(8)
    v_mfma_f32_32x32x16_bf16 v[80:95], v[44:47], a[136:139], v[80:95]
    s_waitcnt vmcnt(8)
    s_barrier
    ds_read_b128 v[40:43], v38 offset:45056
    ds_read_b128 v[144:147], v24 offset:64
    s_waitcnt lgkmcnt(9)
    v_mfma_f32_32x32x16_bf16 v[96:111], v[48:51], a[136:139], v[96:111]
    ds_read_b128 v[44:47], v38 offset:46080
    ds_read_b128 v[148:151], v24 offset:80
    s_waitcnt lgkmcnt(9)
    v_mfma_f32_32x32x16_bf16 v[64:79], v[52:55], a[140:143], v[64:79]
    ds_read_b128 v[48:51], v38 offset:47104
    ds_read_b128 v[152:155], v24 offset:96
    s_waitcnt lgkmcnt(9)
    v_mfma_f32_32x32x16_bf16 v[80:95], v[56:59], a[140:143], v[80:95]
    ds_read_b128 v[52:55], v38 offset:48128
    ds_read_b128 v[156:159], v24 offset:112
    s_waitcnt lgkmcnt(9)
    v_mfma_f32_32x32x16_bf16 v[96:111], v[60:63], a[140:143], v[96:111]
    ds_read_b128 v[56:59], v38 offset:49152
    ds_read_b128 v[160:163], v24 offset:128
    s_waitcnt lgkmcnt(9)
    v_mfma_f32_32x32x16_bf16 v[64:79], v[40:43], a[144:147], v[64:79]
    ds_read_b128 v[60:63], v38 offset:50176
    ds_read_b128 v[164:167], v24 offset:144
    s_waitcnt lgkmcnt(9)
    v_mfma_f32_32x32x16_bf16 v[80:95], v[44:47], a[144:147], v[80:95]
    ds_read_b128 v[40:43], v38 offset:51200
    ds_read_b128 v[168:171], v24 offset:160
    s_waitcnt lgkmcnt(9)
    v_mfma_f32_32x32x16_bf16 v[96:111], v[48:51], a[144:147], v[96:111]
    ds_read_b128 v[44:47], v38 offset:52224
    ds_read_b128 v[172:175], v24 offset:176
    s_waitcnt lgkmcnt(9)
    v_mfma_f32_32x32x16_bf16 v[64:79], v[52:55], a[148:151], v[64:79]
    ds_read_b128 v[48:51], v38 offset:53248
    ds_read_b128 v[176:179], v24 offset:192
    s_waitcnt lgkmcnt(9)
    v_mfma_f32_32x32x16_bf16 v[80:95], v[56:59], a[148:151], v[80:95]
    ds_read_b128 v[52:55], v38 offset:54272
    ds_read_b128 v[180:183], v24 offset:208
    s_waitcnt lgkmcnt(9)
    v_mfma_f32_32x32x16_bf16 v[96:111], v[60:63], a[148:151], v[96:111]
    ds_read_b128 v[56:59], v38 offset:55296
    ds_read_b128 v[184:187], v24 offset:224
    s_waitcnt lgkmcnt(9)
    v_mfma_f32_32x32x16_bf16 v[64:79], v[40:43], a[152:155], v[64:79]
    ds_read_b128 v[60:63], v38 offset:56320
    s_waitcnt lgkmcnt(8)
    v_mfma_f32_32x32x16_bf16 v[80:95], v[44:47], a[152:155], v[80:95]
    s_waitcnt lgkmcnt(6)
    v_mfma_f32_32x32x16_bf16 v[96:111], v[48:51], a[152:155], v[96:111]
    s_waitcnt lgkmcnt(4)
    v_mfma_f32_32x32x16_bf16 v[64:79], v[52:55], a[156:159], v[64:79]
    s_waitcnt lgkmcnt(2)
    v_mfma_f32_32x32x16_bf16 v[80:95], v[56:59], a[156:159], v[80:95]
    s_waitcnt lgkmcnt(0)
    v_mfma_f32_32x32x16_bf16 v[96:111], v[60:63], a[156:159], v[96:111]
    s_branch L_B1E2045
L_B1W2045:
    s_mov_b32 m0, s75
    s_add_u32 s75, s75, 12288
    buffer_load_dwordx4 v39, s[48:51], s73 offen offset:0 sc1 lds
    buffer_load_dwordx4 v39, s[48:51], s73 offen offset:1024 sc1 lds
    buffer_load_dwordx4 v39, s[48:51], s73 offen offset:2048 sc1 lds
    buffer_load_dwordx4 v39, s[48:51], s73 offen offset:3072 sc1 lds
    s_add_u32 s73, s73, 12288
    s_mov_b32 m0, s75
    s_add_u32 s75, s75, 12288
    buffer_load_dwordx4 v39, s[48:51], s73 offen offset:0 sc1 lds
    buffer_load_dwordx4 v39, s[48:51], s73 offen offset:1024 sc1 lds
    buffer_load_dwordx4 v39, s[48:51], s73 offen offset:2048 sc1 lds
    buffer_load_dwordx4 v39, s[48:51], s73 offen offset:3072 sc1 lds
    s_add_u32 s73, s73, 12288
    s_mov_b32 m0, s75
    s_add_u32 s75, s75, 12288
    buffer_load_dwordx4 v39, s[48:51], s73 offen offset:0 sc1 lds
    buffer_load_dwordx4 v39, s[48:51], s73 offen offset:1024 sc1 lds
    buffer_load_dwordx4 v39, s[48:51], s73 offen offset:2048 sc1 lds
    buffer_load_dwordx4 v39, s[48:51], s73 offen offset:3072 sc1 lds
    s_add_u32 s73, s73, 12288
    buffer_load_dwordx4 v[8:11], v31, s[48:51], s87 offen offset:0 sc1
    buffer_load_dwordx4 v[12:15], v31, s[48:51], s87 offen offset:512 sc1
    buffer_load_dwordx4 v[16:19], v31, s[48:51], s87 offen offset:1024 sc1
    buffer_load_dwordx4 v[20:23], v31, s[48:51], s87 offen offset:1536 sc1
    buffer_load_dwordx4 v[24:27], v31, s[48:51], s87 offen offset:2048 sc1
    s_waitcnt vmcnt(13)
    s_barrier
    ds_read_b128 v[40:43], v39 offset:0
    ds_read_b128 v[44:47], v39 offset:1024
    ds_read_b128 v[48:51], v39 offset:2048
    ds_read_b128 v[52:55], v39 offset:3072
    ds_read_b128 v[56:59], v39 offset:4096
    s_waitcnt lgkmcnt(4)
    v_mfma_f32_32x32x16_bf16 v[64:79], v[40:43], a[0:3], 0
    s_mov_b32 m0, s75
    s_add_u32 s75, s75, 12288
    buffer_load_dwordx4 v39, s[48:51], s73 offen offset:0 sc1 lds
    ds_read_b128 v[60:63], v39 offset:5120
    s_waitcnt lgkmcnt(4)
    v_mfma_f32_32x32x16_bf16 v[80:95], v[44:47], a[0:3], 0
    ds_read_b128 v[40:43], v39 offset:6144
    s_waitcnt lgkmcnt(4)
    v_mfma_f32_32x32x16_bf16 v[96:111], v[48:51], a[0:3], 0
    buffer_load_dwordx4 v39, s[48:51], s73 offen offset:1024 sc1 lds
    ds_read_b128 v[44:47], v39 offset:7168
    s_waitcnt lgkmcnt(4)
    v_mfma_f32_32x32x16_bf16 v[64:79], v[52:55], a[4:7], v[64:79]
    ds_read_b128 v[48:51], v39 offset:8192
    s_waitcnt lgkmcnt(4)
    v_mfma_f32_32x32x16_bf16 v[80:95], v[56:59], a[4:7], v[80:95]
    buffer_load_dwordx4 v39, s[48:51], s73 offen offset:2048 sc1 lds
    ds_read_b128 v[52:55], v39 offset:9216
    s_waitcnt lgkmcnt(4)
    v_mfma_f32_32x32x16_bf16 v[96:111], v[60:63], a[4:7], v[96:111]
    ds_read_b128 v[56:59], v39 offset:10240
    s_waitcnt lgkmcnt(4)
    v_mfma_f32_32x32x16_bf16 v[64:79], v[40:43], a[8:11], v[64:79]
    buffer_load_dwordx4 v39, s[48:51], s73 offen offset:3072 sc1 lds
    s_add_u32 s73, s73, 12288
    ds_read_b128 v[60:63], v39 offset:11264
    s_waitcnt lgkmcnt(4)
    v_mfma_f32_32x32x16_bf16 v[80:95], v[44:47], a[8:11], v[80:95]
    s_waitcnt vmcnt(13)
    s_barrier
    ds_read_b128 v[40:43], v39 offset:12288
    s_waitcnt lgkmcnt(4)
    v_mfma_f32_32x32x16_bf16 v[96:111], v[48:51], a[8:11], v[96:111]
    ds_read_b128 v[44:47], v39 offset:13312
    s_waitcnt lgkmcnt(4)
    v_mfma_f32_32x32x16_bf16 v[64:79], v[52:55], a[12:15], v[64:79]
    ds_read_b128 v[48:51], v39 offset:14336
    s_waitcnt lgkmcnt(4)
    v_mfma_f32_32x32x16_bf16 v[80:95], v[56:59], a[12:15], v[80:95]
    ds_read_b128 v[52:55], v39 offset:15360
    s_waitcnt lgkmcnt(4)
    v_mfma_f32_32x32x16_bf16 v[96:111], v[60:63], a[12:15], v[96:111]
    ds_read_b128 v[56:59], v39 offset:16384
    s_waitcnt lgkmcnt(4)
    v_mfma_f32_32x32x16_bf16 v[64:79], v[40:43], a[16:19], v[64:79]
    s_mov_b32 m0, s75
    s_add_u32 s75, s75, 12288
    buffer_load_dwordx4 v39, s[48:51], s73 offen offset:0 sc1 lds
    ds_read_b128 v[60:63], v39 offset:17408
    s_waitcnt lgkmcnt(4)
    v_mfma_f32_32x32x16_bf16 v[80:95], v[44:47], a[16:19], v[80:95]
    ds_read_b128 v[40:43], v39 offset:18432
    s_waitcnt lgkmcnt(4)
    v_mfma_f32_32x32x16_bf16 v[96:111], v[48:51], a[16:19], v[96:111]
    buffer_load_dwordx4 v39, s[48:51], s73 offen offset:1024 sc1 lds
    ds_read_b128 v[44:47], v39 offset:19456
    s_waitcnt lgkmcnt(4)
    v_mfma_f32_32x32x16_bf16 v[64:79], v[52:55], a[20:23], v[64:79]
    ds_read_b128 v[48:51], v39 offset:20480
    s_waitcnt lgkmcnt(4)
    v_mfma_f32_32x32x16_bf16 v[80:95], v[56:59], a[20:23], v[80:95]
    buffer_load_dwordx4 v39, s[48:51], s73 offen offset:2048 sc1 lds
    ds_read_b128 v[52:55], v39 offset:21504
    s_waitcnt vmcnt(7)
    v_pk_add_f32 v[8:9], v[8:9], v[12:13]
    v_pk_add_f32 v[10:11], v[10:11], v[14:15]
    v_pk_add_f32 v[8:9], v[8:9], v[16:17]
    v_pk_add_f32 v[10:11], v[10:11], v[18:19]
    s_waitcnt lgkmcnt(4)
    v_mfma_f32_32x32x16_bf16 v[96:111], v[60:63], a[20:23], v[96:111]
    ds_read_b128 v[56:59], v39 offset:22528
    v_pk_add_f32 v[8:9], v[8:9], v[20:21]
    v_pk_add_f32 v[10:11], v[10:11], v[22:23]
    v_pk_add_f32 v[8:9], v[8:9], v[24:25]
    v_pk_add_f32 v[10:11], v[10:11], v[26:27]
    s_waitcnt lgkmcnt(4)
    v_mfma_f32_32x32x16_bf16 v[64:79], v[40:43], a[24:27], v[64:79]
    buffer_load_dwordx4 v39, s[48:51], s73 offen offset:3072 sc1 lds
    s_add_u32 s73, s73, 12288
    ds_read_b128 v[60:63], v39 offset:23552
    v_mov_b32 v12, v8
    v_mov_b32 v13, v9
    v_mov_b32 v14, v10
    v_mov_b32 v15, v11
    s_waitcnt lgkmcnt(4)
    v_mfma_f32_32x32x16_bf16 v[80:95], v[44:47], a[24:27], v[80:95]
    s_barrier
    s_branch L_PSK4
L_PAD4:
    s_setpc_b64 s[100:101]
L_PSK4:
    ds_read_b128 v[40:43], v39 offset:24576
    v_permlane32_swap_b32 v12, v8
    v_permlane32_swap_b32 v13, v9
    v_permlane32_swap_b32 v14, v10
    v_permlane32_swap_b32 v15, v11
    s_waitcnt lgkmcnt(4)
    v_mfma_f32_32x32x16_bf16 v[96:111], v[48:51], a[24:27], v[96:111]
    ds_read_b128 v[44:47], v39 offset:25600
    v_pk_add_f32 v[8:9], v[8:9], v[12:13]
    v_pk_add_f32 v[10:11], v[10:11], v[14:15]
    ds_write_b128 v35, v[8:11]
    s_waitcnt lgkmcnt(5)
    v_mfma_f32_32x32x16_bf16 v[64:79], v[52:55], a[28:31], v[64:79]
    ds_read_b128 v[48:51], v39 offset:26624
    s_waitcnt lgkmcnt(5)
    v_mfma_f32_32x32x16_bf16 v[80:95], v[56:59], a[28:31], v[80:95]
    ds_read_b128 v[52:55], v39 offset:27648
    s_waitcnt lgkmcnt(5)
    v_mfma_f32_32x32x16_bf16 v[96:111], v[60:63], a[28:31], v[96:111]
    ds_read_b128 v[56:59], v39 offset:28672
    s_waitcnt lgkmcnt(5)
    v_mfma_f32_32x32x16_bf16 v[64:79], v[40:43], a[32:35], v[64:79]
    s_mov_b32 m0, s75
    s_add_u32 s75, s75, 12288
    buffer_load_dwordx4 v39, s[48:51], s73 offen offset:0 sc1 lds
    ds_read_b128 v[60:63], v39 offset:29696
    s_waitcnt lgkmcnt(5)
    v_mfma_f32_32x32x16_bf16 v[80:95], v[44:47], a[32:35], v[80:95]
    ds_read_b128 v[40:43], v39 offset:30720
    s_waitcnt lgkmcnt(4)
    v_mfma_f32_32x32x16_bf16 v[96:111], v[48:51], a[32:35], v[96:111]
    buffer_load_dwordx4 v39, s[48:51], s73 offen offset:1024 sc1 lds
    ds_read_b128 v[44:47], v39 offset:31744
    s_waitcnt lgkmcnt(4)
    v_mfma_f32_32x32x16_bf16 v[64:79], v[52:55], a[36:39], v[64:79]
    ds_read_b128 v[48:51], v39 offset:32768
    s_waitcnt lgkmcnt(4)
    v_mfma_f32_32x32x16_bf16 v[80:95], v[56:59], a[36:39], v[80:95]
    buffer_load_dwordx4 v39, s[48:51], s73 offen offset:2048 sc1 lds
    ds_read_b128 v[52:55], v39 offset:33792
    s_waitcnt lgkmcnt(4)
    v_mfma_f32_32x32x16_bf16 v[96:111], v[60:63], a[36:39], v[96:111]
    ds_read_b128 v[56:59], v39 offset:34816
    s_waitcnt lgkmcnt(4)
    v_mfma_f32_32x32x16_bf16 v[64:79], v[40:43], a[40:43], v[64:79]
    buffer_load_dwordx4 v39, s[48:51], s73 offen offset:3072 sc1 lds
    s_add_u32 s73, s73, 12288
    ds_read_b128 v[60:63], v39 offset:35840
    s_waitcnt lgkmcnt(4)
    v_mfma_f32_32x32x16_bf16 v[80:95], v[44:47], a[40:43], v[80:95]
    s_waitcnt vmcnt(8)
    s_barrier
    ds_read_b128 v[40:43], v39 offset:36864
    s_waitcnt lgkmcnt(4)
    v_mfma_f32_32x32x16_bf16 v[96:111], v[48:51], a[40:43], v[96:111]
    ds_read_b128 v[44:47], v39 offset:37888
    ds_read_b128 v[8:11], v36 offset:0
    ds_read_b128 v[12:15], v36 offset:512
    ds_read_b128 v[16:19], v36 offset:1024
    ds_read_b128 v[20:23], v36 offset:1536
    s_waitcnt lgkmcnt(8)
    v_mfma_f32_32x32x16_bf16 v[64:79], v[52:55], a[44:47], v[64:79]
    ds_read_b128 v[48:51], v39 offset:38912
    s_waitcnt lgkmcnt(8)
    v_mfma_f32_32x32x16_bf16 v[80:95], v[56:59], a[44:47], v[80:95]
    ds_read_b128 v[52:55], v39 offset:39936
    s_waitcnt lgkmcnt(8)
    v_mfma_f32_32x32x16_bf16 v[96:111], v[60:63], a[44:47], v[96:111]
    ds_read_b128 v[56:59], v39 offset:40960
    s_waitcnt lgkmcnt(8)
    v_mfma_f32_32x32x16_bf16 v[64:79], v[40:43], a[48:51], v[64:79]
    s_mov_b32 m0, s75
    s_add_u32 s75, s75, 12288
    buffer_load_dwordx4 v39, s[48:51], s73 offen offset:0 sc1 lds
    ds_read_b128 v[60:63], v39 offset:41984
    s_waitcnt lgkmcnt(8)
    v_mfma_f32_32x32x16_bf16 v[80:95], v[44:47], a[48:51], v[80:95]
    ds_read_b128 v[40:43], v39 offset:43008
    s_waitcnt lgkmcnt(5)
    v_pk_add_f32 v[8:9], v[8:9], v[12:13]
    v_pk_add_f32 v[10:11], v[10:11], v[14:15]
    v_pk_add_f32 v[16:17], v[16:17], v[20:21]
    v_pk_add_f32 v[18:19], v[18:19], v[22:23]
    s_waitcnt lgkmcnt(4)
    v_mfma_f32_32x32x16_bf16 v[96:111], v[48:51], a[48:51], v[96:111]
    buffer_load_dwordx4 v39, s[48:51], s73 offen offset:1024 sc1 lds
    ds_read_b128 v[44:47], v39 offset:44032
    v_pk_add_f32 v[8:9], v[8:9], v[16:17]
    v_pk_add_f32 v[10:11], v[10:11], v[18:19]
    ds_write_b128 v37, v[8:11]
    s_waitcnt lgkmcnt(5)
    v_mfma_f32_32x32x16_bf16 v[64:79], v[52:55], a[52:55], v[64:79]
    ds_read_b128 v[48:51], v39 offset:45056
    s_waitcnt lgkmcnt(5)
    v_mfma_f32_32x32x16_bf16 v[80:95], v[56:59], a[52:55], v[80:95]
    buffer_load_dwordx4 v39, s[48:51], s73 offen offset:2048 sc1 lds
    ds_read_b128 v[52:55], v39 offset:46080
    s_waitcnt lgkmcnt(5)
    v_mfma_f32_32x32x16_bf16 v[96:111], v[60:63], a[52:55], v[96:111]
    ds_read_b128 v[56:59], v39 offset:47104
    s_waitcnt lgkmcnt(5)
    v_mfma_f32_32x32x16_bf16 v[64:79], v[40:43], a[56:59], v[64:79]
    buffer_load_dwordx4 v39, s[48:51], s73 offen offset:3072 sc1 lds
    s_add_u32 s73, s73, 12288
    ds_read_b128 v[60:63], v39 offset:48128
    s_waitcnt lgkmcnt(5)
    v_mfma_f32_32x32x16_bf16 v[80:95], v[44:47], a[56:59], v[80:95]
    s_waitcnt vmcnt(8)
    s_barrier
    ds_read_b128 v[40:43], v39 offset:49152
    s_waitcnt lgkmcnt(4)
    v_mfma_f32_32x32x16_bf16 v[96:111], v[48:51], a[56:59], v[96:111]
    buffer_load_dwordx4 v[208:211], v28, s[28:31], s84 offen
    ds_read_b128 v[44:47], v39 offset:50176
    s_waitcnt lgkmcnt(4)
    v_mfma_f32_32x32x16_bf16 v[64:79], v[52:55], a[60:63], v[64:79]
    ds_read_b128 v[48:51], v39 offset:51200
    s_waitcnt lgkmcnt(4)
    v_mfma_f32_32x32x16_bf16 v[80:95], v[56:59], a[60:63], v[80:95]
    buffer_load_dwordx4 v[212:215], v29, s[28:31], s84 offen
    ds_read_b128 v[52:55], v39 offset:52224
    s_waitcnt lgkmcnt(4)
    v_mfma_f32_32x32x16_bf16 v[96:111], v[60:63], a[60:63], v[96:111]
    ds_read_b128 v[56:59], v39 offset:53248
    s_waitcnt lgkmcnt(4)
    v_mfma_f32_32x32x16_bf16 v[64:79], v[40:43], a[64:67], v[64:79]
    buffer_load_dwordx4 v[216:219], v30, s[28:31], s84 offen
    ds_read_b128 v[60:63], v39 offset:54272
    s_waitcnt lgkmcnt(4)
    v_mfma_f32_32x32x16_bf16 v[80:95], v[44:47], a[64:67], v[80:95]
    ds_read_b128 v[40:43], v39 offset:55296
    s_waitcnt lgkmcnt(4)
    v_mfma_f32_32x32x16_bf16 v[96:111], v[48:51], a[64:67], v[96:111]
    s_mov_b32 m0, s75
    s_add_u32 s75, s75, 12288
    buffer_load_dwordx4 v39, s[48:51], s73 offen offset:0 sc1 lds
    ds_read_b128 v[44:47], v39 offset:56320
    s_waitcnt lgkmcnt(4)
    v_mfma_f32_32x32x16_bf16 v[64:79], v[52:55], a[68:71], v[64:79]
    ds_read_b128 v[48:51], v39 offset:57344
    s_waitcnt lgkmcnt(4)
    v_mfma_f32_32x32x16_bf16 v[80:95], v[56:59], a[68:71], v[80:95]
    buffer_load_dwordx4 v39, s[48:51], s73 offen offset:1024 sc1 lds
    ds_read_b128 v[52:55], v39 offset:58368
    s_waitcnt lgkmcnt(4)
    v_mfma_f32_32x32x16_bf16 v[96:111], v[60:63], a[68:71], v[96:111]
    ds_read_b128 v[56:59], v39 offset:59392
    s_waitcnt lgkmcnt(4)
    v_mfma_f32_32x32x16_bf16 v[64:79], v[40:43], a[72:75], v[64:79]
    buffer_load_dwordx4 v39, s[48:51], s73 offen offset:2048 sc1 lds
    ds_read_b128 v[60:63], v39 offset:60416
    s_waitcnt lgkmcnt(4)
    v_mfma_f32_32x32x16_bf16 v[80:95], v[44:47], a[72:75], v[80:95]
    s_waitcnt vmcnt(10)
    s_barrier
    ds_read_b128 v[40:43], v39 offset:61440
    s_waitcnt lgkmcnt(4)
    v_mfma_f32_32x32x16_bf16 v[96:111], v[48:51], a[72:75], v[96:111]
    buffer_load_dwordx4 v39, s[48:51], s73 offen offset:3072 sc1 lds
    s_add_u32 s73, s73, 12288
    ds_read_b128 v[44:47], v39 offset:62464
    s_waitcnt lgkmcnt(4)
    v_mfma_f32_32x32x16_bf16 v[64:79], v[52:55], a[76:79], v[64:79]
    ds_read_b128 v[48:51], v39 offset:63488
    s_waitcnt lgkmcnt(4)
    v_mfma_f32_32x32x16_bf16 v[80:95], v[56:59], a[76:79], v[80:95]
    ds_read_b128 v[52:55], v39 offset:64512
    s_waitcnt lgkmcnt(4)
    v_mfma_f32_32x32x16_bf16 v[96:111], v[60:63], a[76:79], v[96:111]
    ds_read_b128 v[56:59], v38 offset:0
    s_waitcnt lgkmcnt(4)
    v_mfma_f32_32x32x16_bf16 v[64:79], v[40:43], a[80:83], v[64:79]
    s_mov_b32 m0, s75
    s_add_u32 s75, s75, 12288
    buffer_load_dwordx4 v39, s[48:51], s73 offen offset:0 sc1 lds
    ds_read_b128 v[60:63], v38 offset:1024
    s_waitcnt lgkmcnt(4)
    v_mfma_f32_32x32x16_bf16 v[80:95], v[44:47], a[80:83], v[80:95]
    ds_read_b128 v[40:43], v38 offset:2048
    s_waitcnt lgkmcnt(4)
    v_mfma_f32_32x32x16_bf16 v[96:111], v[48:51], a[80:83], v[96:111]
    buffer_load_dwordx4 v39, s[48:51], s73 offen offset:1024 sc1 lds
    ds_read_b128 v[44:47], v38 offset:3072
    s_waitcnt lgkmcnt(4)
    v_mfma_f32_32x32x16_bf16 v[64:79], v[52:55], a[84:87], v[64:79]
    ds_read_b128 v[48:51], v38 offset:4096
    s_waitcnt lgkmcnt(4)
    v_mfma_f32_32x32x16_bf16 v[80:95], v[56:59], a[84:87], v[80:95]
    buffer_load_dwordx4 v39, s[48:51], s73 offen offset:2048 sc1 lds
    ds_read_b128 v[52:55], v38 offset:5120
    s_waitcnt lgkmcnt(4)
    v_mfma_f32_32x32x16_bf16 v[96:111], v[60:63], a[84:87], v[96:111]
    ds_read_b128 v[56:59], v38 offset:6144
    s_waitcnt lgkmcnt(4)
    v_mfma_f32_32x32x16_bf16 v[64:79], v[40:43], a[88:91], v[64:79]
    buffer_load_dwordx4 v39, s[48:51], s73 offen offset:3072 sc1 lds
    s_add_u32 s73, s73, 12288
    ds_read_b128 v[60:63], v38 offset:7168
    s_waitcnt lgkmcnt(4)
    v_mfma_f32_32x32x16_bf16 v[80:95], v[44:47], a[88:91], v[80:95]
    s_waitcnt vmcnt(11)
    s_barrier
    ds_read_b128 v[40:43], v38 offset:8192
    s_waitcnt lgkmcnt(4)
    v_mfma_f32_32x32x16_bf16 v[96:111], v[48:51], a[88:91], v[96:111]
    ds_read_b128 v[44:47], v38 offset:9216
    s_waitcnt lgkmcnt(4)
    v_mfma_f32_32x32x16_bf16 v[64:79], v[52:55], a[92:95], v[64:79]
    ds_read_b128 v[48:51], v38 offset:10240
    s_waitcnt lgkmcnt(4)
    v_mfma_f32_32x32x16_bf16 v[80:95], v[56:59], a[92:95], v[80:95]
    ds_read_b128 v[52:55], v38 offset:11264
    s_waitcnt lgkmcnt(4)
    v_mfma_f32_32x32x16_bf16 v[96:111], v[60:63], a[92:95], v[96:111]
    ds_read_b128 v[56:59], v38 offset:12288
    s_waitcnt lgkmcnt(4)
    v_mfma_f32_32x32x16_bf16 v[64:79], v[40:43], a[96:99], v[64:79]
    s_mov_b32 m0, s75
    s_add_u32 s75, s75, 12288
    buffer_load_dwordx4 v39, s[48:51], s73 offen offset:0 sc1 lds
    ds_read_b128 v[60:63], v38 offset:13312
    s_waitcnt lgkmcnt(4)
    v_mfma_f32_32x32x16_bf16 v[80:95], v[44:47], a[96:99], v[80:95]
    ds_read_b128 v[40:43], v38 offset:14336
    s_waitcnt lgkmcnt(4)
    v_mfma_f32_32x32x16_bf16 v[96:111], v[48:51], a[96:99], v[96:111]
    buffer_load_dwordx4 v39, s[48:51], s73 offen offset:1024 sc1 lds
    ds_read_b128 v[44:47], v38 offset:15360
    s_waitcnt lgkmcnt(4)
    v_mfma_f32_32x32x16_bf16 v[64:79], v[52:55], a[100:103], v[64:79]
    ds_read_b128 v[48:51], v38 offset:16384
    s_waitcnt lgkmcnt(4)
    v_mfma_f32_32x32x16_bf16 v[80:95], v[56:59], a[100:103], v[80:95]
    buffer_load_dwordx4 v39, s[48:51], s73 offen offset:2048 sc1 lds
    ds_read_b128 v[52:55], v38 offset:17408
    s_waitcnt lgkmcnt(4)
    v_mfma_f32_32x32x16_bf16 v[96:111], v[60:63], a[100:103], v[96:111]
    ds_read_b128 v[56:59], v38 offset:18432
    s_waitcnt lgkmcnt(4)
    v_mfma_f32_32x32x16_bf16 v[64:79], v[40:43], a[104:107], v[64:79]
    buffer_load_dwordx4 v39, s[48:51], s73 offen offset:3072 sc1 lds
    s_add_u32 s73, s73, 12288
    ds_read_b128 v[60:63], v38 offset:19456
    s_waitcnt lgkmcnt(4)
    v_mfma_f32_32x32x16_bf16 v[80:95], v[44:47], a[104:107], v[80:95]
    s_waitcnt vmcnt(8)
    s_barrier
    ds_read_b128 v[40:43], v38 offset:20480
    s_waitcnt lgkmcnt(4)
    v_mfma_f32_32x32x16_bf16 v[96:111], v[48:51], a[104:107], v[96:111]
    ds_read_b128 v[44:47], v38 offset:21504
    s_waitcnt lgkmcnt(4)
    v_mfma_f32_32x32x16_bf16 v[64:79], v[52:55], a[108:111], v[64:79]
    ds_read_b128 v[48:51], v38 offset:22528
    s_waitcnt lgkmcnt(4)
    v_mfma_f32_32x32x16_bf16 v[80:95], v[56:59], a[108:111], v[80:95]
    ds_read_b128 v[52:55], v38 offset:23552
    s_waitcnt lgkmcnt(4)
    v_mfma_f32_32x32x16_bf16 v[96:111], v[60:63], a[108:111], v[96:111]
    ds_read_b128 v[56:59], v38 offset:24576
    s_waitcnt lgkmcnt(4)
    v_mfma_f32_32x32x16_bf16 v[64:79], v[40:43], a[112:115], v[64:79]
    s_mov_b32 m0, s88
    s_nop 0
    buffer_load_dwordx4 v39, s[48:51], s89 offen offset:0 sc1 lds
    ds_read_b128 v[60:63], v38 offset:25600
    s_waitcnt lgkmcnt(4)
    v_mfma_f32_32x32x16_bf16 v[80:95], v[44:47], a[112:115], v[80:95]
    ds_read_b128 v[40:43], v38 offset:26624
    s_waitcnt lgkmcnt(4)
    v_mfma_f32_32x32x16_bf16 v[96:111], v[48:51], a[112:115], v[96:111]
    buffer_load_dwordx4 v39, s[48:51], s89 offen offset:1024 sc1 lds
    ds_read_b128 v[44:47], v38 offset:27648
    s_waitcnt lgkmcnt(4)
    v_mfma_f32_32x32x16_bf16 v[64:79], v[52:55], a[116:119], v[64:79]
    ds_read_b128 v[48:51], v38 offset:28672
    s_waitcnt lgkmcnt(4)
    v_mfma_f32_32x32x16_bf16 v[80:95], v[56:59], a[116:119], v[80:95]
    buffer_load_dwordx4 v39, s[48:51], s89 offen offset:2048 sc1 lds
    ds_read_b128 v[52:55], v38 offset:29696
    s_waitcnt lgkmcnt(4)
    v_mfma_f32_32x32x16_bf16 v[96:111], v[60:63], a[116:119], v[96:111]
    ds_read_b128 v[56:59], v38 offset:30720
    s_waitcnt lgkmcnt(4)
    v_mfma_f32_32x32x16_bf16 v[64:79], v[40:43], a[120:123], v[64:79]
    buffer_load_dwordx4 v39, s[48:51], s89 offen offset:3072 sc1 lds
    ds_read_b128 v[60:63], v38 offset:31744
    s_waitcnt lgkmcnt(4)
    v_mfma_f32_32x32x16_bf16 v[80:95], v[44:47], a[120:123], v[80:95]
    s_waitcnt vmcnt(8)
    s_barrier
    ds_read_b128 v[40:43], v38 offset:32768
    s_waitcnt lgkmcnt(4)
    v_mfma_f32_32x32x16_bf16 v[96:111], v[48:51], a[120:123], v[96:111]
    s_mov_b32 m0, s90
    s_nop 0
    buffer_load_dwordx4 v39, s[48:51], s91 offen offset:0 sc1 lds
    ds_read_b128 v[44:47], v38 offset:33792
    s_waitcnt lgkmcnt(4)
    v_mfma_f32_32x32x16_bf16 v[64:79], v[52:55], a[124:127], v[64:79]
    ds_read_b128 v[48:51], v38 offset:34816
    s_waitcnt lgkmcnt(4)
    v_mfma_f32_32x32x16_bf16 v[80:95], v[56:59], a[124:127], v[80:95]
    buffer_load_dwordx4 v39, s[48:51], s91 offen offset:1024 sc1 lds
    ds_read_b128 v[52:55], v38 offset:35840
    s_waitcnt lgkmcnt(4)
    v_mfma_f32_32x32x16_bf16 v[96:111], v[60:63], a[124:127], v[96:111]
    ds_read_b128 v[56:59], v38 offset:36864
    v_accvgpr_read_b32 v24, a234
    s_waitcnt lgkmcnt(4)
    v_mfma_f32_32x32x16_bf16 v[64:79], v[40:43], a[128:131], v[64:79]
    buffer_load_dwordx4 v39, s[48:51], s91 offen offset:2048 sc1 lds
    ds_read_b128 v[60:63], v38 offset:37888
    s_waitcnt lgkmcnt(4)
    v_mfma_f32_32x32x16_bf16 v[80:95], v[44:47], a[128:131], v[80:95]
    ds_read_b128 v[40:43], v38 offset:38912
    s_waitcnt lgkmcnt(4)
    v_mfma_f32_32x32x16_bf16 v[96:111], v[48:51], a[128:131], v[96:111]
    buffer_load_dwordx4 v39, s[48:51], s91 offen offset:3072 sc1 lds
    ds_read_b128 v[44:47], v38 offset:39936
    s_waitcnt lgkmcnt(4)
    v_mfma_f32_32x32x16_bf16 v[64:79], v[52:55], a[132:135], v[64:79]
    ds_read_b128 v[48:51], v38 offset:40960
    ds_read_b128 v[128:131], v24 offset:0
    s_waitcnt lgkmcnt(5)
    v_mfma_f32_32x32x16_bf16 v[80:95], v[56:59], a[132:135], v[80:95]
    ds_read_b128 v[52:55], v38 offset:41984
    ds_read_b128 v[132:135], v24 offset:16
    s_waitcnt lgkmcnt(6)
    v_mfma_f32_32x32x16_bf16 v[96:111], v[60:63], a[132:135], v[96:111]
    ds_read_b128 v[56:59], v38 offset:43008
    ds_read_b128 v[136:139], v24 offset:32
    s_waitcnt lgkmcnt(7)
    v_mfma_f32_32x32x16_bf16 v[64:79], v[40:43], a[136:139], v[64:79]
    ds_read_b128 v[60:63], v38 offset:44032
    ds_read_b128 v[140:143], v24 offset:48
    s_waitcnt lgkmcnt(8)
    v_mfma_f32_32x32x16_bf16 v[80:95], v[44:47], a[136:139], v[80:95]
    s_waitcnt vmcnt(8)
    s_barrier
    ds_read_b128 v[40:43], v38 offset:45056
    ds_read_b128 v[144:147], v24 offset:64
    s_waitcnt lgkmcnt(9)
    v_mfma_f32_32x32x16_bf16 v[96:111], v[48:51], a[136:139], v[96:111]
    ds_read_b128 v[44:47], v38 offset:46080
    ds_read_b128 v[148:151], v24 offset:80
    s_waitcnt lgkmcnt(9)
    v_mfma_f32_32x32x16_bf16 v[64:79], v[52:55], a[140:143], v[64:79]
    ds_read_b128 v[48:51], v38 offset:47104
    ds_read_b128 v[152:155], v24 offset:96
    s_waitcnt lgkmcnt(9)
    v_mfma_f32_32x32x16_bf16 v[80:95], v[56:59], a[140:143], v[80:95]
    ds_read_b128 v[52:55], v38 offset:48128
    ds_read_b128 v[156:159], v24 offset:112
    s_waitcnt lgkmcnt(9)
    v_mfma_f32_32x32x16_bf16 v[96:111], v[60:63], a[140:143], v[96:111]
    ds_read_b128 v[56:59], v38 offset:49152
    ds_read_b128 v[160:163], v24 offset:128
    s_waitcnt lgkmcnt(9)
    v_mfma_f32_32x32x16_bf16 v[64:79], v[40:43], a[144:147], v[64:79]
    ds_read_b128 v[60:63], v38 offset:50176
    ds_read_b128 v[164:167], v24 offset:144
    s_waitcnt lgkmcnt(9)
    v_mfma_f32_32x32x16_bf16 v[80:95], v[44:47], a[144:147], v[80:95]
    ds_read_b128 v[40:43], v38 offset:51200
    ds_read_b128 v[168:171], v24 offset:160
    s_waitcnt lgkmcnt(9)
    v_mfma_f32_32x32x16_bf16 v[96:111], v[48:51], a[144:147], v[96:111]
    ds_read_b128 v[44:47], v38 offset:52224
    ds_read_b128 v[172:175], v24 offset:176
    s_waitcnt lgkmcnt(9)
    v_mfma_f32_32x32x16_bf16 v[64:79], v[52:55], a[148:151], v[64:79]
    ds_read_b128 v[48:51], v38 offset:53248
    ds_read_b128 v[176:179], v24 offset:192
    s_waitcnt lgkmcnt(9)
    v_mfma_f32_32x32x16_bf16 v[80:95], v[56:59], a[148:151], v[80:95]
    ds_read_b128 v[52:55], v38 offset:54272
    ds_read_b128 v[180:183], v24 offset:208
    s_waitcnt lgkmcnt(9)
    v_mfma_f32_32x32x16_bf16 v[96:111], v[60:63], a[148:151], v[96:111]
    ds_read_b128 v[56:59], v38 offset:55296
    ds_read_b128 v[184:187], v24 offset:224
    s_waitcnt lgkmcnt(9)
    v_mfma_f32_32x32x16_bf16 v[64:79], v[40:43], a[152:155], v[64:79]
    ds_read_b128 v[60:63], v38 offset:56320
    s_waitcnt lgkmcnt(8)
    v_mfma_f32_32x32x16_bf16 v[80:95], v[44:47], a[152:155], v[80:95]
    s_waitcnt lgkmcnt(6)
    v_mfma_f32_32x32x16_bf16 v[96:111], v[48:51], a[152:155], v[96:111]
    s_waitcnt lgkmcnt(4)
    v_mfma_f32_32x32x16_bf16 v[64:79], v[52:55], a[156:159], v[64:79]
    s_waitcnt lgkmcnt(2)
    v_mfma_f32_32x32x16_bf16 v[80:95], v[56:59], a[156:159], v[80:95]
    s_waitcnt lgkmcnt(0)
    v_mfma_f32_32x32x16_bf16 v[96:111], v[60:63], a[156:159], v[96:111]
L_B1E2045:
    v_accvgpr_read_b32 v36, a235
    v_accvgpr_read_b32 v37, a236
    s_barrier
    buffer_store_dwordx4 v[208:211], v32, s[48:51], s85 offen sc1
    buffer_store_dwordx4 v[212:215], v33, s[48:51], s85 offen sc1
    buffer_store_dwordx4 v[216:219], v34, s[48:51], s85 offen sc1
    s_waitcnt lgkmcnt(0)
    s_nop 0
    v_pk_add_f32 v[64:65], v[64:65], v[128:129]
    v_pk_add_f32 v[66:67], v[66:67], v[130:131]
    v_pk_add_f32 v[68:69], v[68:69], v[132:133]
    v_pk_add_f32 v[70:71], v[70:71], v[134:135]
    v_pk_add_f32 v[72:73], v[72:73], v[136:137]
    v_pk_add_f32 v[74:75], v[74:75], v[138:139]
    v_pk_add_f32 v[76:77], v[76:77], v[140:141]
    v_pk_add_f32 v[78:79], v[78:79], v[142:143]
    v_pk_add_f32 v[80:81], v[80:81], v[144:145]
    v_pk_add_f32 v[82:83], v[82:83], v[146:147]
    v_cvt_pk_bf16_f32 v12, v64, v65
    v_cvt_pk_bf16_f32 v13, v66, v67
    v_cvt_pk_bf16_f32 v14, v68, v69
    v_cvt_pk_bf16_f32 v15, v70, v71
    v_cvt_pk_bf16_f32 v16, v72, v73
    v_cvt_pk_bf16_f32 v17, v74, v75
    v_cvt_pk_bf16_f32 v18, v76, v77
    v_cvt_pk_bf16_f32 v19, v78, v79
    v_cvt_pk_bf16_f32 v20, v80, v81
    v_cvt_pk_bf16_f32 v21, v82, v83
    v_mov_b32 v22, 0
    v_mov_b32 v23, 0
    v_mfma_f32_32x32x16_bf16 v[192:207], a[160:163], v[12:15], 0
    v_mfma_f32_32x32x16_bf16 v[192:207], a[164:167], v[16:19], v[192:207]
    v_mfma_f32_32x32x16_bf16 v[192:207], a[168:171], v[20:23], v[192:207]
    v_mfma_f32_32x32x16_bf16 v[208:223], a[172:175], v[12:15], 0
    v_mfma_f32_32x32x16_bf16 v[208:223], a[176:179], v[16:19], v[208:223]
    v_mfma_f32_32x32x16_bf16 v[208:223], a[180:183], v[20:23], v[208:223]
    v_pk_add_f32 v[84:85], v[84:85], v[148:149]
    v_pk_add_f32 v[86:87], v[86:87], v[150:151]
    v_pk_add_f32 v[88:89], v[88:89], v[152:153]
    v_pk_add_f32 v[90:91], v[90:91], v[154:155]
    v_pk_add_f32 v[92:93], v[92:93], v[156:157]
    v_pk_add_f32 v[94:95], v[94:95], v[158:159]
    v_pk_add_f32 v[96:97], v[96:97], v[160:161]
    v_pk_add_f32 v[98:99], v[98:99], v[162:163]
    v_pk_add_f32 v[100:101], v[100:101], v[164:165]
    v_pk_add_f32 v[102:103], v[102:103], v[166:167]
    v_cvt_pk_bf16_f32 v24, v84, v85
    v_cvt_pk_bf16_f32 v25, v86, v87
    v_cvt_pk_bf16_f32 v26, v88, v89
    v_cvt_pk_bf16_f32 v27, v90, v91
    v_cvt_pk_bf16_f32 v28, v92, v93
    v_cvt_pk_bf16_f32 v29, v94, v95
    v_cvt_pk_bf16_f32 v30, v96, v97
    v_cvt_pk_bf16_f32 v31, v98, v99
    v_cvt_pk_bf16_f32 v32, v100, v101
    v_cvt_pk_bf16_f32 v33, v102, v103
    v_mov_b32 v34, 0x3f80
    v_mov_b32 v35, 0
    ds_write_b128 v37, v[24:27]
    ds_write_b128 v37, v[28:31] offset:16
    ds_write_b128 v37, v[32:35] offset:32
    v_accvgpr_read_b32 v245, a242
    v_accvgpr_read_b32 v244, a249
    v_max3_f32 v2, v192, v193, v194
    v_min3_f32 v3, v192, v193, v194
    v_max3_f32 v2, v2, v195, v196
    v_min3_f32 v3, v3, v195, v196
    v_max3_f32 v2, v2, v197, v198
    v_min3_f32 v3, v3, v197, v198
    v_max3_f32 v2, v2, v199, v200
    v_min3_f32 v3, v3, v199, v200
    v_max3_f32 v2, v2, v201, v202
    v_min3_f32 v3, v3, v201, v202
    v_max3_f32 v2, v2, v203, v204
    v_min3_f32 v3, v3, v203, v204
    v_max3_f32 v2, v2, v205, v206
    v_min3_f32 v3, v3, v205, v206
    v_max3_f32 v2, v2, v207, v208
    v_min3_f32 v3, v3, v207, v208
    v_max3_f32 v2, v2, v209, v210
    v_min3_f32 v3, v3, v209, v210
    v_max_f32 v2, v2, v211
    v_min_f32 v3, v3, v211
    v_mul_f32 v4, s68, v2
    v_mul_f32 v6, s68, v3
    v_sub_f32 v4, 0, v4
    v_mov_b32 v7, v6
    v_mov_b32 v5, v4
    v_pk_fma_f32 v[128:129], v[192:193], s[68:69], v[4:5]
    v_pk_fma_f32 v[148:149], v[192:193], s[68:69], v[6:7] neg_lo:[1,0,0] neg_hi:[1,0,0]
    v_pk_fma_f32 v[130:131], v[194:195], s[68:69], v[4:5]
    v_pk_fma_f32 v[150:151], v[194:195], s[68:69], v[6:7] neg_lo:[1,0,0] neg_hi:[1,0,0]
    v_pk_fma_f32 v[132:133], v[196:197], s[68:69], v[4:5]
    v_pk_fma_f32 v[152:153], v[196:197], s[68:69], v[6:7] neg_lo:[1,0,0] neg_hi:[1,0,0]
    v_pk_fma_f32 v[134:135], v[198:199], s[68:69], v[4:5]
    v_pk_fma_f32 v[154:155], v[198:199], s[68:69], v[6:7] neg_lo:[1,0,0] neg_hi:[1,0,0]
    v_pk_fma_f32 v[136:137], v[200:201], s[68:69], v[4:5]
    v_pk_fma_f32 v[156:157], v[200:201], s[68:69], v[6:7] neg_lo:[1,0,0] neg_hi:[1,0,0]
    v_pk_fma_f32 v[138:139], v[202:203], s[68:69], v[4:5]
    v_pk_fma_f32 v[158:159], v[202:203], s[68:69], v[6:7] neg_lo:[1,0,0] neg_hi:[1,0,0]
    v_pk_fma_f32 v[140:141], v[204:205], s[68:69], v[4:5]
    v_pk_fma_f32 v[160:161], v[204:205], s[68:69], v[6:7] neg_lo:[1,0,0] neg_hi:[1,0,0]
    v_pk_fma_f32 v[142:143], v[206:207], s[68:69], v[4:5]
    v_pk_fma_f32 v[162:163], v[206:207], s[68:69], v[6:7] neg_lo:[1,0,0] neg_hi:[1,0,0]
    v_pk_fma_f32 v[144:145], v[208:209], s[68:69], v[4:5]
    v_pk_fma_f32 v[164:165], v[208:209], s[68:69], v[6:7] neg_lo:[1,0,0] neg_hi:[1,0,0]
    v_pk_fma_f32 v[146:147], v[210:211], s[68:69], v[4:5]
    v_pk_fma_f32 v[166:167], v[210:211], s[68:69], v[6:7] neg_lo:[1,0,0] neg_hi:[1,0,0]
    v_exp_f32 v128, v128
    v_exp_f32 v148, v148
    s_add_u32 m0, s82, 102400
    s_add_u32 s70, s95, 0
    buffer_load_dwordx4 v245, s[40:43], s70 offen lds
    v_exp_f32 v129, v129
    v_exp_f32 v149, v149
    v_exp_f32 v130, v130
    v_exp_f32 v150, v150
    s_add_u32 m0, s82, 103424
    s_add_u32 s70, s95, 245760
    buffer_load_dwordx4 v245, s[40:43], s70 offen lds
    v_exp_f32 v131, v131
    v_exp_f32 v151, v151
    v_exp_f32 v132, v132
    v_exp_f32 v152, v152
    s_add_u32 m0, s82, 104448
    s_add_u32 s70, s95, 491520
    buffer_load_dwordx4 v245, s[40:43], s70 offen lds
    v_exp_f32 v133, v133
    v_exp_f32 v153, v153
    v_exp_f32 v134, v134
    v_exp_f32 v154, v154
    s_add_u32 m0, s82, 105472
    s_add_u32 s70, s95, 737280
    buffer_load_dwordx4 v245, s[40:43], s70 offen lds
    v_exp_f32 v135, v135
    v_exp_f32 v155, v155
    v_exp_f32 v136, v136
    v_exp_f32 v156, v156
    s_add_u32 m0, s82, 106496
    s_add_u32 s70, s95, 983040
    buffer_load_dwordx4 v245, s[40:43], s70 offen lds
    v_exp_f32 v137, v137
    v_exp_f32 v157, v157
    v_exp_f32 v138, v138
    v_exp_f32 v158, v158
    buffer_load_dwordx2 a[224:225], v244, s[4:7], 0 offen offset:0
    v_exp_f32 v139, v139
    v_exp_f32 v159, v159
    v_exp_f32 v140, v140
    v_exp_f32 v160, v160
    buffer_load_dwordx2 a[226:227], v244, s[4:7], 0 offen offset:32
    v_exp_f32 v141, v141
    v_exp_f32 v161, v161
    v_exp_f32 v142, v142
    v_exp_f32 v162, v162
    buffer_load_dwordx2 a[228:229], v244, s[4:7], 0 offen offset:64
    v_exp_f32 v143, v143
    v_exp_f32 v163, v163
    v_exp_f32 v144, v144
    v_exp_f32 v164, v164
    buffer_load_dwordx2 a[230:231], v244, s[4:7], 0 offen offset:96
    v_exp_f32 v145, v145
    v_exp_f32 v165, v165
    v_exp_f32 v146, v146
    v_exp_f32 v166, v166
    buffer_load_dwordx2 a[232:233], v244, s[4:7], 0 offen offset:128
    v_exp_f32 v147, v147
    v_exp_f32 v167, v167
    v_pk_add_f32 v[8:9], v[128:129], v[130:131]
    v_pk_add_f32 v[10:11], v[148:149], v[150:151]
    v_pk_add_f32 v[8:9], v[8:9], v[132:133]
    v_pk_add_f32 v[10:11], v[10:11], v[152:153]
    v_pk_add_f32 v[8:9], v[8:9], v[134:135]
    v_pk_add_f32 v[10:11], v[10:11], v[154:155]
    v_pk_add_f32 v[8:9], v[8:9], v[136:137]
    v_pk_add_f32 v[10:11], v[10:11], v[156:157]
    v_pk_add_f32 v[8:9], v[8:9], v[138:139]
    v_pk_add_f32 v[10:11], v[10:11], v[158:159]
    v_pk_add_f32 v[8:9], v[8:9], v[140:141]
    v_pk_add_f32 v[10:11], v[10:11], v[160:161]
    v_pk_add_f32 v[8:9], v[8:9], v[142:143]
    v_pk_add_f32 v[10:11], v[10:11], v[162:163]
    v_pk_add_f32 v[8:9], v[8:9], v[144:145]
    v_pk_add_f32 v[10:11], v[10:11], v[164:165]
    v_pk_add_f32 v[8:9], v[8:9], v[146:147]
    v_pk_add_f32 v[10:11], v[10:11], v[166:167]
    v_add_f32 v8, v8, v9
    v_add_f32 v10, v10, v11
    v_rcp_f32 v8, v8
    v_rcp_f32 v10, v10
    s_nop 0
    v_mov_b32 v9, v8
    v_mov_b32 v11, v10
    v_pk_mul_f32 v[128:129], v[128:129], v[8:9]
    v_pk_mul_f32 v[148:149], v[148:149], v[10:11]
    v_pk_mul_f32 v[130:131], v[130:131], v[8:9]
    v_pk_mul_f32 v[150:151], v[150:151], v[10:11]
    v_pk_mul_f32 v[132:133], v[132:133], v[8:9]
    v_pk_mul_f32 v[152:153], v[152:153], v[10:11]
    v_pk_mul_f32 v[134:135], v[134:135], v[8:9]
    v_pk_mul_f32 v[154:155], v[154:155], v[10:11]
    v_pk_mul_f32 v[136:137], v[136:137], v[8:9]
    v_pk_mul_f32 v[156:157], v[156:157], v[10:11]
    v_pk_mul_f32 v[138:139], v[138:139], v[8:9]
    v_pk_mul_f32 v[158:159], v[158:159], v[10:11]
    v_pk_mul_f32 v[140:141], v[140:141], v[8:9]
    v_pk_mul_f32 v[160:161], v[160:161], v[10:11]
    v_pk_mul_f32 v[142:143], v[142:143], v[8:9]
    v_pk_mul_f32 v[162:163], v[162:163], v[10:11]
    v_pk_mul_f32 v[144:145], v[144:145], v[8:9]
    v_pk_mul_f32 v[164:165], v[164:165], v[10:11]
    s_branch L_PSK5
L_PAD5:
    s_setpc_b64 s[100:101]
L_PSK5:
    v_pk_mul_f32 v[146:147], v[146:147], v[8:9]
    v_pk_mul_f32 v[166:167], v[166:167], v[10:11]
    v_cvt_pk_bf16_f32 v224, v128, v129
    v_cvt_pk_bf16_f32 v225, v130, v131
    v_cvt_pk_bf16_f32 v226, v132, v133
    v_cvt_pk_bf16_f32 v227, v134, v135
    v_cvt_pk_bf16_f32 v228, v136, v137
    v_cvt_pk_bf16_f32 v229, v138, v139
    v_cvt_pk_bf16_f32 v230, v140, v141
    v_cvt_pk_bf16_f32 v231, v142, v143
    v_cvt_pk_bf16_f32 v232, v144, v145
    v_cvt_pk_bf16_f32 v233, v146, v147
    v_cvt_pk_bf16_f32 v234, v148, v149
    v_cvt_pk_bf16_f32 v235, v150, v151
    v_cvt_pk_bf16_f32 v236, v152, v153
    v_cvt_pk_bf16_f32 v237, v154, v155
    v_cvt_pk_bf16_f32 v238, v156, v157
    v_cvt_pk_bf16_f32 v239, v158, v159
    v_cvt_pk_bf16_f32 v240, v160, v161
    v_cvt_pk_bf16_f32 v241, v162, v163
    v_cvt_pk_bf16_f32 v242, v164, v165
    v_cvt_pk_bf16_f32 v243, v166, v167
    ds_write_b128 v36, v[224:227] offset:0
    ds_write_b128 v36, v[228:231] offset:16
    ds_write_b128 v36, v[232:235] offset:32
    ds_write_b128 v36, v[236:239] offset:48
    ds_write_b128 v36, v[240:243] offset:64
    v_accvgpr_read_b32 v9, a237
    v_accvgpr_read_b32 v10, a238
    v_accvgpr_read_b32 v4, a239
    v_accvgpr_read_b32 v6, a240
    s_waitcnt lgkmcnt(0)
    s_barrier
    ds_read_b64_tr_b16 v[40:41], v9 offset:0
    ds_read_b64_tr_b16 v[42:43], v9 offset:320
    ds_read_b64_tr_b16 v[44:45], v10 offset:0
    ds_read_b64_tr_b16 v[46:47], v10 offset:192
    ds_read_b64_tr_b16 v[48:49], v9 offset:1280
    ds_read_b64_tr_b16 v[50:51], v9 offset:1600
    ds_read_b64_tr_b16 v[52:53], v10 offset:768
    ds_read_b64_tr_b16 v[54:55], v10 offset:960
    ds_read_b64_tr_b16 v[56:57], v9 offset:2560
    ds_read_b64_tr_b16 v[58:59], v9 offset:2880
    ds_read_b64_tr_b16 v[60:61], v10 offset:1536
    ds_read_b64_tr_b16 v[62:63], v10 offset:1728
    ds_read_b64_tr_b16 v[64:65], v9 offset:3840
    ds_read_b64_tr_b16 v[66:67], v9 offset:4160
    ds_read_b64_tr_b16 v[68:69], v10 offset:2304
    ds_read_b64_tr_b16 v[70:71], v10 offset:2496
    ds_read_b64_tr_b16 v[72:73], v9 offset:5120
    ds_read_b64_tr_b16 v[74:75], v9 offset:5440
    ds_read_b64_tr_b16 v[76:77], v10 offset:3072
    ds_read_b64_tr_b16 v[78:79], v10 offset:3264
    ds_read_b64_tr_b16 v[80:81], v9 offset:6400
    ds_read_b64_tr_b16 v[82:83], v9 offset:6720
    ds_read_b64_tr_b16 v[84:85], v10 offset:3840
    ds_read_b64_tr_b16 v[86:87], v10 offset:4032
    ds_read_b64_tr_b16 v[88:89], v9 offset:7680
    ds_read_b64_tr_b16 v[90:91], v9 offset:8000
    ds_read_b64_tr_b16 v[92:93], v10 offset:4608
    ds_read_b64_tr_b16 v[94:95], v10 offset:4800
    ds_read_b64_tr_b16 v[96:97], v9 offset:8960
    ds_read_b64_tr_b16 v[98:99], v9 offset:9280
    ds_read_b64_tr_b16 v[100:101], v10 offset:5376
    ds_read_b64_tr_b16 v[102:103], v10 offset:5568
    s_waitcnt lgkmcnt(15)
    v_mfma_f32_32x32x16_bf16 v[192:207], v[40:43], v[44:47], 0
    s_waitcnt lgkmcnt(15)
    v_mfma_f32_32x32x16_bf16 v[192:207], v[48:51], v[52:55], v[192:207]
    s_waitcnt lgkmcnt(15)
    v_mfma_f32_32x32x16_bf16 v[192:207], v[56:59], v[60:63], v[192:207]
    s_waitcnt lgkmcnt(15)
    v_mfma_f32_32x32x16_bf16 v[192:207], v[64:67], v[68:71], v[192:207]
    s_waitcnt lgkmcnt(12)
    v_mfma_f32_32x32x16_bf16 v[192:207], v[72:75], v[76:79], v[192:207]
    s_waitcnt lgkmcnt(8)
    v_mfma_f32_32x32x16_bf16 v[192:207], v[80:83], v[84:87], v[192:207]
    s_waitcnt lgkmcnt(4)
    v_mfma_f32_32x32x16_bf16 v[192:207], v[88:91], v[92:95], v[192:207]
    s_waitcnt lgkmcnt(0)
    v_mfma_f32_32x32x16_bf16 v[192:207], v[96:99], v[100:103], v[192:207]
    s_nop 11
    v_cvt_pk_bf16_f32 v8, v192, v193
    v_cvt_pk_bf16_f32 v9, v194, v195
    v_cvt_pk_bf16_f32 v10, v196, v197
    v_cvt_pk_bf16_f32 v11, v198, v199
    v_cvt_pk_bf16_f32 v12, v200, v201
    v_cvt_pk_bf16_f32 v13, v202, v203
    v_cvt_pk_bf16_f32 v14, v204, v205
    v_cvt_pk_bf16_f32 v15, v206, v207
    buffer_store_dwordx4 v[8:11], v4, s[48:51], s93 offen sc1
    buffer_store_dwordx4 v[12:15], v6, s[48:51], s93 offen sc1
    v_accvgpr_read_b32 v38, a241
    v_accvgpr_read_b32 v2, a251
    v_accvgpr_read_b32 v3, a252
    s_waitcnt vmcnt(0)
    s_barrier
    s_cmp_lg_u32 s59, 0
    s_cbranch_scc1 L_SF3370
    s_lshl_b32 s70, s58, 7
    s_lshl_b32 s71, s57, 2
    s_add_u32 s70, s70, s71
    s_add_u32 s70, s70, 2048
    v_mov_b32 v248, s56
    v_mov_b32 v249, 0
    s_mov_b64 exec, 1
    buffer_store_dword v248, v249, s[48:51], s70 offen sc1
    s_mov_b64 exec, -1
L_SF3370:
    ds_read_b128 v[40:43], v38 offset:0
    ds_read_b128 v[44:47], v38 offset:768
    ds_read_b128 v[48:51], v38 offset:1536
    ds_read_b128 v[52:55], v38 offset:2304
    ds_read_b128 v[56:59], v38 offset:3072
    s_waitcnt lgkmcnt(4)
    v_mfma_f32_32x32x16_bf16 v[112:127], v[40:43], a[0:3], 0
    ds_read_b128 v[60:63], v38 offset:3840
    s_waitcnt lgkmcnt(4)
    v_mfma_f32_32x32x16_bf16 v[112:127], v[44:47], a[4:7], v[112:127]
    s_add_u32 s79, s59, 0
    s_mul_i32 s78, s79, 5120
    s_lshr_b32 s77, s58, 1
    s_mul_i32 s77, s77, 102400
    s_add_u32 s77, s77, s78
    s_add_u32 s77, s77, 21045248
    s_mov_b32 m0, s78
    s_nop 0
    buffer_load_dwordx4 v39, s[48:51], s77 offen offset:0 sc1 lds
    ds_read_b128 v[40:43], v38 offset:4608
    s_waitcnt lgkmcnt(4)
    v_mfma_f32_32x32x16_bf16 v[112:127], v[48:51], a[8:11], v[112:127]
    ds_read_b128 v[44:47], v38 offset:5376
    s_waitcnt lgkmcnt(4)
    v_mfma_f32_32x32x16_bf16 v[112:127], v[52:55], a[12:15], v[112:127]
    ds_read_b128 v[48:51], v38 offset:6144
    s_waitcnt lgkmcnt(4)
    v_mfma_f32_32x32x16_bf16 v[112:127], v[56:59], a[16:19], v[112:127]
    buffer_load_dwordx4 v39, s[48:51], s77 offen offset:1024 sc1 lds
    ds_read_b128 v[52:55], v38 offset:6912
    s_waitcnt lgkmcnt(4)
    v_mfma_f32_32x32x16_bf16 v[112:127], v[60:63], a[20:23], v[112:127]
    ds_read_b128 v[56:59], v38 offset:7680
    s_waitcnt lgkmcnt(4)
    v_mfma_f32_32x32x16_bf16 v[112:127], v[40:43], a[24:27], v[112:127]
    ds_read_b128 v[60:63], v38 offset:8448
    s_waitcnt lgkmcnt(4)
    v_mfma_f32_32x32x16_bf16 v[112:127], v[44:47], a[28:31], v[112:127]
    buffer_load_dwordx4 v39, s[48:51], s77 offen offset:2048 sc1 lds
    ds_read_b128 v[40:43], v38 offset:9216
    s_waitcnt lgkmcnt(4)
    v_mfma_f32_32x32x16_bf16 v[112:127], v[48:51], a[32:35], v[112:127]
    ds_read_b128 v[44:47], v38 offset:9984
    s_waitcnt lgkmcnt(4)
    v_mfma_f32_32x32x16_bf16 v[112:127], v[52:55], a[36:39], v[112:127]
    ds_read_b128 v[48:51], v38 offset:10752
    s_waitcnt lgkmcnt(4)
    v_mfma_f32_32x32x16_bf16 v[112:127], v[56:59], a[40:43], v[112:127]
    buffer_load_dwordx4 v39, s[48:51], s77 offen offset:3072 sc1 lds
    ds_read_b128 v[52:55], v38 offset:11520
    s_waitcnt lgkmcnt(4)
    v_mfma_f32_32x32x16_bf16 v[112:127], v[60:63], a[44:47], v[112:127]
    ds_read_b128 v[56:59], v38 offset:12288
    s_waitcnt lgkmcnt(4)
    v_mfma_f32_32x32x16_bf16 v[112:127], v[40:43], a[48:51], v[112:127]
    ds_read_b128 v[60:63], v38 offset:13056
    s_waitcnt lgkmcnt(4)
    v_mfma_f32_32x32x16_bf16 v[112:127], v[44:47], a[52:55], v[112:127]
    s_add_u32 m0, s78, 4096
    s_add_u32 s77, s77, 4096
    buffer_load_dwordx4 v39, s[48:51], s77 offen sc1 lds
    ds_read_b128 v[40:43], v38 offset:13824
    s_waitcnt lgkmcnt(4)
    v_mfma_f32_32x32x16_bf16 v[112:127], v[48:51], a[56:59], v[112:127]
    ds_read_b128 v[44:47], v38 offset:14592
    s_waitcnt lgkmcnt(4)
    v_mfma_f32_32x32x16_bf16 v[112:127], v[52:55], a[60:63], v[112:127]
    ds_read_b128 v[48:51], v38 offset:15360
    s_waitcnt lgkmcnt(4)
    v_mfma_f32_32x32x16_bf16 v[112:127], v[56:59], a[64:67], v[112:127]
    s_add_u32 s79, s59, 4
    s_mul_i32 s78, s79, 5120
    s_lshr_b32 s77, s58, 1
    s_mul_i32 s77, s77, 102400
    s_add_u32 s77, s77, s78
    s_add_u32 s77, s77, 21045248
    s_mov_b32 m0, s78
    s_nop 0
    buffer_load_dwordx4 v39, s[48:51], s77 offen offset:0 sc1 lds
    ds_read_b128 v[52:55], v38 offset:16128
    s_waitcnt lgkmcnt(4)
    v_mfma_f32_32x32x16_bf16 v[112:127], v[60:63], a[68:71], v[112:127]
    ds_read_b128 v[56:59], v38 offset:16896
    s_waitcnt lgkmcnt(4)
    v_mfma_f32_32x32x16_bf16 v[112:127], v[40:43], a[72:75], v[112:127]
    ds_read_b128 v[60:63], v38 offset:17664
    s_waitcnt lgkmcnt(4)
    v_mfma_f32_32x32x16_bf16 v[112:127], v[44:47], a[76:79], v[112:127]
    buffer_load_dwordx4 v39, s[48:51], s77 offen offset:1024 sc1 lds
    ds_read_b128 v[40:43], v38 offset:18432
    s_waitcnt lgkmcnt(4)
    v_mfma_f32_32x32x16_bf16 v[112:127], v[48:51], a[80:83], v[112:127]
    ds_read_b128 v[44:47], v38 offset:19200
    s_waitcnt lgkmcnt(4)
    v_mfma_f32_32x32x16_bf16 v[112:127], v[52:55], a[84:87], v[112:127]
    ds_read_b128 v[48:51], v38 offset:19968
    s_waitcnt lgkmcnt(4)
    v_mfma_f32_32x32x16_bf16 v[112:127], v[56:59], a[88:91], v[112:127]
    buffer_load_dwordx4 v39, s[48:51], s77 offen offset:2048 sc1 lds
    ds_read_b128 v[52:55], v38 offset:20736
    s_waitcnt lgkmcnt(4)
    v_mfma_f32_32x32x16_bf16 v[112:127], v[60:63], a[92:95], v[112:127]
    ds_read_b128 v[56:59], v38 offset:21504
    s_waitcnt lgkmcnt(4)
    v_mfma_f32_32x32x16_bf16 v[112:127], v[40:43], a[96:99], v[112:127]
    ds_read_b128 v[60:63], v38 offset:22272
    s_waitcnt lgkmcnt(4)
    v_mfma_f32_32x32x16_bf16 v[112:127], v[44:47], a[100:103], v[112:127]
    buffer_load_dwordx4 v39, s[48:51], s77 offen offset:3072 sc1 lds
    ds_read_b128 v[40:43], v38 offset:23040
    s_waitcnt lgkmcnt(4)
    v_mfma_f32_32x32x16_bf16 v[112:127], v[48:51], a[104:107], v[112:127]
    ds_read_b128 v[44:47], v38 offset:23808
    s_waitcnt lgkmcnt(4)
    v_mfma_f32_32x32x16_bf16 v[112:127], v[52:55], a[108:111], v[112:127]
    ds_read_b128 v[48:51], v38 offset:24576
    s_waitcnt lgkmcnt(4)
    v_mfma_f32_32x32x16_bf16 v[112:127], v[56:59], a[112:115], v[112:127]
    s_add_u32 m0, s78, 4096
    s_add_u32 s77, s77, 4096
    buffer_load_dwordx4 v39, s[48:51], s77 offen sc1 lds
    ds_read_b128 v[52:55], v38 offset:25344
    s_waitcnt lgkmcnt(4)
    v_mfma_f32_32x32x16_bf16 v[112:127], v[60:63], a[116:119], v[112:127]
    ds_read_b128 v[56:59], v38 offset:26112
    s_waitcnt lgkmcnt(4)
    v_mfma_f32_32x32x16_bf16 v[112:127], v[40:43], a[120:123], v[112:127]
    ds_read_b128 v[60:63], v38 offset:26880
    s_waitcnt lgkmcnt(4)
    v_mfma_f32_32x32x16_bf16 v[112:127], v[44:47], a[124:127], v[112:127]
    s_lshl_b32 s70, s61, 2
    s_add_u32 s70, s70, s59
    s_mul_i32 s70, s70, 17280
    s_and_b32 s71, s60, 1
    s_mul_i32 s71, s71, 1664
    s_add_u32 s70, s70, s71
    buffer_load_dword v246, v2, s[20:23], s70 offen
    ds_read_b128 v[40:43], v38 offset:27648
    s_waitcnt lgkmcnt(4)
    v_mfma_f32_32x32x16_bf16 v[112:127], v[48:51], a[128:131], v[112:127]
    ds_read_b128 v[44:47], v38 offset:28416
    s_waitcnt lgkmcnt(4)
    v_mfma_f32_32x32x16_bf16 v[112:127], v[52:55], a[132:135], v[112:127]
    ds_read_b128 v[48:51], v38 offset:29184
    s_waitcnt lgkmcnt(4)
    v_mfma_f32_32x32x16_bf16 v[112:127], v[56:59], a[136:139], v[112:127]
    buffer_load_dword v247, v3, s[20:23], s70 offen
    ds_read_b128 v[52:55], v38 offset:29952
    s_waitcnt lgkmcnt(4)
    v_mfma_f32_32x32x16_bf16 v[112:127], v[60:63], a[140:143], v[112:127]
    s_waitcnt lgkmcnt(3)
    v_mfma_f32_32x32x16_bf16 v[112:127], v[40:43], a[144:147], v[112:127]
    s_waitcnt lgkmcnt(2)
    v_mfma_f32_32x32x16_bf16 v[112:127], v[44:47], a[148:151], v[112:127]
    s_waitcnt lgkmcnt(1)
    v_mfma_f32_32x32x16_bf16 v[112:127], v[48:51], a[152:155], v[112:127]
    s_waitcnt lgkmcnt(0)
    v_mfma_f32_32x32x16_bf16 v[112:127], v[52:55], a[156:159], v[112:127]
    v_pk_add_f32 v[104:105], v[104:105], v[168:169]
    v_pk_add_f32 v[106:107], v[106:107], v[170:171]
    v_pk_add_f32 v[108:109], v[108:109], v[172:173]
    v_pk_add_f32 v[110:111], v[110:111], v[174:175]
    s_nop 7
    v_pk_add_f32 v[112:113], v[112:113], v[176:177]
    v_pk_add_f32 v[114:115], v[114:115], v[178:179]
    v_pk_add_f32 v[116:117], v[116:117], v[180:181]
    v_pk_add_f32 v[118:119], v[118:119], v[182:183]
    v_pk_add_f32 v[120:121], v[120:121], v[184:185]
    v_pk_add_f32 v[122:123], v[122:123], v[186:187]
    v_cvt_pk_bf16_f32 v12, v104, v105
    v_cvt_pk_bf16_f32 v13, v106, v107
    v_cvt_pk_bf16_f32 v14, v108, v109
    v_cvt_pk_bf16_f32 v15, v110, v111
    v_cvt_pk_bf16_f32 v16, v112, v113
    v_cvt_pk_bf16_f32 v17, v114, v115
    v_cvt_pk_bf16_f32 v18, v116, v117
    v_cvt_pk_bf16_f32 v19, v118, v119
    v_cvt_pk_bf16_f32 v20, v120, v121
    v_cvt_pk_bf16_f32 v21, v122, v123
    v_mov_b32 v22, 0
    v_mov_b32 v23, 0
    v_mfma_f32_32x32x16_bf16 v[192:207], a[160:163], v[12:15], 0
    v_mfma_f32_32x32x16_bf16 v[192:207], a[164:167], v[16:19], v[192:207]
    v_mfma_f32_32x32x16_bf16 v[192:207], a[168:171], v[20:23], v[192:207]
    v_mfma_f32_32x32x16_bf16 v[208:223], a[172:175], v[12:15], 0
    v_mfma_f32_32x32x16_bf16 v[208:223], a[176:179], v[16:19], v[208:223]
    v_mfma_f32_32x32x16_bf16 v[208:223], a[180:183], v[20:23], v[208:223]
    v_accvgpr_read_b32 v2, a250
    ds_read_b64_tr_b16 v[40:41], v2 offset:0
    ds_read_b64_tr_b16 v[42:43], v2 offset:512
    ds_read_b64_tr_b16 v[44:45], v2 offset:1024
    ds_read_b64_tr_b16 v[46:47], v2 offset:1536
    ds_read_b64_tr_b16 v[48:49], v2 offset:2048
    ds_read_b64_tr_b16 v[50:51], v2 offset:2560
    ds_read_b64_tr_b16 v[52:53], v2 offset:3072
    ds_read_b64_tr_b16 v[54:55], v2 offset:3584
    ds_read_b64_tr_b16 v[56:57], v2 offset:4096
    ds_read_b64_tr_b16 v[58:59], v2 offset:4608
    v_and_b32 v3, 15, v1
    v_lshlrev_b32 v3, 2, v3
    s_lshl_b32 s70, s59, 6
    v_add_u32 v60, s70, v3
    v_add_u32 v60, 162304, v60
    v_add_u32 v61, 162304, v3
    s_waitcnt lgkmcnt(0)
    v_mfma_f32_16x16x32_bf16 v[64:67], a[204:207], v[40:43], 0
    v_mfma_f32_16x16x32_bf16 v[64:67], a[208:211], v[44:47], v[64:67]
    v_mfma_f32_16x16x32_bf16 v[64:67], a[212:215], v[48:51], v[64:67]
    v_mfma_f32_16x16x32_bf16 v[64:67], a[216:219], v[52:55], v[64:67]
    v_mfma_f32_16x16x32_bf16 v[64:67], a[220:223], v[56:59], v[64:67]
    v_max3_f32 v2, v192, v193, v194
    v_min3_f32 v3, v192, v193, v194
    v_max3_f32 v2, v2, v195, v196
    v_min3_f32 v3, v3, v195, v196
    v_max3_f32 v2, v2, v197, v198
    v_min3_f32 v3, v3, v197, v198
    v_max3_f32 v2, v2, v199, v200
    v_min3_f32 v3, v3, v199, v200
    v_max3_f32 v2, v2, v201, v202
    v_min3_f32 v3, v3, v201, v202
    v_max3_f32 v2, v2, v203, v204
    v_min3_f32 v3, v3, v203, v204
    v_max3_f32 v2, v2, v205, v206
    v_min3_f32 v3, v3, v205, v206
    v_max3_f32 v2, v2, v207, v208
    v_min3_f32 v3, v3, v207, v208
    v_max3_f32 v2, v2, v209, v210
    v_min3_f32 v3, v3, v209, v210
    v_max_f32 v2, v2, v211
    v_min_f32 v3, v3, v211
    v_mul_f32 v4, s68, v2
    v_mul_f32 v6, s68, v3
    v_sub_f32 v4, 0, v4
    v_mov_b32 v7, v6
    v_mov_b32 v5, v4
    v_pk_fma_f32 v[128:129], v[192:193], s[68:69], v[4:5]
    v_pk_fma_f32 v[148:149], v[192:193], s[68:69], v[6:7] neg_lo:[1,0,0] neg_hi:[1,0,0]
    v_pk_fma_f32 v[130:131], v[194:195], s[68:69], v[4:5]
    v_pk_fma_f32 v[150:151], v[194:195], s[68:69], v[6:7] neg_lo:[1,0,0] neg_hi:[1,0,0]
    v_pk_fma_f32 v[132:133], v[196:197], s[68:69], v[4:5]
    v_pk_fma_f32 v[152:153], v[196:197], s[68:69], v[6:7] neg_lo:[1,0,0] neg_hi:[1,0,0]
    v_pk_fma_f32 v[134:135], v[198:199], s[68:69], v[4:5]
    v_pk_fma_f32 v[154:155], v[198:199], s[68:69], v[6:7] neg_lo:[1,0,0] neg_hi:[1,0,0]
    v_pk_fma_f32 v[136:137], v[200:201], s[68:69], v[4:5]
    v_pk_fma_f32 v[156:157], v[200:201], s[68:69], v[6:7] neg_lo:[1,0,0] neg_hi:[1,0,0]
    v_pk_fma_f32 v[138:139], v[202:203], s[68:69], v[4:5]
    v_pk_fma_f32 v[158:159], v[202:203], s[68:69], v[6:7] neg_lo:[1,0,0] neg_hi:[1,0,0]
    v_pk_fma_f32 v[140:141], v[204:205], s[68:69], v[4:5]
    v_pk_fma_f32 v[160:161], v[204:205], s[68:69], v[6:7] neg_lo:[1,0,0] neg_hi:[1,0,0]
    v_pk_fma_f32 v[142:143], v[206:207], s[68:69], v[4:5]
    v_pk_fma_f32 v[162:163], v[206:207], s[68:69], v[6:7] neg_lo:[1,0,0] neg_hi:[1,0,0]
    v_pk_fma_f32 v[144:145], v[208:209], s[68:69], v[4:5]
    v_pk_fma_f32 v[164:165], v[208:209], s[68:69], v[6:7] neg_lo:[1,0,0] neg_hi:[1,0,0]
    v_pk_fma_f32 v[146:147], v[210:211], s[68:69], v[4:5]
    v_pk_fma_f32 v[166:167], v[210:211], s[68:69], v[6:7] neg_lo:[1,0,0] neg_hi:[1,0,0]
    v_exp_f32 v128, v128
    v_exp_f32 v148, v148
    v_exp_f32 v129, v129
    v_exp_f32 v149, v149
    v_exp_f32 v130, v130
    v_exp_f32 v150, v150
    v_exp_f32 v131, v131
    v_exp_f32 v151, v151
    v_exp_f32 v132, v132
    v_exp_f32 v152, v152
    v_exp_f32 v133, v133
    v_exp_f32 v153, v153
    v_exp_f32 v134, v134
    v_exp_f32 v154, v154
    v_exp_f32 v135, v135
    v_exp_f32 v155, v155
    v_exp_f32 v136, v136
    v_exp_f32 v156, v156
    v_exp_f32 v137, v137
    v_exp_f32 v157, v157
    v_exp_f32 v138, v138
    v_exp_f32 v158, v158
    v_exp_f32 v139, v139
    v_exp_f32 v159, v159
    v_exp_f32 v140, v140
    v_exp_f32 v160, v160
    v_exp_f32 v141, v141
    v_exp_f32 v161, v161
    v_exp_f32 v142, v142
    v_exp_f32 v162, v162
    v_exp_f32 v143, v143
    v_exp_f32 v163, v163
    v_exp_f32 v144, v144
    v_exp_f32 v164, v164
    v_exp_f32 v145, v145
    v_exp_f32 v165, v165
    v_exp_f32 v146, v146
    v_exp_f32 v166, v166
    v_exp_f32 v147, v147
    v_exp_f32 v167, v167
    v_pk_add_f32 v[8:9], v[128:129], v[130:131]
    v_pk_add_f32 v[10:11], v[148:149], v[150:151]
    v_pk_add_f32 v[8:9], v[8:9], v[132:133]
    v_pk_add_f32 v[10:11], v[10:11], v[152:153]
    v_pk_add_f32 v[8:9], v[8:9], v[134:135]
    v_pk_add_f32 v[10:11], v[10:11], v[154:155]
    v_pk_add_f32 v[8:9], v[8:9], v[136:137]
    v_pk_add_f32 v[10:11], v[10:11], v[156:157]
    v_pk_add_f32 v[8:9], v[8:9], v[138:139]
    v_pk_add_f32 v[10:11], v[10:11], v[158:159]
    v_pk_add_f32 v[8:9], v[8:9], v[140:141]
    v_pk_add_f32 v[10:11], v[10:11], v[160:161]
    v_pk_add_f32 v[8:9], v[8:9], v[142:143]
    v_pk_add_f32 v[10:11], v[10:11], v[162:163]
    v_pk_add_f32 v[8:9], v[8:9], v[144:145]
    v_pk_add_f32 v[10:11], v[10:11], v[164:165]
    v_pk_add_f32 v[8:9], v[8:9], v[146:147]
    v_pk_add_f32 v[10:11], v[10:11], v[166:167]
    v_add_f32 v8, v8, v9
    v_add_f32 v10, v10, v11
    v_rcp_f32 v8, v8
    v_rcp_f32 v10, v10
    s_nop 0
    v_mov_b32 v9, v8
    v_mov_b32 v11, v10
    v_pk_mul_f32 v[128:129], v[128:129], v[8:9]
    v_pk_mul_f32 v[148:149], v[148:149], v[10:11]
    v_pk_mul_f32 v[130:131], v[130:131], v[8:9]
    v_pk_mul_f32 v[150:151], v[150:151], v[10:11]
    v_pk_mul_f32 v[132:133], v[132:133], v[8:9]
    v_pk_mul_f32 v[152:153], v[152:153], v[10:11]
    v_pk_mul_f32 v[134:135], v[134:135], v[8:9]
    v_pk_mul_f32 v[154:155], v[154:155], v[10:11]
    v_pk_mul_f32 v[136:137], v[136:137], v[8:9]
    v_pk_mul_f32 v[156:157], v[156:157], v[10:11]
    v_pk_mul_f32 v[138:139], v[138:139], v[8:9]
    v_pk_mul_f32 v[158:159], v[158:159], v[10:11]
    v_pk_mul_f32 v[140:141], v[140:141], v[8:9]
    v_pk_mul_f32 v[160:161], v[160:161], v[10:11]
    v_pk_mul_f32 v[142:143], v[142:143], v[8:9]
    v_pk_mul_f32 v[162:163], v[162:163], v[10:11]
    v_pk_mul_f32 v[144:145], v[144:145], v[8:9]
    v_pk_mul_f32 v[164:165], v[164:165], v[10:11]
    v_pk_mul_f32 v[146:147], v[146:147], v[8:9]
    v_pk_mul_f32 v[166:167], v[166:167], v[10:11]
    v_cvt_pk_bf16_f32 v224, v128, v129
    v_cvt_pk_bf16_f32 v225, v130, v131
    v_cvt_pk_bf16_f32 v226, v132, v133
    v_cvt_pk_bf16_f32 v227, v134, v135
    v_cvt_pk_bf16_f32 v228, v136, v137
    v_cvt_pk_bf16_f32 v229, v138, v139
    v_cvt_pk_bf16_f32 v230, v140, v141
    v_cvt_pk_bf16_f32 v231, v142, v143
    v_cvt_pk_bf16_f32 v232, v144, v145
    v_cvt_pk_bf16_f32 v233, v146, v147
    v_cvt_pk_bf16_f32 v234, v148, v149
    v_cvt_pk_bf16_f32 v235, v150, v151
    v_cvt_pk_bf16_f32 v236, v152, v153
    v_cvt_pk_bf16_f32 v237, v154, v155
    v_cvt_pk_bf16_f32 v238, v156, v157
    v_cvt_pk_bf16_f32 v239, v158, v159
    v_cvt_pk_bf16_f32 v240, v160, v161
    v_cvt_pk_bf16_f32 v241, v162, v163
    v_cvt_pk_bf16_f32 v242, v164, v165
    v_cvt_pk_bf16_f32 v243, v166, v167
    ds_write_b32 v60, v64
    v_accvgpr_read_b32 v3, a243
    s_waitcnt lgkmcnt(0)
    s_barrier
    s_cmp_lg_u32 s59, 0
    s_cbranch_scc1 L_M3745
    s_cmp_ge_u32 s61, 20
    s_cbranch_scc1 L_M3745
    ds_read_b32 v8, v61
    ds_read_b32 v9, v61 offset:64
    ds_read_b32 v10, v61 offset:128
    ds_read_b32 v11, v61 offset:192
    s_waitcnt lgkmcnt(0)
    v_add_f32 v8, v8, v9
    v_add_f32 v10, v10, v11
    v_add_f32 v8, v8, v10
    v_cvt_pk_bf16_f32 v8, v8, v8
    v_and_b32 v8, 0xffff0000, v8
    v_lshlrev_b32 v4, 2, v1
    s_lshl_b32 s70, s92, 6
    s_add_u32 s70, s70, 29696
    s_mov_b64 exec, 0xffff
    buffer_store_dword v8, v4, s[48:51], s70 offen sc1
    s_mov_b64 exec, -1
    s_waitcnt vmcnt(0)
    v_mov_b32 v248, s56
    v_mul_u32_u24 v249, 1024, v1
    s_lshl_b32 s70, s92, 2
    s_add_u32 s70, s70, 16384
    s_mov_b64 exec, 0xff
    buffer_store_dword v248, v249, s[48:51], s70 offen sc1
    s_mov_b64 exec, -1
L_M3745:
    s_cmp_lg_u32 s59, 1
    s_cbranch_scc1 L_TC3774
    s_call_b64 s[100:101], L_PAD11
L_TC3774:
    s_cmp_lg_u32 s59, 2
    s_cbranch_scc1 L_TC3778
    s_call_b64 s[100:101], L_PAD12
L_TC3778:
    s_cmp_lg_u32 s59, 3
    s_cbranch_scc1 L_TC3782
    s_call_b64 s[100:101], L_PAD13
L_TC3782:
    s_cmp_lg_u32 s59, 0
    s_cbranch_scc1 L_PD3786
    s_lshl_b32 s70, s58, 7
    s_add_u32 s70, s70, 2048
    s_mov_b32 s71, 1048576
    v_min_u32 v248, 15, v1
    v_lshlrev_b32 v248, 2, v248
L_PL3786:
    buffer_load_dword v250, v248, s[48:51], s70 offen sc1
    s_waitcnt vmcnt(0)
    v_cmp_ne_u32 vcc, s56, v250
    s_sub_u32 s71, s71, 1
    s_cmp_eq_u32 s71, 0
    s_cbranch_scc1 L_PT3786
    s_cbranch_vccnz L_PL3786
    s_branch L_PD3786
L_PT3786:
    v_mov_b32 v250, 176
    v_mov_b32 v251, 0
    buffer_store_dword v250, v251, s[52:55], 0 offen
    s_waitcnt vmcnt(0)
L_PD3786:
    s_barrier
    s_mul_i32 s70, s58, 57344
    s_add_u32 s70, s70, 516096
    buffer_load_dwordx4 v[128:131], v3, s[48:51], s70 offen sc1
    s_add_u32 s70, s70, 3584
    buffer_load_dwordx4 v[132:135], v3, s[48:51], s70 offen sc1
    s_add_u32 s70, s70, 3584
    buffer_load_dwordx4 v[136:139], v3, s[48:51], s70 offen sc1
    s_add_u32 s70, s70, 3584
    buffer_load_dwordx4 v[140:143], v3, s[48:51], s70 offen sc1
    s_add_u32 s70, s70, 3584
    buffer_load_dwordx4 v[144:147], v3, s[48:51], s70 offen sc1
    s_add_u32 s70, s70, 3584
    buffer_load_dwordx4 v[148:151], v3, s[48:51], s70 offen sc1
    s_add_u32 s70, s70, 3584
    buffer_load_dwordx4 v[152:155], v3, s[48:51], s70 offen sc1
    s_add_u32 s70, s70, 3584
    buffer_load_dwordx4 v[156:159], v3, s[48:51], s70 offen sc1
    s_add_u32 s70, s70, 3584
    buffer_load_dwordx4 v[160:163], v3, s[48:51], s70 offen sc1
    s_add_u32 s70, s70, 3584
    buffer_load_dwordx4 v[164:167], v3, s[48:51], s70 offen sc1
    s_add_u32 s70, s70, 3584
    buffer_load_dwordx4 v[168:171], v3, s[48:51], s70 offen sc1
    s_add_u32 s70, s70, 3584
    buffer_load_dwordx4 v[172:175], v3, s[48:51], s70 offen sc1
    s_add_u32 s70, s70, 3584
    buffer_load_dwordx4 v[176:179], v3, s[48:51], s70 offen sc1
    s_add_u32 s70, s70, 3584
    buffer_load_dwordx4 v[180:183], v3, s[48:51], s70 offen sc1
    s_add_u32 s70, s70, 3584
    buffer_load_dwordx4 v[184:187], v3, s[48:51], s70 offen sc1
    s_add_u32 s70, s70, 3584
    buffer_load_dwordx4 v[188:191], v3, s[48:51], s70 offen sc1
    v_accvgpr_read_b32 v3, a244
    v_accvgpr_read_b32 v6, a245
    v_accvgpr_read_b32 v7, a246
    v_accvgpr_read_b32 v36, a247
    v_accvgpr_read_b32 v37, a248
    s_mov_b32 s71, 0x3f80
    s_mov_b32 s72, 0x3f800000
    s_waitcnt vmcnt(15)
    v_lshlrev_b32 v8, 16, v128
    v_and_b32 v9, 0xffff0000, v128
    v_lshlrev_b32 v10, 16, v129
    v_and_b32 v11, 0xffff0000, v129
    v_lshlrev_b32 v12, 16, v130
    v_and_b32 v13, 0xffff0000, v130
    v_lshlrev_b32 v14, 16, v131
    v_and_b32 v15, 0xffff0000, v131
    s_waitcnt vmcnt(14)
    v_dot2_f32_bf16 v8, v132, s71, v8
    v_dot2_f32_bf16 v9, v132, s72, v9
    v_dot2_f32_bf16 v10, v133, s71, v10
    v_dot2_f32_bf16 v11, v133, s72, v11
    v_dot2_f32_bf16 v12, v134, s71, v12
    v_dot2_f32_bf16 v13, v134, s72, v13
    v_dot2_f32_bf16 v14, v135, s71, v14
    v_dot2_f32_bf16 v15, v135, s72, v15
    s_waitcnt vmcnt(13)
    v_dot2_f32_bf16 v8, v136, s71, v8
    v_dot2_f32_bf16 v9, v136, s72, v9
    v_dot2_f32_bf16 v10, v137, s71, v10
    v_dot2_f32_bf16 v11, v137, s72, v11
    v_dot2_f32_bf16 v12, v138, s71, v12
    v_dot2_f32_bf16 v13, v138, s72, v13
    v_dot2_f32_bf16 v14, v139, s71, v14
    v_dot2_f32_bf16 v15, v139, s72, v15
    s_waitcnt vmcnt(12)
    v_dot2_f32_bf16 v8, v140, s71, v8
    v_dot2_f32_bf16 v9, v140, s72, v9
    v_dot2_f32_bf16 v10, v141, s71, v10
    v_dot2_f32_bf16 v11, v141, s72, v11
    v_dot2_f32_bf16 v12, v142, s71, v12
    v_dot2_f32_bf16 v13, v142, s72, v13
    v_dot2_f32_bf16 v14, v143, s71, v14
    v_dot2_f32_bf16 v15, v143, s72, v15
    s_branch L_PSK6
L_PAD6:
    s_setpc_b64 s[100:101]
L_PSK6:
    s_waitcnt vmcnt(11)
    v_dot2_f32_bf16 v8, v144, s71, v8
    v_dot2_f32_bf16 v9, v144, s72, v9
    v_dot2_f32_bf16 v10, v145, s71, v10
    v_dot2_f32_bf16 v11, v145, s72, v11
    v_dot2_f32_bf16 v12, v146, s71, v12
    v_dot2_f32_bf16 v13, v146, s72, v13
    v_dot2_f32_bf16 v14, v147, s71, v14
    v_dot2_f32_bf16 v15, v147, s72, v15
    s_waitcnt vmcnt(10)
    v_dot2_f32_bf16 v8, v148, s71, v8
    v_dot2_f32_bf16 v9, v148, s72, v9
    v_dot2_f32_bf16 v10, v149, s71, v10
    v_dot2_f32_bf16 v11, v149, s72, v11
    v_dot2_f32_bf16 v12, v150, s71, v12
    v_dot2_f32_bf16 v13, v150, s72, v13
    v_dot2_f32_bf16 v14, v151, s71, v14
    v_dot2_f32_bf16 v15, v151, s72, v15
    s_waitcnt vmcnt(9)
    v_dot2_f32_bf16 v8, v152, s71, v8
    v_dot2_f32_bf16 v9, v152, s72, v9
    v_dot2_f32_bf16 v10, v153, s71, v10
    v_dot2_f32_bf16 v11, v153, s72, v11
    v_dot2_f32_bf16 v12, v154, s71, v12
    v_dot2_f32_bf16 v13, v154, s72, v13
    v_dot2_f32_bf16 v14, v155, s71, v14
    v_dot2_f32_bf16 v15, v155, s72, v15
    s_waitcnt vmcnt(8)
    v_dot2_f32_bf16 v8, v156, s71, v8
    v_dot2_f32_bf16 v9, v156, s72, v9
    v_dot2_f32_bf16 v10, v157, s71, v10
    v_dot2_f32_bf16 v11, v157, s72, v11
    v_dot2_f32_bf16 v12, v158, s71, v12
    v_dot2_f32_bf16 v13, v158, s72, v13
    v_dot2_f32_bf16 v14, v159, s71, v14
    v_dot2_f32_bf16 v15, v159, s72, v15
    s_waitcnt vmcnt(7)
    v_dot2_f32_bf16 v8, v160, s71, v8
    v_dot2_f32_bf16 v9, v160, s72, v9
    v_dot2_f32_bf16 v10, v161, s71, v10
    v_dot2_f32_bf16 v11, v161, s72, v11
    v_dot2_f32_bf16 v12, v162, s71, v12
    v_dot2_f32_bf16 v13, v162, s72, v13
    v_dot2_f32_bf16 v14, v163, s71, v14
    v_dot2_f32_bf16 v15, v163, s72, v15
    s_waitcnt vmcnt(6)
    v_dot2_f32_bf16 v8, v164, s71, v8
    v_dot2_f32_bf16 v9, v164, s72, v9
    v_dot2_f32_bf16 v10, v165, s71, v10
    v_dot2_f32_bf16 v11, v165, s72, v11
    v_dot2_f32_bf16 v12, v166, s71, v12
    v_dot2_f32_bf16 v13, v166, s72, v13
    v_dot2_f32_bf16 v14, v167, s71, v14
    v_dot2_f32_bf16 v15, v167, s72, v15
    s_waitcnt vmcnt(5)
    v_dot2_f32_bf16 v8, v168, s71, v8
    v_dot2_f32_bf16 v9, v168, s72, v9
    v_dot2_f32_bf16 v10, v169, s71, v10
    v_dot2_f32_bf16 v11, v169, s72, v11
    v_dot2_f32_bf16 v12, v170, s71, v12
    v_dot2_f32_bf16 v13, v170, s72, v13
    v_dot2_f32_bf16 v14, v171, s71, v14
    v_dot2_f32_bf16 v15, v171, s72, v15
    s_waitcnt vmcnt(4)
    v_dot2_f32_bf16 v8, v172, s71, v8
    v_dot2_f32_bf16 v9, v172, s72, v9
    v_dot2_f32_bf16 v10, v173, s71, v10
    v_dot2_f32_bf16 v11, v173, s72, v11
    v_dot2_f32_bf16 v12, v174, s71, v12
    v_dot2_f32_bf16 v13, v174, s72, v13
    v_dot2_f32_bf16 v14, v175, s71, v14
    v_dot2_f32_bf16 v15, v175, s72, v15
    s_waitcnt vmcnt(3)
    v_dot2_f32_bf16 v8, v176, s71, v8
    v_dot2_f32_bf16 v9, v176, s72, v9
    v_dot2_f32_bf16 v10, v177, s71, v10
    v_dot2_f32_bf16 v11, v177, s72, v11
    v_dot2_f32_bf16 v12, v178, s71, v12
    v_dot2_f32_bf16 v13, v178, s72, v13
    v_dot2_f32_bf16 v14, v179, s71, v14
    v_dot2_f32_bf16 v15, v179, s72, v15
    s_waitcnt vmcnt(2)
    v_dot2_f32_bf16 v8, v180, s71, v8
    v_dot2_f32_bf16 v9, v180, s72, v9
    v_dot2_f32_bf16 v10, v181, s71, v10
    v_dot2_f32_bf16 v11, v181, s72, v11
    v_dot2_f32_bf16 v12, v182, s71, v12
    v_dot2_f32_bf16 v13, v182, s72, v13
    v_dot2_f32_bf16 v14, v183, s71, v14
    v_dot2_f32_bf16 v15, v183, s72, v15
    s_waitcnt vmcnt(1)
    v_dot2_f32_bf16 v8, v184, s71, v8
    v_dot2_f32_bf16 v9, v184, s72, v9
    v_dot2_f32_bf16 v10, v185, s71, v10
    v_dot2_f32_bf16 v11, v185, s72, v11
    v_dot2_f32_bf16 v12, v186, s71, v12
    v_dot2_f32_bf16 v13, v186, s72, v13
    v_dot2_f32_bf16 v14, v187, s71, v14
    v_dot2_f32_bf16 v15, v187, s72, v15
    s_waitcnt vmcnt(0)
    v_dot2_f32_bf16 v8, v188, s71, v8
    v_dot2_f32_bf16 v9, v188, s72, v9
    v_dot2_f32_bf16 v10, v189, s71, v10
    v_dot2_f32_bf16 v11, v189, s72, v11
    v_dot2_f32_bf16 v12, v190, s71, v12
    v_dot2_f32_bf16 v13, v190, s72, v13
    v_dot2_f32_bf16 v14, v191, s71, v14
    v_dot2_f32_bf16 v15, v191, s72, v15
    v_cvt_pk_bf16_f32 v16, v8, v9
    v_cvt_pk_bf16_f32 v17, v10, v11
    v_cvt_pk_bf16_f32 v18, v12, v13
    v_cvt_pk_bf16_f32 v19, v14, v15
    ds_write_b128 v3, v[16:19]
    s_waitcnt lgkmcnt(0)
    s_barrier
    ds_read_b128 v[128:131], v6 offset:0
    ds_read_b128 v[148:151], v7 offset:0
    ds_read_b128 v[132:135], v6 offset:16
    ds_read_b128 v[152:155], v7 offset:16
    ds_read_b128 v[136:139], v6 offset:32
    ds_read_b128 v[156:159], v7 offset:32
    ds_read_b128 v[140:143], v6 offset:48
    ds_read_b128 v[160:163], v7 offset:48
    ds_read_b128 v[144:147], v6 offset:64
    ds_read_b128 v[164:167], v7 offset:64
    s_waitcnt lgkmcnt(8)
    v_mfma_f32_32x32x16_bf16 v[192:207], v[128:131], v[224:227], 0
    v_mfma_f32_32x32x16_bf16 v[208:223], v[148:151], v[224:227], 0
    s_waitcnt lgkmcnt(6)
    v_mfma_f32_32x32x16_bf16 v[192:207], v[132:135], v[228:231], v[192:207]
    v_mfma_f32_32x32x16_bf16 v[208:223], v[152:155], v[228:231], v[208:223]
    s_waitcnt lgkmcnt(4)
    v_mfma_f32_32x32x16_bf16 v[192:207], v[136:139], v[232:235], v[192:207]
    v_mfma_f32_32x32x16_bf16 v[208:223], v[156:159], v[232:235], v[208:223]
    s_waitcnt lgkmcnt(2)
    v_mfma_f32_32x32x16_bf16 v[192:207], v[140:143], v[236:239], v[192:207]
    v_mfma_f32_32x32x16_bf16 v[208:223], v[160:163], v[236:239], v[208:223]
    s_waitcnt lgkmcnt(0)
    v_mfma_f32_32x32x16_bf16 v[192:207], v[144:147], v[240:243], v[192:207]
    v_mfma_f32_32x32x16_bf16 v[208:223], v[164:167], v[240:243], v[208:223]
    s_nop 11
    v_add_f32 v8, 0x358637bd, v212
    v_rcp_f32 v8, v8
    s_nop 0
    v_mov_b32 v9, v8
    v_pk_mul_f32 v[192:193], v[192:193], v[8:9]
    v_pk_mul_f32 v[194:195], v[194:195], v[8:9]
    v_pk_mul_f32 v[196:197], v[196:197], v[8:9]
    v_pk_mul_f32 v[198:199], v[198:199], v[8:9]
    v_pk_mul_f32 v[200:201], v[200:201], v[8:9]
    v_pk_mul_f32 v[202:203], v[202:203], v[8:9]
    v_pk_mul_f32 v[204:205], v[204:205], v[8:9]
    v_pk_mul_f32 v[206:207], v[206:207], v[8:9]
    v_pk_mul_f32 v[208:209], v[208:209], v[8:9]
    v_pk_mul_f32 v[210:211], v[210:211], v[8:9]
    v_cvt_pk_bf16_f32 v12, v192, v193
    v_cvt_pk_bf16_f32 v13, v194, v195
    v_cvt_pk_bf16_f32 v14, v196, v197
    v_cvt_pk_bf16_f32 v15, v198, v199
    v_cvt_pk_bf16_f32 v16, v200, v201
    v_cvt_pk_bf16_f32 v17, v202, v203
    v_cvt_pk_bf16_f32 v18, v204, v205
    v_cvt_pk_bf16_f32 v19, v206, v207
    v_cvt_pk_bf16_f32 v20, v208, v209
    v_cvt_pk_bf16_f32 v21, v210, v211
    buffer_store_dwordx4 v[12:15], v36, s[48:51], s94 offen sc1
    buffer_store_dwordx4 v[16:19], v36, s[48:51], s94 offen offset:256 sc1
    buffer_store_dwordx2 v[20:21], v37, s[48:51], s94 offen sc1
    s_add_u32 s79, s59, 8
    s_mul_i32 s78, s79, 5120
    s_lshr_b32 s77, s58, 1
    s_mul_i32 s77, s77, 102400
    s_add_u32 s77, s77, s78
    s_add_u32 s77, s77, 21045248
    s_mov_b32 m0, s78
    s_nop 0
    buffer_load_dwordx4 v39, s[48:51], s77 offen offset:0 sc1 lds
    buffer_load_dwordx4 v39, s[48:51], s77 offen offset:1024 sc1 lds
    buffer_load_dwordx4 v39, s[48:51], s77 offen offset:2048 sc1 lds
    buffer_load_dwordx4 v39, s[48:51], s77 offen offset:3072 sc1 lds
    s_add_u32 m0, s78, 4096
    s_add_u32 s77, s77, 4096
    buffer_load_dwordx4 v39, s[48:51], s77 offen sc1 lds
    s_waitcnt vmcnt(5)
    s_barrier
    s_cmp_lg_u32 s59, 0
    s_cbranch_scc1 L_SF4069
    s_lshl_b32 s70, s57, 7
    s_lshl_b32 s71, s58, 2
    s_add_u32 s70, s70, s71
    s_add_u32 s70, s70, 4096
    v_mov_b32 v248, s56
    v_mov_b32 v249, 0
    s_mov_b64 exec, 1
    buffer_store_dword v248, v249, s[48:51], s70 offen sc1
    s_mov_b64 exec, -1
L_SF4069:
    s_cmp_eq_u32 s59, 0
    s_cbranch_scc1 L_WO4081
    s_add_u32 s79, s59, 11
    s_min_u32 s79, s79, 19
    s_mul_i32 s78, s79, 5120
    s_lshr_b32 s77, s58, 1
    s_mul_i32 s77, s77, 102400
    s_add_u32 s77, s77, s78
    s_add_u32 s77, s77, 21045248
    s_mov_b32 m0, s78
    s_nop 0
    buffer_load_dwordx4 v39, s[48:51], s77 offen offset:0 sc1 lds
    buffer_load_dwordx4 v39, s[48:51], s77 offen offset:1024 sc1 lds
    buffer_load_dwordx4 v39, s[48:51], s77 offen offset:2048 sc1 lds
    buffer_load_dwordx4 v39, s[48:51], s77 offen offset:3072 sc1 lds
    s_add_u32 m0, s78, 4096
    s_add_u32 s77, s77, 4096
    buffer_load_dwordx4 v39, s[48:51], s77 offen sc1 lds
    s_add_u32 s79, s59, 14
    s_min_u32 s79, s79, 19
    s_mul_i32 s78, s79, 5120
    s_lshr_b32 s77, s58, 1
    s_mul_i32 s77, s77, 102400
    s_add_u32 s77, s77, s78
    s_add_u32 s77, s77, 21045248
    s_mov_b32 m0, s78
    s_nop 0
    buffer_load_dwordx4 v39, s[48:51], s77 offen offset:0 sc1 lds
    buffer_load_dwordx4 v39, s[48:51], s77 offen offset:1024 sc1 lds
    buffer_load_dwordx4 v39, s[48:51], s77 offen offset:2048 sc1 lds
    buffer_load_dwordx4 v39, s[48:51], s77 offen offset:3072 sc1 lds
    s_add_u32 m0, s78, 4096
    s_add_u32 s77, s77, 4096
    buffer_load_dwordx4 v39, s[48:51], s77 offen sc1 lds
    s_add_u32 s79, s59, 17
    s_min_u32 s79, s79, 19
    s_mul_i32 s78, s79, 5120
    s_lshr_b32 s77, s58, 1
    s_mul_i32 s77, s77, 102400
    s_add_u32 s77, s77, s78
    s_add_u32 s77, s77, 21045248
    s_mov_b32 m0, s78
    s_nop 0
    buffer_load_dwordx4 v39, s[48:51], s77 offen offset:0 sc1 lds
    buffer_load_dwordx4 v39, s[48:51], s77 offen offset:1024 sc1 lds
    buffer_load_dwordx4 v39, s[48:51], s77 offen offset:2048 sc1 lds
    buffer_load_dwordx4 v39, s[48:51], s77 offen offset:3072 sc1 lds
    s_add_u32 m0, s78, 4096
    s_add_u32 s77, s77, 4096
    buffer_load_dwordx4 v39, s[48:51], s77 offen sc1 lds
L_WO4081:
    v_lshrrev_b32 v2, 4, v1
    v_bfe_u32 v3, v1, 2, 2
    v_lshl_add_u32 v2, v2, 2, v3
    v_mul_u32_u24 v2, 160, v2
    v_and_b32 v3, 3, v1
    v_lshl_add_u32 v36, v3, 3, v2
    s_mul_i32 s70, s63, 51200
    v_add_u32 v36, s70, v36
    v_lshlrev_b32 v39, 4, v1
    v_lshrrev_b32 v3, 4, v1
    v_lshlrev_b32 v3, 4, v3
    s_mul_i32 s71, s64, 320
    v_add_u32 v37, s71, v3
    v_lshlrev_b32 v35, 4, v0
    v_cmp_gt_u32 vcc, 160, v0
    v_mov_b32 v3, 2147418112
    s_nop 0
    v_cndmask_b32 v35, v3, v35, vcc
    v_lshrrev_b32 v34, 4, v1
    v_lshlrev_b32 v34, 3, v34
    s_lshl_b32 s76, s66, 5
    v_add_u32 v2, 0, v1
    v_mul_u32_u24 v3, 4682, v2
    v_lshrrev_b32 v3, 16, v3
    v_mul_u32_u24 v4, 14, v3
    v_sub_u32 v4, v2, v4
    v_mul_u32_u24 v3, 3456, v3
    v_lshl_add_u32 v3, v4, 4, v3
    v_add_u32 v200, s76, v3
    v_add_u32 v2, 64, v1
    v_mul_u32_u24 v3, 4682, v2
    v_lshrrev_b32 v3, 16, v3
    v_mul_u32_u24 v4, 14, v3
    v_sub_u32 v4, v2, v4
    v_mul_u32_u24 v3, 3456, v3
    v_lshl_add_u32 v3, v4, 4, v3
    v_add_u32 v201, s76, v3
    v_add_u32 v2, 128, v1
    v_mul_u32_u24 v3, 4682, v2
    v_lshrrev_b32 v3, 16, v3
    v_mul_u32_u24 v4, 14, v3
    v_sub_u32 v4, v2, v4
    v_mul_u32_u24 v3, 3456, v3
    v_lshl_add_u32 v3, v4, 4, v3
    v_add_u32 v202, s76, v3
    v_add_u32 v2, 192, v1
    v_mul_u32_u24 v3, 4682, v2
    v_lshrrev_b32 v3, 16, v3
    v_mul_u32_u24 v4, 14, v3
    v_sub_u32 v4, v2, v4
    v_mul_u32_u24 v3, 3456, v3
    v_lshl_add_u32 v3, v4, 4, v3
    v_add_u32 v203, s76, v3
    v_add_u32 v2, 256, v1
    v_mul_u32_u24 v3, 4682, v2
    v_lshrrev_b32 v3, 16, v3
    v_mul_u32_u24 v4, 14, v3
    v_sub_u32 v4, v2, v4
    v_mul_u32_u24 v3, 3456, v3
    v_lshl_add_u32 v3, v4, 4, v3
    v_add_u32 v204, s76, v3
    v_add_u32 v2, 320, v1
    v_mul_u32_u24 v3, 4682, v2
    v_lshrrev_b32 v3, 16, v3
    v_mul_u32_u24 v4, 14, v3
    v_sub_u32 v4, v2, v4
    v_mul_u32_u24 v3, 3456, v3
    v_lshl_add_u32 v3, v4, 4, v3
    v_add_u32 v205, s76, v3
    v_add_u32 v2, 384, v1
    v_mul_u32_u24 v3, 4682, v2
    v_lshrrev_b32 v3, 16, v3
    v_mul_u32_u24 v4, 14, v3
    v_sub_u32 v4, v2, v4
    v_mul_u32_u24 v3, 3456, v3
    v_lshl_add_u32 v3, v4, 4, v3
    v_add_u32 v206, s76, v3
    v_and_b32 v2, 15, v1
    v_lshlrev_b32 v2, 3, v2
    v_cmp_gt_u32 vcc, 16, v1
    v_mov_b32 v3, 2147418112
    s_nop 0
    v_cndmask_b32 v33, v3, v2, vcc
    v_lshlrev_b32 v32, 3, v0
    v_add_u32 v32, 143360, v32
    s_lshl_b32 s70, s65, 3
    s_add_u32 s70, s70, s64
    s_lshl_b32 s70, s70, 7
    s_add_u32 s84, s70, 385024
    s_mul_i32 s70, s64, 5
    s_lshr_b32 s70, s70, 1
    s_lshl_b32 s70, s70, 10
    s_mul_i32 s71, s65, 20480
    s_add_u32 s70, s70, s71
    s_add_u32 s85, s70, 9134080
    s_mul_i32 s70, s63, 10240
    s_add_u32 s70, s70, 6512640
    s_mul_i32 s72, s65, 20480
    s_add_u32 s72, s72, s70
    s_xor_b32 s73, s65, 1
    s_mul_i32 s73, s73, 20480
    s_add_u32 s73, s73, s70
    s_mov_b32 s86, 29696
    s_mov_b32 s87, 34816
    s_mov_b32 s88, 32256
    s_lshl_b32 s70, s66, 5
    s_lshl_b32 s71, s59, 5
    s_add_u32 s89, s71, s70
    s_add_u32 s75, s59, 4
    s_min_u32 s75, s75, 6
    s_lshl_b32 s71, s75, 5
    s_add_u32 s90, s71, s70
    s_cmp_eq_u32 s59, 0
    s_cbranch_scc1 L_W1A4242
    s_add_u32 s79, s59, 14
    s_min_u32 s79, s79, 19
    s_mul_i32 s77, s79, 110592
    s_mul_i32 s78, s79, 7168
    s_add_u32 m0, s78, 0
    s_nop 0
    buffer_load_dwordx4 v200, s[20:23], s77 offen lds
    s_add_u32 m0, s78, 1024
    s_nop 0
    buffer_load_dwordx4 v201, s[20:23], s77 offen lds
    s_add_u32 m0, s78, 2048
    s_nop 0
    buffer_load_dwordx4 v202, s[20:23], s77 offen lds
    s_add_u32 m0, s78, 3072
    s_nop 0
    buffer_load_dwordx4 v203, s[20:23], s77 offen lds
    s_add_u32 m0, s78, 4096
    s_nop 0
    buffer_load_dwordx4 v204, s[20:23], s77 offen lds
    s_add_u32 m0, s78, 5120
    s_nop 0
    buffer_load_dwordx4 v205, s[20:23], s77 offen lds
    s_add_u32 m0, s78, 6144
    s_nop 0
    buffer_load_dwordx4 v206, s[20:23], s77 offen lds
    s_add_u32 s79, s59, 17
    s_min_u32 s79, s79, 19
    s_mul_i32 s77, s79, 110592
    s_mul_i32 s78, s79, 7168
    s_add_u32 m0, s78, 0
    s_nop 0
    buffer_load_dwordx4 v200, s[20:23], s77 offen lds
    s_add_u32 m0, s78, 1024
    s_nop 0
    buffer_load_dwordx4 v201, s[20:23], s77 offen lds
    s_add_u32 m0, s78, 2048
    s_nop 0
    buffer_load_dwordx4 v202, s[20:23], s77 offen lds
    s_add_u32 m0, s78, 3072
    s_nop 0
    buffer_load_dwordx4 v203, s[20:23], s77 offen lds
    s_add_u32 m0, s78, 4096
    s_nop 0
    buffer_load_dwordx4 v204, s[20:23], s77 offen lds
    s_add_u32 m0, s78, 5120
    s_nop 0
    buffer_load_dwordx4 v205, s[20:23], s77 offen lds
    s_add_u32 m0, s78, 6144
    s_nop 0
    buffer_load_dwordx4 v206, s[20:23], s77 offen lds
L_W1A4242:
    s_cmp_lg_u32 s59, 0
    s_cbranch_scc1 L_PD4295
    s_lshl_b32 s70, s60, 10
    s_add_u32 s70, s70, 16384
    s_mov_b32 s71, 1048576
    v_min_u32 v248, 39, v1
    v_lshlrev_b32 v248, 4, v248
L_PL4295:
    buffer_load_dwordx4 v[250:253], v248, s[48:51], s70 offen sc1
    s_waitcnt vmcnt(0)
    v_xor_b32 v250, s56, v250
    v_xor_b32 v251, s56, v251
    v_xor_b32 v252, s56, v252
    v_xor_b32 v253, s56, v253
    v_or_b32 v250, v250, v251
    v_or_b32 v252, v252, v253
    v_or_b32 v250, v250, v252
    v_cmp_ne_u32 vcc, 0, v250
    s_sub_u32 s71, s71, 1
    s_cmp_eq_u32 s71, 0
    s_cbranch_scc1 L_PT4295
    s_cbranch_vccnz L_PL4295
    s_branch L_PD4295
L_PT4295:
    v_mov_b32 v250, 193
    v_mov_b32 v251, 0
    buffer_store_dword v250, v251, s[52:55], 0 offen
    s_waitcnt vmcnt(0)
L_PD4295:
    s_cmp_lg_u32 s59, 0
    s_cbranch_scc1 L_PD4324
    s_lshl_b32 s70, s57, 7
    s_add_u32 s70, s70, 4096
    s_mov_b32 s71, 1048576
    v_min_u32 v248, 15, v1
    v_lshlrev_b32 v248, 2, v248
L_PL4324:
    buffer_load_dword v250, v248, s[48:51], s70 offen sc1
    s_waitcnt vmcnt(0)
    v_cmp_ne_u32 vcc, s56, v250
    s_sub_u32 s71, s71, 1
    s_cmp_eq_u32 s71, 0
    s_cbranch_scc1 L_PT4324
    s_cbranch_vccnz L_PL4324
    s_branch L_PD4324
L_PT4324:
    v_mov_b32 v250, 192
    v_mov_b32 v251, 0
    buffer_store_dword v250, v251, s[52:55], 0 offen
    s_waitcnt vmcnt(0)
L_PD4324:
    s_barrier
    buffer_load_dwordx4 a[0:3], v39, s[48:51], s72 offen offset:0 sc1
    buffer_load_dwordx4 a[4:7], v39, s[48:51], s73 offen offset:0 sc1
    buffer_load_dwordx4 a[8:11], v39, s[48:51], s72 offen offset:1024 sc1
    buffer_load_dwordx4 a[12:15], v39, s[48:51], s73 offen offset:1024 sc1
    buffer_load_dwordx4 a[16:19], v39, s[48:51], s72 offen offset:2048 sc1
    buffer_load_dwordx4 a[20:23], v39, s[48:51], s73 offen offset:2048 sc1
    buffer_load_dwordx4 a[24:27], v39, s[48:51], s72 offen offset:3072 sc1
    buffer_load_dwordx4 a[28:31], v39, s[48:51], s73 offen offset:3072 sc1
    s_add_u32 s72, s72, 4096
    s_add_u32 s73, s73, 4096
    s_waitcnt vmcnt(6)
    s_barrier
    ds_read_b64_tr_b16 v[40:41], v36 offset:0
    ds_read_b64_tr_b16 v[42:43], v36 offset:2560
    ds_read_b64_tr_b16 v[44:45], v36 offset:32
    ds_read_b64_tr_b16 v[46:47], v36 offset:2592
    ds_read_b64_tr_b16 v[48:49], v36 offset:64
    ds_read_b64_tr_b16 v[50:51], v36 offset:2624
    ds_read_b64_tr_b16 v[52:53], v36 offset:96
    ds_read_b64_tr_b16 v[54:55], v36 offset:2656
    ds_read_b64_tr_b16 v[56:57], v36 offset:128
    ds_read_b64_tr_b16 v[58:59], v36 offset:2688
    s_waitcnt lgkmcnt(6)
    v_mfma_f32_16x16x32_bf16 v[128:131], v[40:43], a[0:3], 0
    ds_read_b64_tr_b16 v[60:61], v36 offset:5120
    v_mfma_f32_16x16x32_bf16 v[132:135], v[40:43], a[4:7], 0
    ds_read_b64_tr_b16 v[62:63], v36 offset:7680
    buffer_load_dwordx4 a[32:35], v39, s[48:51], s72 offen offset:0 sc1
    v_mfma_f32_16x16x32_bf16 v[136:139], v[44:47], a[0:3], 0
    ds_read_b64_tr_b16 v[64:65], v36 offset:5152
    v_mfma_f32_16x16x32_bf16 v[140:143], v[44:47], a[4:7], 0
    ds_read_b64_tr_b16 v[66:67], v36 offset:7712
    buffer_load_dwordx4 a[36:39], v39, s[48:51], s73 offen offset:0 sc1
    s_waitcnt lgkmcnt(4)
    v_mfma_f32_16x16x32_bf16 v[144:147], v[48:51], a[0:3], 0
    ds_read_b64_tr_b16 v[68:69], v36 offset:5184
    v_mfma_f32_16x16x32_bf16 v[148:151], v[48:51], a[4:7], 0
    ds_read_b64_tr_b16 v[70:71], v36 offset:7744
    v_mfma_f32_16x16x32_bf16 v[152:155], v[52:55], a[0:3], 0
    ds_read_b64_tr_b16 v[72:73], v36 offset:5216
    v_mfma_f32_16x16x32_bf16 v[156:159], v[52:55], a[4:7], 0
    ds_read_b64_tr_b16 v[74:75], v36 offset:7776
    v_mfma_f32_16x16x32_bf16 v[160:163], v[56:59], a[0:3], 0
    ds_read_b64_tr_b16 v[76:77], v36 offset:5248
    v_mfma_f32_16x16x32_bf16 v[164:167], v[56:59], a[4:7], 0
    ds_read_b64_tr_b16 v[78:79], v36 offset:7808
    s_waitcnt vmcnt(6)
    s_waitcnt lgkmcnt(6)
    v_mfma_f32_16x16x32_bf16 v[128:131], v[60:63], a[8:11], v[128:131]
    ds_read_b64_tr_b16 v[40:41], v36 offset:10240
    v_mfma_f32_16x16x32_bf16 v[132:135], v[60:63], a[12:15], v[132:135]
    ds_read_b64_tr_b16 v[42:43], v36 offset:12800
    buffer_load_dwordx4 a[40:43], v39, s[48:51], s72 offen offset:1024 sc1
    v_mfma_f32_16x16x32_bf16 v[136:139], v[64:67], a[8:11], v[136:139]
    ds_read_b64_tr_b16 v[44:45], v36 offset:10272
    v_mfma_f32_16x16x32_bf16 v[140:143], v[64:67], a[12:15], v[140:143]
    ds_read_b64_tr_b16 v[46:47], v36 offset:12832
    buffer_load_dwordx4 a[44:47], v39, s[48:51], s73 offen offset:1024 sc1
    s_waitcnt lgkmcnt(4)
    v_mfma_f32_16x16x32_bf16 v[144:147], v[68:71], a[8:11], v[144:147]
    ds_read_b64_tr_b16 v[48:49], v36 offset:10304
    v_mfma_f32_16x16x32_bf16 v[148:151], v[68:71], a[12:15], v[148:151]
    ds_read_b64_tr_b16 v[50:51], v36 offset:12864
    v_mfma_f32_16x16x32_bf16 v[152:155], v[72:75], a[8:11], v[152:155]
    ds_read_b64_tr_b16 v[52:53], v36 offset:10336
    v_mfma_f32_16x16x32_bf16 v[156:159], v[72:75], a[12:15], v[156:159]
    ds_read_b64_tr_b16 v[54:55], v36 offset:12896
    v_mfma_f32_16x16x32_bf16 v[160:163], v[76:79], a[8:11], v[160:163]
    ds_read_b64_tr_b16 v[56:57], v36 offset:10368
    v_mfma_f32_16x16x32_bf16 v[164:167], v[76:79], a[12:15], v[164:167]
    ds_read_b64_tr_b16 v[58:59], v36 offset:12928
    s_waitcnt vmcnt(6)
    s_waitcnt lgkmcnt(6)
    v_mfma_f32_16x16x32_bf16 v[128:131], v[40:43], a[16:19], v[128:131]
    ds_read_b64_tr_b16 v[60:61], v36 offset:15360
    v_mfma_f32_16x16x32_bf16 v[132:135], v[40:43], a[20:23], v[132:135]
    ds_read_b64_tr_b16 v[62:63], v36 offset:17920
    buffer_load_dwordx4 a[48:51], v39, s[48:51], s72 offen offset:2048 sc1
    v_mfma_f32_16x16x32_bf16 v[136:139], v[44:47], a[16:19], v[136:139]
    ds_read_b64_tr_b16 v[64:65], v36 offset:15392
    v_mfma_f32_16x16x32_bf16 v[140:143], v[44:47], a[20:23], v[140:143]
    ds_read_b64_tr_b16 v[66:67], v36 offset:17952
    buffer_load_dwordx4 a[52:55], v39, s[48:51], s73 offen offset:2048 sc1
    s_waitcnt lgkmcnt(4)
    v_mfma_f32_16x16x32_bf16 v[144:147], v[48:51], a[16:19], v[144:147]
    ds_read_b64_tr_b16 v[68:69], v36 offset:15424
    v_mfma_f32_16x16x32_bf16 v[148:151], v[48:51], a[20:23], v[148:151]
    ds_read_b64_tr_b16 v[70:71], v36 offset:17984
    v_mfma_f32_16x16x32_bf16 v[152:155], v[52:55], a[16:19], v[152:155]
    ds_read_b64_tr_b16 v[72:73], v36 offset:15456
    v_mfma_f32_16x16x32_bf16 v[156:159], v[52:55], a[20:23], v[156:159]
    ds_read_b64_tr_b16 v[74:75], v36 offset:18016
    v_mfma_f32_16x16x32_bf16 v[160:163], v[56:59], a[16:19], v[160:163]
    ds_read_b64_tr_b16 v[76:77], v36 offset:15488
    v_mfma_f32_16x16x32_bf16 v[164:167], v[56:59], a[20:23], v[164:167]
    ds_read_b64_tr_b16 v[78:79], v36 offset:18048
    s_waitcnt vmcnt(6)
    s_waitcnt lgkmcnt(6)
    v_mfma_f32_16x16x32_bf16 v[128:131], v[60:63], a[24:27], v[128:131]
    ds_read_b64_tr_b16 v[40:41], v36 offset:20480
    v_mfma_f32_16x16x32_bf16 v[132:135], v[60:63], a[28:31], v[132:135]
    ds_read_b64_tr_b16 v[42:43], v36 offset:23040
    buffer_load_dwordx4 a[56:59], v39, s[48:51], s72 offen offset:3072 sc1
    v_mfma_f32_16x16x32_bf16 v[136:139], v[64:67], a[24:27], v[136:139]
    ds_read_b64_tr_b16 v[44:45], v36 offset:20512
    v_mfma_f32_16x16x32_bf16 v[140:143], v[64:67], a[28:31], v[140:143]
    ds_read_b64_tr_b16 v[46:47], v36 offset:23072
    buffer_load_dwordx4 a[60:63], v39, s[48:51], s73 offen offset:3072 sc1
    s_add_u32 s72, s72, 4096
    s_add_u32 s73, s73, 4096
    s_waitcnt lgkmcnt(4)
    v_mfma_f32_16x16x32_bf16 v[144:147], v[68:71], a[24:27], v[144:147]
    ds_read_b64_tr_b16 v[48:49], v36 offset:20544
    v_mfma_f32_16x16x32_bf16 v[148:151], v[68:71], a[28:31], v[148:151]
    ds_read_b64_tr_b16 v[50:51], v36 offset:23104
    v_mfma_f32_16x16x32_bf16 v[152:155], v[72:75], a[24:27], v[152:155]
    ds_read_b64_tr_b16 v[52:53], v36 offset:20576
    v_mfma_f32_16x16x32_bf16 v[156:159], v[72:75], a[28:31], v[156:159]
    ds_read_b64_tr_b16 v[54:55], v36 offset:23136
    v_mfma_f32_16x16x32_bf16 v[160:163], v[76:79], a[24:27], v[160:163]
    ds_read_b64_tr_b16 v[56:57], v36 offset:20608
    v_mfma_f32_16x16x32_bf16 v[164:167], v[76:79], a[28:31], v[164:167]
    ds_read_b64_tr_b16 v[58:59], v36 offset:23168
    s_waitcnt vmcnt(6)
    s_waitcnt lgkmcnt(6)
    v_mfma_f32_16x16x32_bf16 v[128:131], v[40:43], a[32:35], v[128:131]
    ds_read_b64_tr_b16 v[60:61], v36 offset:25600
    v_mfma_f32_16x16x32_bf16 v[132:135], v[40:43], a[36:39], v[132:135]
    ds_read_b64_tr_b16 v[62:63], v36 offset:28160
    buffer_load_dwordx4 a[64:67], v39, s[48:51], s72 offen offset:0 sc1
    v_mfma_f32_16x16x32_bf16 v[136:139], v[44:47], a[32:35], v[136:139]
    ds_read_b64_tr_b16 v[64:65], v36 offset:25632
    v_mfma_f32_16x16x32_bf16 v[140:143], v[44:47], a[36:39], v[140:143]
    ds_read_b64_tr_b16 v[66:67], v36 offset:28192
    buffer_load_dwordx4 a[68:71], v39, s[48:51], s73 offen offset:0 sc1
    s_waitcnt lgkmcnt(4)
    v_mfma_f32_16x16x32_bf16 v[144:147], v[48:51], a[32:35], v[144:147]
    ds_read_b64_tr_b16 v[68:69], v36 offset:25664
    v_mfma_f32_16x16x32_bf16 v[148:151], v[48:51], a[36:39], v[148:151]
    ds_read_b64_tr_b16 v[70:71], v36 offset:28224
    v_mfma_f32_16x16x32_bf16 v[152:155], v[52:55], a[32:35], v[152:155]
    ds_read_b64_tr_b16 v[72:73], v36 offset:25696
    v_mfma_f32_16x16x32_bf16 v[156:159], v[52:55], a[36:39], v[156:159]
    ds_read_b64_tr_b16 v[74:75], v36 offset:28256
    v_mfma_f32_16x16x32_bf16 v[160:163], v[56:59], a[32:35], v[160:163]
    ds_read_b64_tr_b16 v[76:77], v36 offset:25728
    v_mfma_f32_16x16x32_bf16 v[164:167], v[56:59], a[36:39], v[164:167]
    ds_read_b64_tr_b16 v[78:79], v36 offset:28288
    s_waitcnt vmcnt(6)
    s_waitcnt lgkmcnt(6)
    v_mfma_f32_16x16x32_bf16 v[128:131], v[60:63], a[40:43], v[128:131]
    ds_read_b64_tr_b16 v[40:41], v36 offset:30720
    v_mfma_f32_16x16x32_bf16 v[132:135], v[60:63], a[44:47], v[132:135]
    ds_read_b64_tr_b16 v[42:43], v36 offset:33280
    buffer_load_dwordx4 a[72:75], v39, s[48:51], s72 offen offset:1024 sc1
    s_branch L_PSK7
L_PAD7:
    s_setpc_b64 s[100:101]
L_PSK7:
    v_mfma_f32_16x16x32_bf16 v[136:139], v[64:67], a[40:43], v[136:139]
    ds_read_b64_tr_b16 v[44:45], v36 offset:30752
    v_mfma_f32_16x16x32_bf16 v[140:143], v[64:67], a[44:47], v[140:143]
    ds_read_b64_tr_b16 v[46:47], v36 offset:33312
    buffer_load_dwordx4 a[76:79], v39, s[48:51], s73 offen offset:1024 sc1
    s_waitcnt lgkmcnt(4)
    v_mfma_f32_16x16x32_bf16 v[144:147], v[68:71], a[40:43], v[144:147]
    ds_read_b64_tr_b16 v[48:49], v36 offset:30784
    v_mfma_f32_16x16x32_bf16 v[148:151], v[68:71], a[44:47], v[148:151]
    ds_read_b64_tr_b16 v[50:51], v36 offset:33344
    buffer_load_dwordx4 v[80:83], v37, s[48:51], s86 offen offset:0 sc1
    v_mfma_f32_16x16x32_bf16 v[152:155], v[72:75], a[40:43], v[152:155]
    ds_read_b64_tr_b16 v[52:53], v36 offset:30816
    v_mfma_f32_16x16x32_bf16 v[156:159], v[72:75], a[44:47], v[156:159]
    ds_read_b64_tr_b16 v[54:55], v36 offset:33376
    buffer_load_dwordx4 v[100:103], v37, s[48:51], s87 offen offset:0 sc1
    v_mfma_f32_16x16x32_bf16 v[160:163], v[76:79], a[40:43], v[160:163]
    ds_read_b64_tr_b16 v[56:57], v36 offset:30848
    v_mfma_f32_16x16x32_bf16 v[164:167], v[76:79], a[44:47], v[164:167]
    ds_read_b64_tr_b16 v[58:59], v36 offset:33408
    buffer_load_dwordx4 v[84:87], v37, s[48:51], s86 offen offset:64 sc1
    s_waitcnt vmcnt(9)
    s_waitcnt lgkmcnt(6)
    v_mfma_f32_16x16x32_bf16 v[128:131], v[40:43], a[48:51], v[128:131]
    ds_read_b64_tr_b16 v[60:61], v36 offset:35840
    v_mfma_f32_16x16x32_bf16 v[132:135], v[40:43], a[52:55], v[132:135]
    ds_read_b64_tr_b16 v[62:63], v36 offset:38400
    buffer_load_dwordx4 v[104:107], v37, s[48:51], s87 offen offset:64 sc1
    v_mfma_f32_16x16x32_bf16 v[136:139], v[44:47], a[48:51], v[136:139]
    ds_read_b64_tr_b16 v[64:65], v36 offset:35872
    v_mfma_f32_16x16x32_bf16 v[140:143], v[44:47], a[52:55], v[140:143]
    ds_read_b64_tr_b16 v[66:67], v36 offset:38432
    buffer_load_dwordx4 v[88:91], v37, s[48:51], s86 offen offset:128 sc1
    s_waitcnt lgkmcnt(4)
    v_mfma_f32_16x16x32_bf16 v[144:147], v[48:51], a[48:51], v[144:147]
    ds_read_b64_tr_b16 v[68:69], v36 offset:35904
    v_mfma_f32_16x16x32_bf16 v[148:151], v[48:51], a[52:55], v[148:151]
    ds_read_b64_tr_b16 v[70:71], v36 offset:38464
    buffer_load_dwordx4 v[108:111], v37, s[48:51], s87 offen offset:128 sc1
    v_mfma_f32_16x16x32_bf16 v[152:155], v[52:55], a[48:51], v[152:155]
    ds_read_b64_tr_b16 v[72:73], v36 offset:35936
    v_mfma_f32_16x16x32_bf16 v[156:159], v[52:55], a[52:55], v[156:159]
    ds_read_b64_tr_b16 v[74:75], v36 offset:38496
    v_mfma_f32_16x16x32_bf16 v[160:163], v[56:59], a[48:51], v[160:163]
    ds_read_b64_tr_b16 v[76:77], v36 offset:35968
    v_mfma_f32_16x16x32_bf16 v[164:167], v[56:59], a[52:55], v[164:167]
    ds_read_b64_tr_b16 v[78:79], v36 offset:38528
    s_waitcnt vmcnt(10)
    s_waitcnt lgkmcnt(6)
    v_mfma_f32_16x16x32_bf16 v[128:131], v[60:63], a[56:59], v[128:131]
    ds_read_b64_tr_b16 v[40:41], v36 offset:40960
    v_mfma_f32_16x16x32_bf16 v[132:135], v[60:63], a[60:63], v[132:135]
    ds_read_b64_tr_b16 v[42:43], v36 offset:43520
    buffer_load_dwordx4 v[92:95], v37, s[48:51], s86 offen offset:192 sc1
    v_mfma_f32_16x16x32_bf16 v[136:139], v[64:67], a[56:59], v[136:139]
    ds_read_b64_tr_b16 v[44:45], v36 offset:40992
    v_mfma_f32_16x16x32_bf16 v[140:143], v[64:67], a[60:63], v[140:143]
    ds_read_b64_tr_b16 v[46:47], v36 offset:43552
    buffer_load_dwordx4 v[112:115], v37, s[48:51], s87 offen offset:192 sc1
    s_waitcnt lgkmcnt(4)
    v_mfma_f32_16x16x32_bf16 v[144:147], v[68:71], a[56:59], v[144:147]
    ds_read_b64_tr_b16 v[48:49], v36 offset:41024
    v_mfma_f32_16x16x32_bf16 v[148:151], v[68:71], a[60:63], v[148:151]
    ds_read_b64_tr_b16 v[50:51], v36 offset:43584
    buffer_load_dwordx4 v[96:99], v37, s[48:51], s86 offen offset:256 sc1
    v_mfma_f32_16x16x32_bf16 v[152:155], v[72:75], a[56:59], v[152:155]
    ds_read_b64_tr_b16 v[52:53], v36 offset:41056
    v_mfma_f32_16x16x32_bf16 v[156:159], v[72:75], a[60:63], v[156:159]
    ds_read_b64_tr_b16 v[54:55], v36 offset:43616
    v_mfma_f32_16x16x32_bf16 v[160:163], v[76:79], a[56:59], v[160:163]
    ds_read_b64_tr_b16 v[56:57], v36 offset:41088
    v_mfma_f32_16x16x32_bf16 v[164:167], v[76:79], a[60:63], v[164:167]
    ds_read_b64_tr_b16 v[58:59], v36 offset:43648
    s_waitcnt vmcnt(11)
    s_waitcnt lgkmcnt(6)
    v_mfma_f32_16x16x32_bf16 v[128:131], v[40:43], a[64:67], v[128:131]
    ds_read_b64_tr_b16 v[60:61], v36 offset:46080
    v_mfma_f32_16x16x32_bf16 v[132:135], v[40:43], a[68:71], v[132:135]
    ds_read_b64_tr_b16 v[62:63], v36 offset:48640
    buffer_load_dwordx4 v[116:119], v37, s[48:51], s87 offen offset:256 sc1
    v_mfma_f32_16x16x32_bf16 v[136:139], v[44:47], a[64:67], v[136:139]
    ds_read_b64_tr_b16 v[64:65], v36 offset:46112
    v_mfma_f32_16x16x32_bf16 v[140:143], v[44:47], a[68:71], v[140:143]
    ds_read_b64_tr_b16 v[66:67], v36 offset:48672
    buffer_load_dwordx4 v[176:179], v35, s[48:51], s87 offen sc1
    s_waitcnt lgkmcnt(4)
    v_mfma_f32_16x16x32_bf16 v[144:147], v[48:51], a[64:67], v[144:147]
    ds_read_b64_tr_b16 v[68:69], v36 offset:46144
    v_mfma_f32_16x16x32_bf16 v[148:151], v[48:51], a[68:71], v[148:151]
    ds_read_b64_tr_b16 v[70:71], v36 offset:48704
    buffer_load_dwordx4 v[180:183], v35, s[48:51], s88 offen sc1
    v_mfma_f32_16x16x32_bf16 v[152:155], v[52:55], a[64:67], v[152:155]
    ds_read_b64_tr_b16 v[72:73], v36 offset:46176
    v_mfma_f32_16x16x32_bf16 v[156:159], v[52:55], a[68:71], v[156:159]
    ds_read_b64_tr_b16 v[74:75], v36 offset:48736
    v_mfma_f32_16x16x32_bf16 v[160:163], v[56:59], a[64:67], v[160:163]
    ds_read_b64_tr_b16 v[76:77], v36 offset:46208
    v_mfma_f32_16x16x32_bf16 v[164:167], v[56:59], a[68:71], v[164:167]
    ds_read_b64_tr_b16 v[78:79], v36 offset:48768
    s_waitcnt vmcnt(12)
    s_waitcnt lgkmcnt(6)
    v_mfma_f32_16x16x32_bf16 v[128:131], v[60:63], a[72:75], v[128:131]
    v_mfma_f32_16x16x32_bf16 v[132:135], v[60:63], a[76:79], v[132:135]
    buffer_load_dwordx2 v[184:185], v34, s[24:27], s89 offen
    v_mfma_f32_16x16x32_bf16 v[136:139], v[64:67], a[72:75], v[136:139]
    v_mfma_f32_16x16x32_bf16 v[140:143], v[64:67], a[76:79], v[140:143]
    buffer_load_dwordx2 v[186:187], v34, s[24:27], s90 offen
    s_waitcnt lgkmcnt(0)
    v_mfma_f32_16x16x32_bf16 v[144:147], v[68:71], a[72:75], v[144:147]
    v_mfma_f32_16x16x32_bf16 v[148:151], v[68:71], a[76:79], v[148:151]
    v_mfma_f32_16x16x32_bf16 v[152:155], v[72:75], a[72:75], v[152:155]
    v_mfma_f32_16x16x32_bf16 v[156:159], v[72:75], a[76:79], v[156:159]
    v_mfma_f32_16x16x32_bf16 v[160:163], v[76:79], a[72:75], v[160:163]
    v_mfma_f32_16x16x32_bf16 v[164:167], v[76:79], a[76:79], v[164:167]
    v_lshlrev_b32 v2, 4, v1
    s_mul_i32 s70, s59, 5120
    s_add_u32 s70, s70, 143360
    v_add_u32 v3, s70, v2
    s_xor_b32 s71, s59, 2
    s_mul_i32 s71, s71, 5120
    s_add_u32 s71, s71, 143360
    v_add_u32 v4, s71, v2
    ds_write_b128 v3, v[132:135] offset:0
    ds_write_b128 v3, v[140:143] offset:1024
    ds_write_b128 v3, v[148:151] offset:2048
    ds_write_b128 v3, v[156:159] offset:3072
    ds_write_b128 v3, v[164:167] offset:4096
    s_waitcnt vmcnt(0)
    v_add_f32 v100, 1.0, v100
    v_add_f32 v101, 1.0, v101
    v_add_f32 v102, 1.0, v102
    v_add_f32 v103, 1.0, v103
    v_add_f32 v104, 1.0, v104
    v_add_f32 v105, 1.0, v105
    v_add_f32 v106, 1.0, v106
    v_add_f32 v107, 1.0, v107
    v_add_f32 v108, 1.0, v108
    v_add_f32 v109, 1.0, v109
    v_add_f32 v110, 1.0, v110
    v_add_f32 v111, 1.0, v111
    v_add_f32 v112, 1.0, v112
    v_add_f32 v113, 1.0, v113
    v_add_f32 v114, 1.0, v114
    v_add_f32 v115, 1.0, v115
    v_add_f32 v116, 1.0, v116
    v_add_f32 v117, 1.0, v117
    v_add_f32 v118, 1.0, v118
    v_add_f32 v119, 1.0, v119
    v_add_f32 v176, 1.0, v176
    v_add_f32 v177, 1.0, v177
    v_add_f32 v178, 1.0, v178
    v_add_f32 v179, 1.0, v179
    v_cvt_pk_bf16_f32 v40, v100, v101
    v_cvt_pk_bf16_f32 v41, v102, v103
    v_cvt_pk_bf16_f32 v42, v104, v105
    v_cvt_pk_bf16_f32 v43, v106, v107
    v_cvt_pk_bf16_f32 v44, v108, v109
    v_cvt_pk_bf16_f32 v45, v110, v111
    v_cvt_pk_bf16_f32 v46, v112, v113
    v_cvt_pk_bf16_f32 v47, v114, v115
    v_cvt_pk_bf16_f32 v48, v116, v117
    v_cvt_pk_bf16_f32 v49, v118, v119
    v_lshlrev_b32 v100, 16, v40
    v_and_b32 v101, 0xffff0000, v40
    v_lshlrev_b32 v102, 16, v41
    v_and_b32 v103, 0xffff0000, v41
    v_lshlrev_b32 v104, 16, v42
    v_and_b32 v105, 0xffff0000, v42
    v_lshlrev_b32 v106, 16, v43
    v_and_b32 v107, 0xffff0000, v43
    v_lshlrev_b32 v108, 16, v44
    v_and_b32 v109, 0xffff0000, v44
    v_lshlrev_b32 v110, 16, v45
    v_and_b32 v111, 0xffff0000, v45
    v_lshlrev_b32 v112, 16, v46
    v_and_b32 v113, 0xffff0000, v46
    v_lshlrev_b32 v114, 16, v47
    v_and_b32 v115, 0xffff0000, v47
    v_lshlrev_b32 v116, 16, v48
    v_and_b32 v117, 0xffff0000, v48
    v_lshlrev_b32 v118, 16, v49
    v_and_b32 v119, 0xffff0000, v49
    v_cvt_pk_bf16_f32 v176, v176, v177
    v_cvt_pk_bf16_f32 v177, v178, v179
    v_cvt_pk_bf16_f32 v178, v180, v181
    v_cvt_pk_bf16_f32 v179, v182, v183
    v_accvgpr_read_b32 v40, a224
    v_accvgpr_read_b32 v41, a225
    v_accvgpr_read_b32 v42, a226
    v_accvgpr_read_b32 v43, a227
    v_accvgpr_read_b32 v44, a228
    v_accvgpr_read_b32 v45, a229
    v_accvgpr_read_b32 v46, a230
    v_accvgpr_read_b32 v47, a231
    v_accvgpr_read_b32 v48, a232
    v_accvgpr_read_b32 v49, a233
    v_lshlrev_b32 v52, 16, v40
    v_and_b32 v53, 0xffff0000, v40
    v_lshlrev_b32 v54, 16, v41
    v_and_b32 v55, 0xffff0000, v41
    v_lshlrev_b32 v56, 16, v42
    v_and_b32 v57, 0xffff0000, v42
    v_lshlrev_b32 v58, 16, v43
    v_and_b32 v59, 0xffff0000, v43
    v_lshlrev_b32 v60, 16, v44
    v_and_b32 v61, 0xffff0000, v44
    v_lshlrev_b32 v62, 16, v45
    v_and_b32 v63, 0xffff0000, v45
    v_lshlrev_b32 v64, 16, v46
    v_and_b32 v65, 0xffff0000, v46
    v_lshlrev_b32 v66, 16, v47
    v_and_b32 v67, 0xffff0000, v47
    v_lshlrev_b32 v68, 16, v48
    v_and_b32 v69, 0xffff0000, v48
    v_lshlrev_b32 v70, 16, v49
    v_and_b32 v71, 0xffff0000, v49
    s_waitcnt lgkmcnt(0)
    s_barrier
    ds_read_b128 v[8:11], v4 offset:0
    ds_read_b128 v[12:15], v4 offset:1024
    ds_read_b128 v[16:19], v4 offset:2048
    ds_read_b128 v[20:23], v4 offset:3072
    ds_read_b128 v[24:27], v4 offset:4096
    s_mov_b32 s79, s59
    s_mul_i32 s77, s79, 110592
    s_mul_i32 s78, s79, 7168
    s_add_u32 m0, s78, 0
    s_nop 0
    buffer_load_dwordx4 v200, s[20:23], s77 offen lds
    s_add_u32 m0, s78, 1024
    s_nop 0
    buffer_load_dwordx4 v201, s[20:23], s77 offen lds
    s_add_u32 m0, s78, 2048
    s_nop 0
    buffer_load_dwordx4 v202, s[20:23], s77 offen lds
    s_add_u32 m0, s78, 3072
    s_nop 0
    buffer_load_dwordx4 v203, s[20:23], s77 offen lds
    s_add_u32 m0, s78, 4096
    s_nop 0
    buffer_load_dwordx4 v204, s[20:23], s77 offen lds
    s_add_u32 m0, s78, 5120
    s_nop 0
    buffer_load_dwordx4 v205, s[20:23], s77 offen lds
    s_add_u32 m0, s78, 6144
    s_nop 0
    buffer_load_dwordx4 v206, s[20:23], s77 offen lds
    s_waitcnt lgkmcnt(0)
    v_pk_add_f32 v[128:129], v[128:129], v[8:9]
    v_pk_add_f32 v[130:131], v[130:131], v[10:11]
    v_pk_add_f32 v[136:137], v[136:137], v[12:13]
    v_pk_add_f32 v[138:139], v[138:139], v[14:15]
    v_pk_add_f32 v[144:145], v[144:145], v[16:17]
    v_pk_add_f32 v[146:147], v[146:147], v[18:19]
    v_pk_add_f32 v[152:153], v[152:153], v[20:21]
    v_pk_add_f32 v[154:155], v[154:155], v[22:23]
    v_pk_add_f32 v[160:161], v[160:161], v[24:25]
    v_pk_add_f32 v[162:163], v[162:163], v[26:27]
    v_pk_fma_f32 v[224:225], v[128:129], v[80:81], v[52:53]
    v_pk_fma_f32 v[226:227], v[130:131], v[82:83], v[54:55]
    v_pk_fma_f32 v[228:229], v[136:137], v[84:85], v[56:57]
    v_pk_fma_f32 v[230:231], v[138:139], v[86:87], v[58:59]
    v_pk_fma_f32 v[232:233], v[144:145], v[88:89], v[60:61]
    v_pk_fma_f32 v[234:235], v[146:147], v[90:91], v[62:63]
    v_pk_fma_f32 v[236:237], v[152:153], v[92:93], v[64:65]
    v_pk_fma_f32 v[238:239], v[154:155], v[94:95], v[66:67]
    v_pk_fma_f32 v[240:241], v[160:161], v[96:97], v[68:69]
    v_pk_fma_f32 v[242:243], v[162:163], v[98:99], v[70:71]
    v_pk_mul_f32 v[100:101], v[100:101], v[224:225]
    v_pk_mul_f32 v[102:103], v[102:103], v[226:227]
    v_pk_mul_f32 v[104:105], v[104:105], v[228:229]
    v_pk_mul_f32 v[106:107], v[106:107], v[230:231]
    v_pk_mul_f32 v[108:109], v[108:109], v[232:233]
    v_pk_mul_f32 v[110:111], v[110:111], v[234:235]
    v_pk_mul_f32 v[112:113], v[112:113], v[236:237]
    v_pk_mul_f32 v[114:115], v[114:115], v[238:239]
    v_pk_mul_f32 v[116:117], v[116:117], v[240:241]
    v_pk_mul_f32 v[118:119], v[118:119], v[242:243]
    v_cvt_pk_bf16_f32 v20, v100, v101
    v_cvt_pk_bf16_f32 v21, v102, v103
    v_cvt_pk_bf16_f32 v22, v104, v105
    v_cvt_pk_bf16_f32 v23, v106, v107
    v_cvt_pk_bf16_f32 v24, v108, v109
    v_cvt_pk_bf16_f32 v25, v110, v111
    v_cvt_pk_bf16_f32 v26, v112, v113
    v_cvt_pk_bf16_f32 v27, v114, v115
    v_cvt_pk_bf16_f32 v28, v116, v117
    v_cvt_pk_bf16_f32 v29, v118, v119
    s_and_b32 s71, s64, 1
    s_cmp_eq_u32 s71, 0
    s_cbranch_scc0 L_CO4790
    buffer_store_dwordx4 v[20:23], v39, s[48:51], s85 offen sc1
    buffer_store_dwordx4 v[24:27], v39, s[48:51], s85 offen offset:1024 sc1
    buffer_store_dwordx2 v[28:29], v39, s[48:51], s85 offen offset:2048 sc1
    s_branch L_CE4790
L_CO4790:
    buffer_store_dwordx2 v[20:21], v39, s[48:51], s85 offen offset:8 sc1
    buffer_store_dwordx4 v[22:25], v39, s[48:51], s85 offen offset:1024 sc1
    buffer_store_dwordx4 v[26:29], v39, s[48:51], s85 offen offset:2048 sc1
L_CE4790:
    v_pk_add_f32 v[8:9], v[224:225], v[226:227]
    v_pk_mul_f32 v[10:11], v[224:225], v[224:225]
    v_pk_fma_f32 v[10:11], v[226:227], v[226:227], v[10:11]
    v_pk_add_f32 v[8:9], v[8:9], v[228:229]
    v_pk_fma_f32 v[10:11], v[228:229], v[228:229], v[10:11]
    v_pk_add_f32 v[8:9], v[8:9], v[230:231]
    v_pk_fma_f32 v[10:11], v[230:231], v[230:231], v[10:11]
    v_pk_add_f32 v[8:9], v[8:9], v[232:233]
    v_pk_fma_f32 v[10:11], v[232:233], v[232:233], v[10:11]
    v_pk_add_f32 v[8:9], v[8:9], v[234:235]
    v_pk_fma_f32 v[10:11], v[234:235], v[234:235], v[10:11]
    v_pk_add_f32 v[8:9], v[8:9], v[236:237]
    v_pk_fma_f32 v[10:11], v[236:237], v[236:237], v[10:11]
    v_pk_add_f32 v[8:9], v[8:9], v[238:239]
    v_pk_fma_f32 v[10:11], v[238:239], v[238:239], v[10:11]
    v_pk_add_f32 v[8:9], v[8:9], v[240:241]
    v_pk_fma_f32 v[10:11], v[240:241], v[240:241], v[10:11]
    v_pk_add_f32 v[8:9], v[8:9], v[242:243]
    v_pk_fma_f32 v[10:11], v[242:243], v[242:243], v[10:11]
    v_add_f32 v8, v8, v9
    v_add_f32 v9, v10, v11
    v_mov_b32 v10, v8
    v_mov_b32 v11, v9
    s_nop 0
    v_permlane16_swap_b32 v10, v8
    v_permlane16_swap_b32 v11, v9
    v_add_f32 v8, v8, v10
    v_add_f32 v9, v9, v11
    v_mov_b32 v10, v8
    v_mov_b32 v11, v9
    s_nop 0
    v_permlane32_swap_b32 v10, v8
    v_permlane32_swap_b32 v11, v9
    v_add_f32 v8, v8, v10
    v_add_f32 v9, v9, v11
    buffer_store_dwordx2 v[8:9], v33, s[48:51], s84 offen sc1
    s_add_u32 s79, s59, 4
    s_mul_i32 s77, s79, 110592
    s_mul_i32 s78, s79, 7168
    s_add_u32 m0, s78, 0
    s_nop 0
    buffer_load_dwordx4 v200, s[20:23], s77 offen lds
    s_add_u32 m0, s78, 1024
    s_nop 0
    buffer_load_dwordx4 v201, s[20:23], s77 offen lds
    s_add_u32 m0, s78, 2048
    s_nop 0
    buffer_load_dwordx4 v202, s[20:23], s77 offen lds
    s_add_u32 m0, s78, 3072
    s_nop 0
    buffer_load_dwordx4 v203, s[20:23], s77 offen lds
    s_add_u32 m0, s78, 4096
    s_nop 0
    buffer_load_dwordx4 v204, s[20:23], s77 offen lds
    s_add_u32 m0, s78, 5120
    s_nop 0
    buffer_load_dwordx4 v205, s[20:23], s77 offen lds
    s_add_u32 m0, s78, 6144
    s_nop 0
    buffer_load_dwordx4 v206, s[20:23], s77 offen lds
    s_waitcnt vmcnt(7)
    s_barrier
    s_cmp_lg_u32 s59, 0
    s_cbranch_scc1 L_SF4864
    s_lshl_b32 s70, s57, 7
    s_lshl_b32 s71, s58, 2
    s_add_u32 s70, s70, s71
    s_add_u32 s70, s70, 6144
    v_mov_b32 v248, s56
    v_mov_b32 v249, 0
    s_mov_b64 exec, 1
    buffer_store_dword v248, v249, s[48:51], s70 offen sc1
    s_mov_b64 exec, -1
L_SF4864:
    v_mov_b32 v12, 0
    v_mov_b32 v13, 0
    v_cmp_gt_u32 vcc, 160, v0
    s_nop 0
    s_and_saveexec_b64 s[70:71], vcc
    ds_write_b64 v32, v[176:177]
    ds_write_b64 v32, v[178:179] offset:1296
    ds_write_b64 v32, v[12:13] offset:2592
    s_mov_b64 exec, s[70:71]
    s_cmp_eq_u32 s59, 0
    s_cbranch_scc1 L_W14884
    s_add_u32 s79, s59, 7
    s_min_u32 s79, s79, 14
    s_mul_i32 s77, s79, 110592
    s_mul_i32 s78, s79, 7168
    s_add_u32 m0, s78, 0
    s_nop 0
    buffer_load_dwordx4 v200, s[20:23], s77 offen lds
    s_add_u32 m0, s78, 1024
    s_nop 0
    buffer_load_dwordx4 v201, s[20:23], s77 offen lds
    s_add_u32 m0, s78, 2048
    s_nop 0
    buffer_load_dwordx4 v202, s[20:23], s77 offen lds
    s_add_u32 m0, s78, 3072
    s_nop 0
    buffer_load_dwordx4 v203, s[20:23], s77 offen lds
    s_add_u32 m0, s78, 4096
    s_nop 0
    buffer_load_dwordx4 v204, s[20:23], s77 offen lds
    s_add_u32 m0, s78, 5120
    s_nop 0
    buffer_load_dwordx4 v205, s[20:23], s77 offen lds
    s_add_u32 m0, s78, 6144
    s_nop 0
    buffer_load_dwordx4 v206, s[20:23], s77 offen lds
    s_add_u32 s79, s59, 10
    s_min_u32 s79, s79, 14
    s_mul_i32 s77, s79, 110592
    s_mul_i32 s78, s79, 7168
    s_add_u32 m0, s78, 0
    s_nop 0
    buffer_load_dwordx4 v200, s[20:23], s77 offen lds
    s_add_u32 m0, s78, 1024
    s_nop 0
    buffer_load_dwordx4 v201, s[20:23], s77 offen lds
    s_add_u32 m0, s78, 2048
    s_nop 0
    buffer_load_dwordx4 v202, s[20:23], s77 offen lds
    s_add_u32 m0, s78, 3072
    s_nop 0
    buffer_load_dwordx4 v203, s[20:23], s77 offen lds
    s_add_u32 m0, s78, 4096
    s_nop 0
    buffer_load_dwordx4 v204, s[20:23], s77 offen lds
    s_add_u32 m0, s78, 5120
    s_nop 0
    buffer_load_dwordx4 v205, s[20:23], s77 offen lds
    s_add_u32 m0, s78, 6144
    s_nop 0
    buffer_load_dwordx4 v206, s[20:23], s77 offen lds
    s_add_u32 s79, s59, 13
    s_min_u32 s79, s79, 14
    s_mul_i32 s77, s79, 110592
    s_mul_i32 s78, s79, 7168
    s_add_u32 m0, s78, 0
    s_nop 0
    buffer_load_dwordx4 v200, s[20:23], s77 offen lds
    s_add_u32 m0, s78, 1024
    s_nop 0
    buffer_load_dwordx4 v201, s[20:23], s77 offen lds
    s_add_u32 m0, s78, 2048
    s_nop 0
    buffer_load_dwordx4 v202, s[20:23], s77 offen lds
    s_add_u32 m0, s78, 3072
    s_nop 0
    buffer_load_dwordx4 v203, s[20:23], s77 offen lds
    s_add_u32 m0, s78, 4096
    s_nop 0
    buffer_load_dwordx4 v204, s[20:23], s77 offen lds
    s_add_u32 m0, s78, 5120
    s_nop 0
    buffer_load_dwordx4 v205, s[20:23], s77 offen lds
    s_add_u32 m0, s78, 6144
    s_nop 0
    buffer_load_dwordx4 v206, s[20:23], s77 offen lds
L_W14884:
    s_waitcnt lgkmcnt(0)
    v_lshrrev_b32 v2, 4, v1
    v_bfe_u32 v3, v1, 2, 2
    v_lshl_add_u32 v2, v2, 2, v3
    v_mul_u32_u24 v2, 224, v2
    v_and_b32 v3, 3, v1
    v_lshl_add_u32 v36, v3, 3, v2
    v_add_u32 v37, 57344, v36
    v_add_u32 v38, 114688, v36
    v_and_b32 v2, 15, v1
    v_min_u32 v3, 2, v2
    v_mul_u32_u24 v3, 1296, v3
    v_lshrrev_b32 v4, 4, v1
    v_lshl_add_u32 v3, v4, 3, v3
    v_add_u32 v35, 143360, v3
    s_add_u32 s75, s59, 4
    s_min_u32 s75, s75, 6
    s_lshl_b32 s70, s59, 5
    s_lshl_b32 s71, s75, 5
    v_add_u32 v26, s70, v36
    v_add_u32 v29, s71, v36
    v_add_u32 v27, s70, v37
    v_add_u32 v30, s71, v37
    v_add_u32 v28, s70, v38
    v_add_u32 v31, s71, v38
    v_mul_u32_u24 v3, 448, v2
    v_lshl_add_u32 v3, v4, 4, v3
    v_add_u32 v3, 147264, v3
    s_lshl_b32 s70, s59, 6
    v_add_u32 v24, s70, v3
    s_lshl_b32 s70, s75, 6
    v_add_u32 v25, s70, v3
    v_lshlrev_b32 v34, 4, v4
    v_add_u32 v34, 147264, v34
    v_lshlrev_b32 v3, 8, v4
    v_lshl_add_u32 v33, v2, 3, v3
    s_lshl_b32 s70, s57, 3
    s_lshl_b32 s71, s59, 1
    s_add_u32 s74, s70, s71
    s_mul_i32 s72, s74, 20480
    s_add_u32 s72, s72, 9134080
    s_add_u32 s73, s72, 20480
    s_lshl_b32 s70, s74, 10
    s_add_u32 s84, s70, 385024
    s_lshr_b32 s70, s66, 1
    s_lshl_b32 s70, s70, 10
    s_mul_i32 s71, s74, 55296
    s_add_u32 s70, s70, s71
    s_add_u32 s85, s70, 11755520
    s_add_u32 s86, s85, 55296
    s_mul_i32 s70, s63, 138240
    s_mul_i32 s71, s64, 276480
    s_add_u32 s70, s70, s71
    s_add_u32 s89, s70, 18833408
    s_cmp_lg_u32 s59, 0
    s_cbranch_scc1 L_PD5016
    s_lshl_b32 s70, s57, 7
    s_add_u32 s70, s70, 6144
    s_mov_b32 s71, 1048576
    v_min_u32 v248, 15, v1
    v_lshlrev_b32 v248, 2, v248
L_PL5016:
    buffer_load_dword v250, v248, s[48:51], s70 offen sc1
    s_waitcnt vmcnt(0)
    v_cmp_ne_u32 vcc, s56, v250
    s_sub_u32 s71, s71, 1
    s_cmp_eq_u32 s71, 0
    s_cbranch_scc1 L_PT5016
    s_cbranch_vccnz L_PL5016
    s_branch L_PD5016
L_PT5016:
    v_mov_b32 v250, 208
    v_mov_b32 v251, 0
    buffer_store_dword v250, v251, s[52:55], 0 offen
    s_waitcnt vmcnt(0)
L_PD5016:
    s_barrier
    buffer_load_dwordx4 a[0:3], v39, s[48:51], s72 offen offset:0 sc1
    buffer_load_dwordx4 a[4:7], v39, s[48:51], s73 offen offset:0 sc1
    buffer_load_dwordx4 a[8:11], v39, s[48:51], s72 offen offset:1024 sc1
    buffer_load_dwordx4 a[12:15], v39, s[48:51], s73 offen offset:1024 sc1
    buffer_load_dwordx4 a[16:19], v39, s[48:51], s72 offen offset:2048 sc1
    buffer_load_dwordx4 a[20:23], v39, s[48:51], s73 offen offset:2048 sc1
    buffer_load_dwordx4 a[24:27], v39, s[48:51], s72 offen offset:3072 sc1
    buffer_load_dwordx4 a[28:31], v39, s[48:51], s73 offen offset:3072 sc1
    s_add_u32 s72, s72, 4096
    s_add_u32 s73, s73, 4096
    buffer_load_dwordx4 a[32:35], v39, s[48:51], s72 offen offset:0 sc1
    buffer_load_dwordx4 a[36:39], v39, s[48:51], s73 offen offset:0 sc1
    buffer_load_dwordx4 a[40:43], v39, s[48:51], s72 offen offset:1024 sc1
    buffer_load_dwordx4 a[44:47], v39, s[48:51], s73 offen offset:1024 sc1
    buffer_load_dwordx2 v[8:9], v33, s[48:51], s84 offen sc1
    buffer_load_dwordx2 v[10:11], v33, s[48:51], s84 offen offset:128 sc1
    buffer_load_dwordx2 v[12:13], v33, s[48:51], s84 offen offset:1024 sc1
    buffer_load_dwordx2 v[14:15], v33, s[48:51], s84 offen offset:1152 sc1
    s_waitcnt vmcnt(16)
    s_barrier
    ds_read_b64 v[40:41], v35 offset:0
    ds_read_b64 v[42:43], v35 offset:32
    ds_read_b64_tr_b16 v[44:45], v26 offset:0
    ds_read_b64_tr_b16 v[46:47], v26 offset:3584
    ds_read_b64_tr_b16 v[48:49], v29 offset:0
    ds_read_b64_tr_b16 v[50:51], v29 offset:3584
    ds_read_b64 v[52:53], v35 offset:64
    ds_read_b64 v[54:55], v35 offset:96
    ds_read_b64_tr_b16 v[56:57], v26 offset:7168
    ds_read_b64_tr_b16 v[58:59], v26 offset:10752
    ds_read_b64_tr_b16 v[60:61], v29 offset:7168
    ds_read_b64_tr_b16 v[62:63], v29 offset:10752
    v_and_b32 v2, 15, v1
    v_cmp_eq_u32 vcc, 1, v2
    v_lshlrev_b32 v16, 16, v184
    v_and_b32 v17, 0xffff0000, v184
    v_lshlrev_b32 v18, 16, v185
    v_and_b32 v19, 0xffff0000, v185
    v_cndmask_b32 v16, 0, v16, vcc
    v_cndmask_b32 v17, 0, v17, vcc
    v_cndmask_b32 v18, 0, v18, vcc
    v_cndmask_b32 v19, 0, v19, vcc
    v_lshlrev_b32 v20, 16, v186
    v_and_b32 v21, 0xffff0000, v186
    v_lshlrev_b32 v22, 16, v187
    v_and_b32 v23, 0xffff0000, v187
    v_cndmask_b32 v20, 0, v20, vcc
    v_cndmask_b32 v21, 0, v21, vcc
    v_cndmask_b32 v22, 0, v22, vcc
    v_cndmask_b32 v23, 0, v23, vcc
    ds_read_b64 v[64:65], v35 offset:128
    ds_read_b64 v[66:67], v35 offset:160
    ds_read_b64_tr_b16 v[68:69], v26 offset:14336
    ds_read_b64_tr_b16 v[70:71], v26 offset:17920
    ds_read_b64_tr_b16 v[72:73], v29 offset:14336
    ds_read_b64_tr_b16 v[74:75], v29 offset:17920
    s_waitcnt lgkmcnt(12)
    v_mfma_f32_16x16x32_bf16 v[128:131], v[44:47], v[40:43], 0
    v_mfma_f32_16x16x32_bf16 v[132:135], v[48:51], v[40:43], 0
    ds_read_b64 v[40:41], v35 offset:192
    ds_read_b64 v[42:43], v35 offset:224
    ds_read_b64_tr_b16 v[44:45], v26 offset:21504
    ds_read_b64_tr_b16 v[46:47], v26 offset:25088
    ds_read_b64_tr_b16 v[48:49], v29 offset:21504
    ds_read_b64_tr_b16 v[50:51], v29 offset:25088
    s_waitcnt lgkmcnt(12)
    v_mfma_f32_16x16x32_bf16 v[128:131], v[56:59], v[52:55], v[128:131]
    v_mfma_f32_16x16x32_bf16 v[132:135], v[60:63], v[52:55], v[132:135]
    ds_read_b64 v[52:53], v35 offset:256
    ds_read_b64 v[54:55], v35 offset:288
    ds_read_b64_tr_b16 v[56:57], v26 offset:28672
    ds_read_b64_tr_b16 v[58:59], v26 offset:32256
    ds_read_b64_tr_b16 v[60:61], v29 offset:28672
    ds_read_b64_tr_b16 v[62:63], v29 offset:32256
    s_waitcnt lgkmcnt(12)
    v_mfma_f32_16x16x32_bf16 v[128:131], v[68:71], v[64:67], v[128:131]
    v_mfma_f32_16x16x32_bf16 v[132:135], v[72:75], v[64:67], v[132:135]
    ds_read_b64 v[64:65], v35 offset:320
    ds_read_b64 v[66:67], v35 offset:352
    ds_read_b64_tr_b16 v[68:69], v26 offset:35840
    ds_read_b64_tr_b16 v[70:71], v26 offset:39424
    ds_read_b64_tr_b16 v[72:73], v29 offset:35840
    ds_read_b64_tr_b16 v[74:75], v29 offset:39424
    s_waitcnt lgkmcnt(12)
    v_mfma_f32_16x16x32_bf16 v[128:131], v[44:47], v[40:43], v[128:131]
    v_mfma_f32_16x16x32_bf16 v[132:135], v[48:51], v[40:43], v[132:135]
    ds_read_b64 v[40:41], v35 offset:384
    ds_read_b64 v[42:43], v35 offset:416
    s_branch L_PSK8
L_PAD8:
    s_setpc_b64 s[100:101]
L_PSK8:
    ds_read_b64_tr_b16 v[44:45], v26 offset:43008
    ds_read_b64_tr_b16 v[46:47], v26 offset:46592
    ds_read_b64_tr_b16 v[48:49], v29 offset:43008
    ds_read_b64_tr_b16 v[50:51], v29 offset:46592
    s_waitcnt lgkmcnt(12)
    v_mfma_f32_16x16x32_bf16 v[128:131], v[56:59], v[52:55], v[128:131]
    v_mfma_f32_16x16x32_bf16 v[132:135], v[60:63], v[52:55], v[132:135]
    ds_read_b64 v[52:53], v35 offset:448
    ds_read_b64 v[54:55], v35 offset:480
    ds_read_b64_tr_b16 v[56:57], v26 offset:50176
    ds_read_b64_tr_b16 v[58:59], v26 offset:53760
    ds_read_b64_tr_b16 v[60:61], v29 offset:50176
    ds_read_b64_tr_b16 v[62:63], v29 offset:53760
    s_waitcnt lgkmcnt(12)
    v_mfma_f32_16x16x32_bf16 v[128:131], v[68:71], v[64:67], v[128:131]
    v_mfma_f32_16x16x32_bf16 v[132:135], v[72:75], v[64:67], v[132:135]
    ds_read_b64 v[64:65], v35 offset:512
    ds_read_b64 v[66:67], v35 offset:544
    ds_read_b64_tr_b16 v[68:69], v27 offset:0
    ds_read_b64_tr_b16 v[70:71], v27 offset:3584
    ds_read_b64_tr_b16 v[72:73], v30 offset:0
    ds_read_b64_tr_b16 v[74:75], v30 offset:3584
    s_waitcnt lgkmcnt(12)
    v_mfma_f32_16x16x32_bf16 v[128:131], v[44:47], v[40:43], v[128:131]
    v_mfma_f32_16x16x32_bf16 v[132:135], v[48:51], v[40:43], v[132:135]
    ds_read_b64 v[40:41], v35 offset:576
    ds_read_b64 v[42:43], v35 offset:608
    ds_read_b64_tr_b16 v[44:45], v27 offset:7168
    ds_read_b64_tr_b16 v[46:47], v27 offset:10752
    ds_read_b64_tr_b16 v[48:49], v30 offset:7168
    ds_read_b64_tr_b16 v[50:51], v30 offset:10752
    s_waitcnt lgkmcnt(12)
    v_mfma_f32_16x16x32_bf16 v[128:131], v[56:59], v[52:55], v[128:131]
    v_mfma_f32_16x16x32_bf16 v[132:135], v[60:63], v[52:55], v[132:135]
    ds_read_b64 v[52:53], v35 offset:640
    ds_read_b64 v[54:55], v35 offset:672
    ds_read_b64_tr_b16 v[56:57], v27 offset:14336
    ds_read_b64_tr_b16 v[58:59], v27 offset:17920
    ds_read_b64_tr_b16 v[60:61], v30 offset:14336
    ds_read_b64_tr_b16 v[62:63], v30 offset:17920
    s_waitcnt lgkmcnt(12)
    v_mfma_f32_16x16x32_bf16 v[128:131], v[68:71], v[64:67], v[128:131]
    v_mfma_f32_16x16x32_bf16 v[132:135], v[72:75], v[64:67], v[132:135]
    ds_read_b64 v[64:65], v35 offset:704
    ds_read_b64 v[66:67], v35 offset:736
    ds_read_b64_tr_b16 v[68:69], v27 offset:21504
    ds_read_b64_tr_b16 v[70:71], v27 offset:25088
    ds_read_b64_tr_b16 v[72:73], v30 offset:21504
    ds_read_b64_tr_b16 v[74:75], v30 offset:25088
    s_waitcnt lgkmcnt(12)
    v_mfma_f32_16x16x32_bf16 v[128:131], v[44:47], v[40:43], v[128:131]
    v_mfma_f32_16x16x32_bf16 v[132:135], v[48:51], v[40:43], v[132:135]
    ds_read_b64 v[40:41], v35 offset:768
    ds_read_b64 v[42:43], v35 offset:800
    ds_read_b64_tr_b16 v[44:45], v27 offset:28672
    ds_read_b64_tr_b16 v[46:47], v27 offset:32256
    ds_read_b64_tr_b16 v[48:49], v30 offset:28672
    ds_read_b64_tr_b16 v[50:51], v30 offset:32256
    s_waitcnt lgkmcnt(12)
    v_mfma_f32_16x16x32_bf16 v[128:131], v[56:59], v[52:55], v[128:131]
    v_mfma_f32_16x16x32_bf16 v[132:135], v[60:63], v[52:55], v[132:135]
    ds_read_b64 v[52:53], v35 offset:832
    ds_read_b64 v[54:55], v35 offset:864
    ds_read_b64_tr_b16 v[56:57], v27 offset:35840
    ds_read_b64_tr_b16 v[58:59], v27 offset:39424
    ds_read_b64_tr_b16 v[60:61], v30 offset:35840
    ds_read_b64_tr_b16 v[62:63], v30 offset:39424
    s_waitcnt lgkmcnt(12)
    v_mfma_f32_16x16x32_bf16 v[128:131], v[68:71], v[64:67], v[128:131]
    v_mfma_f32_16x16x32_bf16 v[132:135], v[72:75], v[64:67], v[132:135]
    ds_read_b64 v[64:65], v35 offset:896
    ds_read_b64 v[66:67], v35 offset:928
    ds_read_b64_tr_b16 v[68:69], v27 offset:43008
    ds_read_b64_tr_b16 v[70:71], v27 offset:46592
    ds_read_b64_tr_b16 v[72:73], v30 offset:43008
    ds_read_b64_tr_b16 v[74:75], v30 offset:46592
    s_waitcnt lgkmcnt(12)
    v_mfma_f32_16x16x32_bf16 v[128:131], v[44:47], v[40:43], v[128:131]
    v_mfma_f32_16x16x32_bf16 v[132:135], v[48:51], v[40:43], v[132:135]
    ds_read_b64 v[40:41], v35 offset:960
    ds_read_b64 v[42:43], v35 offset:992
    ds_read_b64_tr_b16 v[44:45], v27 offset:50176
    ds_read_b64_tr_b16 v[46:47], v27 offset:53760
    ds_read_b64_tr_b16 v[48:49], v30 offset:50176
    ds_read_b64_tr_b16 v[50:51], v30 offset:53760
    s_waitcnt lgkmcnt(12)
    v_mfma_f32_16x16x32_bf16 v[128:131], v[56:59], v[52:55], v[128:131]
    v_mfma_f32_16x16x32_bf16 v[132:135], v[60:63], v[52:55], v[132:135]
    ds_read_b64 v[52:53], v35 offset:1024
    ds_read_b64 v[54:55], v35 offset:1056
    ds_read_b64_tr_b16 v[56:57], v28 offset:0
    ds_read_b64_tr_b16 v[58:59], v28 offset:3584
    ds_read_b64_tr_b16 v[60:61], v31 offset:0
    ds_read_b64_tr_b16 v[62:63], v31 offset:3584
    s_waitcnt lgkmcnt(12)
    v_mfma_f32_16x16x32_bf16 v[128:131], v[68:71], v[64:67], v[128:131]
    v_mfma_f32_16x16x32_bf16 v[132:135], v[72:75], v[64:67], v[132:135]
    ds_read_b64 v[64:65], v35 offset:1088
    ds_read_b64 v[66:67], v35 offset:1120
    ds_read_b64_tr_b16 v[68:69], v28 offset:7168
    ds_read_b64_tr_b16 v[70:71], v28 offset:10752
    ds_read_b64_tr_b16 v[72:73], v31 offset:7168
    ds_read_b64_tr_b16 v[74:75], v31 offset:10752
    s_waitcnt lgkmcnt(12)
    v_mfma_f32_16x16x32_bf16 v[128:131], v[44:47], v[40:43], v[128:131]
    v_mfma_f32_16x16x32_bf16 v[132:135], v[48:51], v[40:43], v[132:135]
    ds_read_b64 v[40:41], v35 offset:1152
    ds_read_b64 v[42:43], v35 offset:1184
    ds_read_b64_tr_b16 v[44:45], v28 offset:14336
    ds_read_b64_tr_b16 v[46:47], v28 offset:17920
    ds_read_b64_tr_b16 v[48:49], v31 offset:14336
    ds_read_b64_tr_b16 v[50:51], v31 offset:17920
    s_waitcnt lgkmcnt(12)
    v_mfma_f32_16x16x32_bf16 v[128:131], v[56:59], v[52:55], v[128:131]
    v_mfma_f32_16x16x32_bf16 v[132:135], v[60:63], v[52:55], v[132:135]
    ds_read_b64 v[52:53], v35 offset:1216
    ds_read_b64 v[54:55], v35 offset:1248
    ds_read_b64_tr_b16 v[56:57], v28 offset:21504
    ds_read_b64_tr_b16 v[58:59], v28 offset:25088
    ds_read_b64_tr_b16 v[60:61], v31 offset:21504
    ds_read_b64_tr_b16 v[62:63], v31 offset:25088
    s_waitcnt lgkmcnt(12)
    v_mfma_f32_16x16x32_bf16 v[128:131], v[68:71], v[64:67], v[128:131]
    v_mfma_f32_16x16x32_bf16 v[132:135], v[72:75], v[64:67], v[132:135]
    s_waitcnt lgkmcnt(6)
    v_mfma_f32_16x16x32_bf16 v[128:131], v[44:47], v[40:43], v[128:131]
    v_mfma_f32_16x16x32_bf16 v[132:135], v[48:51], v[40:43], v[132:135]
    s_waitcnt lgkmcnt(0)
    v_mfma_f32_16x16x32_bf16 v[128:131], v[56:59], v[52:55], v[128:131]
    v_mfma_f32_16x16x32_bf16 v[132:135], v[60:63], v[52:55], v[132:135]
    v_cmp_gt_u32 vcc, 2, v2
    s_nop 5
    v_pk_add_f32 v[128:129], v[128:129], v[16:17]
    v_pk_add_f32 v[130:131], v[130:131], v[18:19]
    v_pk_add_f32 v[132:133], v[132:133], v[20:21]
    v_pk_add_f32 v[134:135], v[134:135], v[22:23]
    s_and_saveexec_b64 s[70:71], vcc
    ds_write_b128 v24, v[128:131]
    ds_write_b128 v25, v[132:135]
    s_mov_b64 exec, s[70:71]
    s_waitcnt lgkmcnt(0)
    s_barrier
    ds_read_b128 v[96:99], v34 offset:0
    ds_read_b128 v[188:191], v34 offset:448
    ds_read_b128 v[100:103], v34 offset:64
    ds_read_b128 v[192:195], v34 offset:512
    ds_read_b128 v[104:107], v34 offset:128
    ds_read_b128 v[196:199], v34 offset:576
    ds_read_b128 v[108:111], v34 offset:192
    ds_read_b128 v[200:203], v34 offset:640
    ds_read_b128 v[112:115], v34 offset:256
    ds_read_b128 v[204:207], v34 offset:704
    ds_read_b128 v[116:119], v34 offset:320
    ds_read_b128 v[208:211], v34 offset:768
    ds_read_b128 v[120:123], v34 offset:384
    ds_read_b128 v[212:215], v34 offset:832
    ds_read_b64_tr_b16 v[40:41], v36 offset:0
    ds_read_b64_tr_b16 v[42:43], v36 offset:3584
    ds_read_b64_tr_b16 v[44:45], v36 offset:32
    ds_read_b64_tr_b16 v[46:47], v36 offset:3616
    ds_read_b64_tr_b16 v[48:49], v36 offset:64
    ds_read_b64_tr_b16 v[50:51], v36 offset:3648
    ds_read_b64_tr_b16 v[52:53], v36 offset:96
    ds_read_b64_tr_b16 v[54:55], v36 offset:3680
    ds_read_b64_tr_b16 v[56:57], v36 offset:128
    ds_read_b64_tr_b16 v[58:59], v36 offset:3712
    ds_read_b64_tr_b16 v[60:61], v36 offset:160
    ds_read_b64_tr_b16 v[62:63], v36 offset:3744
    ds_read_b64_tr_b16 v[64:65], v36 offset:192
    ds_read_b64_tr_b16 v[66:67], v36 offset:3776
    s_waitcnt vmcnt(14)
    s_waitcnt lgkmcnt(10)
    v_mfma_f32_16x16x32_bf16 v[128:131], v[40:43], a[0:3], 0
    ds_read_b64_tr_b16 v[68:69], v36 offset:7168
    v_mfma_f32_16x16x32_bf16 v[132:135], v[40:43], a[4:7], 0
    ds_read_b64_tr_b16 v[70:71], v36 offset:10752
    buffer_load_dwordx4 a[48:51], v39, s[48:51], s72 offen offset:2048 sc1
    v_mfma_f32_16x16x32_bf16 v[136:139], v[44:47], a[0:3], 0
    ds_read_b64_tr_b16 v[72:73], v36 offset:7200
    v_mfma_f32_16x16x32_bf16 v[140:143], v[44:47], a[4:7], 0
    ds_read_b64_tr_b16 v[74:75], v36 offset:10784
    buffer_load_dwordx4 a[52:55], v39, s[48:51], s73 offen offset:2048 sc1
    s_waitcnt lgkmcnt(4)
    v_mfma_f32_16x16x32_bf16 v[144:147], v[48:51], a[0:3], 0
    ds_read_b64_tr_b16 v[76:77], v36 offset:7232
    v_mfma_f32_16x16x32_bf16 v[148:151], v[48:51], a[4:7], 0
    ds_read_b64_tr_b16 v[78:79], v36 offset:10816
    v_mfma_f32_16x16x32_bf16 v[152:155], v[52:55], a[0:3], 0
    ds_read_b64_tr_b16 v[80:81], v36 offset:7264
    v_mfma_f32_16x16x32_bf16 v[156:159], v[52:55], a[4:7], 0
    ds_read_b64_tr_b16 v[82:83], v36 offset:10848
    v_mfma_f32_16x16x32_bf16 v[160:163], v[56:59], a[0:3], 0
    ds_read_b64_tr_b16 v[84:85], v36 offset:7296
    v_mfma_f32_16x16x32_bf16 v[164:167], v[56:59], a[4:7], 0
    ds_read_b64_tr_b16 v[86:87], v36 offset:10880
    v_mfma_f32_16x16x32_bf16 v[168:171], v[60:63], a[0:3], 0
    ds_read_b64_tr_b16 v[88:89], v36 offset:7328
    v_mfma_f32_16x16x32_bf16 v[172:175], v[60:63], a[4:7], 0
    ds_read_b64_tr_b16 v[90:91], v36 offset:10912
    v_mfma_f32_16x16x32_bf16 v[176:179], v[64:67], a[0:3], 0
    ds_read_b64_tr_b16 v[92:93], v36 offset:7360
    v_mfma_f32_16x16x32_bf16 v[180:183], v[64:67], a[4:7], 0
    ds_read_b64_tr_b16 v[94:95], v36 offset:10944
    s_waitcnt vmcnt(14)
    s_waitcnt lgkmcnt(10)
    v_mfma_f32_16x16x32_bf16 v[128:131], v[68:71], a[8:11], v[128:131]
    ds_read_b64_tr_b16 v[40:41], v36 offset:14336
    v_mfma_f32_16x16x32_bf16 v[132:135], v[68:71], a[12:15], v[132:135]
    ds_read_b64_tr_b16 v[42:43], v36 offset:17920
    buffer_load_dwordx4 a[56:59], v39, s[48:51], s72 offen offset:3072 sc1
    v_mfma_f32_16x16x32_bf16 v[136:139], v[72:75], a[8:11], v[136:139]
    ds_read_b64_tr_b16 v[44:45], v36 offset:14368
    v_mfma_f32_16x16x32_bf16 v[140:143], v[72:75], a[12:15], v[140:143]
    ds_read_b64_tr_b16 v[46:47], v36 offset:17952
    buffer_load_dwordx4 a[60:63], v39, s[48:51], s73 offen offset:3072 sc1
    s_add_u32 s72, s72, 4096
    s_add_u32 s73, s73, 4096
    s_waitcnt lgkmcnt(4)
    v_mfma_f32_16x16x32_bf16 v[144:147], v[76:79], a[8:11], v[144:147]
    ds_read_b64_tr_b16 v[48:49], v36 offset:14400
    v_mfma_f32_16x16x32_bf16 v[148:151], v[76:79], a[12:15], v[148:151]
    ds_read_b64_tr_b16 v[50:51], v36 offset:17984
    v_mfma_f32_16x16x32_bf16 v[152:155], v[80:83], a[8:11], v[152:155]
    ds_read_b64_tr_b16 v[52:53], v36 offset:14432
    v_mfma_f32_16x16x32_bf16 v[156:159], v[80:83], a[12:15], v[156:159]
    ds_read_b64_tr_b16 v[54:55], v36 offset:18016
    v_mfma_f32_16x16x32_bf16 v[160:163], v[84:87], a[8:11], v[160:163]
    ds_read_b64_tr_b16 v[56:57], v36 offset:14464
    v_mfma_f32_16x16x32_bf16 v[164:167], v[84:87], a[12:15], v[164:167]
    ds_read_b64_tr_b16 v[58:59], v36 offset:18048
    v_mfma_f32_16x16x32_bf16 v[168:171], v[88:91], a[8:11], v[168:171]
    ds_read_b64_tr_b16 v[60:61], v36 offset:14496
    v_mfma_f32_16x16x32_bf16 v[172:175], v[88:91], a[12:15], v[172:175]
    ds_read_b64_tr_b16 v[62:63], v36 offset:18080
    v_mfma_f32_16x16x32_bf16 v[176:179], v[92:95], a[8:11], v[176:179]
    ds_read_b64_tr_b16 v[64:65], v36 offset:14528
    v_mfma_f32_16x16x32_bf16 v[180:183], v[92:95], a[12:15], v[180:183]
    ds_read_b64_tr_b16 v[66:67], v36 offset:18112
    s_waitcnt vmcnt(14)
    s_waitcnt vmcnt(4)
    s_waitcnt lgkmcnt(10)
    v_mfma_f32_16x16x32_bf16 v[128:131], v[40:43], a[16:19], v[128:131]
    ds_read_b64_tr_b16 v[68:69], v36 offset:21504
    v_mfma_f32_16x16x32_bf16 v[132:135], v[40:43], a[20:23], v[132:135]
    ds_read_b64_tr_b16 v[70:71], v36 offset:25088
    buffer_load_dwordx4 a[0:3], v39, s[48:51], s72 offen offset:0 sc1
    v_mfma_f32_16x16x32_bf16 v[136:139], v[44:47], a[16:19], v[136:139]
    ds_read_b64_tr_b16 v[72:73], v36 offset:21536
    v_mfma_f32_16x16x32_bf16 v[140:143], v[44:47], a[20:23], v[140:143]
    ds_read_b64_tr_b16 v[74:75], v36 offset:25120
    buffer_load_dwordx4 a[4:7], v39, s[48:51], s73 offen offset:0 sc1
    s_waitcnt lgkmcnt(4)
    v_mfma_f32_16x16x32_bf16 v[144:147], v[48:51], a[16:19], v[144:147]
    ds_read_b64_tr_b16 v[76:77], v36 offset:21568
    v_mfma_f32_16x16x32_bf16 v[148:151], v[48:51], a[20:23], v[148:151]
    ds_read_b64_tr_b16 v[78:79], v36 offset:25152
    v_pk_add_f32 v[8:9], v[8:9], v[10:11]
    v_pk_add_f32 v[12:13], v[12:13], v[14:15]
    v_mfma_f32_16x16x32_bf16 v[152:155], v[52:55], a[16:19], v[152:155]
    ds_read_b64_tr_b16 v[80:81], v36 offset:21600
    v_mfma_f32_16x16x32_bf16 v[156:159], v[52:55], a[20:23], v[156:159]
    ds_read_b64_tr_b16 v[82:83], v36 offset:25184
    v_mov_b32 v10, v8
    v_mov_b32 v11, v9
    v_mov_b32 v14, v12
    v_mov_b32 v15, v13
    v_mfma_f32_16x16x32_bf16 v[160:163], v[56:59], a[16:19], v[160:163]
    ds_read_b64_tr_b16 v[84:85], v36 offset:21632
    v_mfma_f32_16x16x32_bf16 v[164:167], v[56:59], a[20:23], v[164:167]
    ds_read_b64_tr_b16 v[86:87], v36 offset:25216
    v_mfma_f32_16x16x32_bf16 v[168:171], v[60:63], a[16:19], v[168:171]
    ds_read_b64_tr_b16 v[88:89], v36 offset:21664
    v_mfma_f32_16x16x32_bf16 v[172:175], v[60:63], a[20:23], v[172:175]
    ds_read_b64_tr_b16 v[90:91], v36 offset:25248
    v_mfma_f32_16x16x32_bf16 v[176:179], v[64:67], a[16:19], v[176:179]
    ds_read_b64_tr_b16 v[92:93], v36 offset:21696
    v_mfma_f32_16x16x32_bf16 v[180:183], v[64:67], a[20:23], v[180:183]
    ds_read_b64_tr_b16 v[94:95], v36 offset:25280
    s_waitcnt lgkmcnt(10)
    v_mfma_f32_16x16x32_bf16 v[128:131], v[68:71], a[24:27], v[128:131]
    ds_read_b64_tr_b16 v[40:41], v36 offset:28672
    v_mfma_f32_16x16x32_bf16 v[132:135], v[68:71], a[28:31], v[132:135]
    ds_read_b64_tr_b16 v[42:43], v36 offset:32256
    buffer_load_dwordx4 a[8:11], v39, s[48:51], s72 offen offset:1024 sc1
    v_mfma_f32_16x16x32_bf16 v[136:139], v[72:75], a[24:27], v[136:139]
    ds_read_b64_tr_b16 v[44:45], v36 offset:28704
    v_mfma_f32_16x16x32_bf16 v[140:143], v[72:75], a[28:31], v[140:143]
    ds_read_b64_tr_b16 v[46:47], v36 offset:32288
    buffer_load_dwordx4 a[12:15], v39, s[48:51], s73 offen offset:1024 sc1
    s_waitcnt lgkmcnt(4)
    v_mfma_f32_16x16x32_bf16 v[144:147], v[76:79], a[24:27], v[144:147]
    ds_read_b64_tr_b16 v[48:49], v36 offset:28736
    v_mfma_f32_16x16x32_bf16 v[148:151], v[76:79], a[28:31], v[148:151]
    ds_read_b64_tr_b16 v[50:51], v36 offset:32320
    v_permlane16_swap_b32 v10, v8
    v_permlane16_swap_b32 v11, v9
    v_permlane16_swap_b32 v14, v12
    v_permlane16_swap_b32 v15, v13
    v_mfma_f32_16x16x32_bf16 v[152:155], v[80:83], a[24:27], v[152:155]
    ds_read_b64_tr_b16 v[52:53], v36 offset:28768
    v_mfma_f32_16x16x32_bf16 v[156:159], v[80:83], a[28:31], v[156:159]
    ds_read_b64_tr_b16 v[54:55], v36 offset:32352
    v_pk_add_f32 v[8:9], v[8:9], v[10:11]
    v_pk_add_f32 v[12:13], v[12:13], v[14:15]
    v_mfma_f32_16x16x32_bf16 v[160:163], v[84:87], a[24:27], v[160:163]
    ds_read_b64_tr_b16 v[56:57], v36 offset:28800
    v_mfma_f32_16x16x32_bf16 v[164:167], v[84:87], a[28:31], v[164:167]
    ds_read_b64_tr_b16 v[58:59], v36 offset:32384
    v_mfma_f32_16x16x32_bf16 v[168:171], v[88:91], a[24:27], v[168:171]
    ds_read_b64_tr_b16 v[60:61], v36 offset:28832
    v_mfma_f32_16x16x32_bf16 v[172:175], v[88:91], a[28:31], v[172:175]
    ds_read_b64_tr_b16 v[62:63], v36 offset:32416
    v_mfma_f32_16x16x32_bf16 v[176:179], v[92:95], a[24:27], v[176:179]
    ds_read_b64_tr_b16 v[64:65], v36 offset:28864
    v_mfma_f32_16x16x32_bf16 v[180:183], v[92:95], a[28:31], v[180:183]
    ds_read_b64_tr_b16 v[66:67], v36 offset:32448
    s_waitcnt lgkmcnt(10)
    v_mfma_f32_16x16x32_bf16 v[128:131], v[40:43], a[32:35], v[128:131]
    ds_read_b64_tr_b16 v[68:69], v36 offset:35840
    v_mfma_f32_16x16x32_bf16 v[132:135], v[40:43], a[36:39], v[132:135]
    ds_read_b64_tr_b16 v[70:71], v36 offset:39424
    buffer_load_dwordx4 a[16:19], v39, s[48:51], s72 offen offset:2048 sc1
    v_mfma_f32_16x16x32_bf16 v[136:139], v[44:47], a[32:35], v[136:139]
    ds_read_b64_tr_b16 v[72:73], v36 offset:35872
    v_mfma_f32_16x16x32_bf16 v[140:143], v[44:47], a[36:39], v[140:143]
    ds_read_b64_tr_b16 v[74:75], v36 offset:39456
    buffer_load_dwordx4 a[20:23], v39, s[48:51], s73 offen offset:2048 sc1
    s_waitcnt lgkmcnt(4)
    v_mfma_f32_16x16x32_bf16 v[144:147], v[48:51], a[32:35], v[144:147]
    ds_read_b64_tr_b16 v[76:77], v36 offset:35904
    v_mfma_f32_16x16x32_bf16 v[148:151], v[48:51], a[36:39], v[148:151]
    ds_read_b64_tr_b16 v[78:79], v36 offset:39488
    v_mov_b32 v10, v8
    v_mov_b32 v11, v9
    v_mov_b32 v14, v12
    v_mov_b32 v15, v13
    v_mfma_f32_16x16x32_bf16 v[152:155], v[52:55], a[32:35], v[152:155]
    ds_read_b64_tr_b16 v[80:81], v36 offset:35936
    v_mfma_f32_16x16x32_bf16 v[156:159], v[52:55], a[36:39], v[156:159]
    ds_read_b64_tr_b16 v[82:83], v36 offset:39520
    v_permlane32_swap_b32 v10, v8
    v_permlane32_swap_b32 v11, v9
    v_permlane32_swap_b32 v14, v12
    v_permlane32_swap_b32 v15, v13
    v_mfma_f32_16x16x32_bf16 v[160:163], v[56:59], a[32:35], v[160:163]
    ds_read_b64_tr_b16 v[84:85], v36 offset:35968
    v_mfma_f32_16x16x32_bf16 v[164:167], v[56:59], a[36:39], v[164:167]
    ds_read_b64_tr_b16 v[86:87], v36 offset:39552
    v_mfma_f32_16x16x32_bf16 v[168:171], v[60:63], a[32:35], v[168:171]
    ds_read_b64_tr_b16 v[88:89], v36 offset:36000
    v_mfma_f32_16x16x32_bf16 v[172:175], v[60:63], a[36:39], v[172:175]
    ds_read_b64_tr_b16 v[90:91], v36 offset:39584
    v_mfma_f32_16x16x32_bf16 v[176:179], v[64:67], a[32:35], v[176:179]
    ds_read_b64_tr_b16 v[92:93], v36 offset:36032
    v_mfma_f32_16x16x32_bf16 v[180:183], v[64:67], a[36:39], v[180:183]
    ds_read_b64_tr_b16 v[94:95], v36 offset:39616
    s_waitcnt lgkmcnt(10)
    v_mfma_f32_16x16x32_bf16 v[128:131], v[68:71], a[40:43], v[128:131]
    ds_read_b64_tr_b16 v[40:41], v36 offset:43008
    v_mfma_f32_16x16x32_bf16 v[132:135], v[68:71], a[44:47], v[132:135]
    ds_read_b64_tr_b16 v[42:43], v36 offset:46592
    buffer_load_dwordx4 a[24:27], v39, s[48:51], s72 offen offset:3072 sc1
    v_mfma_f32_16x16x32_bf16 v[136:139], v[72:75], a[40:43], v[136:139]
    ds_read_b64_tr_b16 v[44:45], v36 offset:43040
    v_mfma_f32_16x16x32_bf16 v[140:143], v[72:75], a[44:47], v[140:143]
    ds_read_b64_tr_b16 v[46:47], v36 offset:46624
    buffer_load_dwordx4 a[28:31], v39, s[48:51], s73 offen offset:3072 sc1
    s_add_u32 s72, s72, 4096
    s_add_u32 s73, s73, 4096
    s_waitcnt lgkmcnt(4)
    v_mfma_f32_16x16x32_bf16 v[144:147], v[76:79], a[40:43], v[144:147]
    ds_read_b64_tr_b16 v[48:49], v36 offset:43072
    v_mfma_f32_16x16x32_bf16 v[148:151], v[76:79], a[44:47], v[148:151]
    ds_read_b64_tr_b16 v[50:51], v36 offset:46656
    v_pk_add_f32 v[8:9], v[8:9], v[10:11]
    v_pk_add_f32 v[12:13], v[12:13], v[14:15]
    v_mfma_f32_16x16x32_bf16 v[152:155], v[80:83], a[40:43], v[152:155]
    ds_read_b64_tr_b16 v[52:53], v36 offset:43104
    v_mfma_f32_16x16x32_bf16 v[156:159], v[80:83], a[44:47], v[156:159]
    ds_read_b64_tr_b16 v[54:55], v36 offset:46688
    v_mul_f32 v8, 0x3acccccd, v8
    v_mul_f32 v9, 0x3acccccd, v9
    v_fma_f32 v9, -v8, v8, v9
    v_mfma_f32_16x16x32_bf16 v[160:163], v[84:87], a[40:43], v[160:163]
    ds_read_b64_tr_b16 v[56:57], v36 offset:43136
    v_mfma_f32_16x16x32_bf16 v[164:167], v[84:87], a[44:47], v[164:167]
    ds_read_b64_tr_b16 v[58:59], v36 offset:46720
    v_mfma_f32_16x16x32_bf16 v[168:171], v[88:91], a[40:43], v[168:171]
    ds_read_b64_tr_b16 v[60:61], v36 offset:43168
    v_mfma_f32_16x16x32_bf16 v[172:175], v[88:91], a[44:47], v[172:175]
    ds_read_b64_tr_b16 v[62:63], v36 offset:46752
    v_mfma_f32_16x16x32_bf16 v[176:179], v[92:95], a[40:43], v[176:179]
    ds_read_b64_tr_b16 v[64:65], v36 offset:43200
    v_mfma_f32_16x16x32_bf16 v[180:183], v[92:95], a[44:47], v[180:183]
    ds_read_b64_tr_b16 v[66:67], v36 offset:46784
    s_waitcnt vmcnt(10)
    s_waitcnt lgkmcnt(10)
    v_mfma_f32_16x16x32_bf16 v[128:131], v[40:43], a[48:51], v[128:131]
    ds_read_b64_tr_b16 v[68:69], v36 offset:50176
    v_mfma_f32_16x16x32_bf16 v[132:135], v[40:43], a[52:55], v[132:135]
    ds_read_b64_tr_b16 v[70:71], v36 offset:53760
    buffer_load_dwordx4 a[32:35], v39, s[48:51], s72 offen offset:0 sc1
    v_mfma_f32_16x16x32_bf16 v[136:139], v[44:47], a[48:51], v[136:139]
    ds_read_b64_tr_b16 v[72:73], v36 offset:50208
    v_mfma_f32_16x16x32_bf16 v[140:143], v[44:47], a[52:55], v[140:143]
    ds_read_b64_tr_b16 v[74:75], v36 offset:53792
    buffer_load_dwordx4 a[36:39], v39, s[48:51], s73 offen offset:0 sc1
    s_waitcnt lgkmcnt(4)
    v_mfma_f32_16x16x32_bf16 v[144:147], v[48:51], a[48:51], v[144:147]
    ds_read_b64_tr_b16 v[76:77], v36 offset:50240
    v_mfma_f32_16x16x32_bf16 v[148:151], v[48:51], a[52:55], v[148:151]
    ds_read_b64_tr_b16 v[78:79], v36 offset:53824
    v_max_f32 v9, 0, v9
    v_add_f32 v9, 0x3727c5ac, v9
    v_rsq_f32 v16, v9
    v_mfma_f32_16x16x32_bf16 v[152:155], v[52:55], a[48:51], v[152:155]
    ds_read_b64_tr_b16 v[80:81], v36 offset:50272
    v_mfma_f32_16x16x32_bf16 v[156:159], v[52:55], a[52:55], v[156:159]
    ds_read_b64_tr_b16 v[82:83], v36 offset:53856
    v_mul_f32 v18, v8, v16
    v_sub_f32 v18, 0, v18
    v_mov_b32 v17, v16
    v_mov_b32 v19, v18
    v_mfma_f32_16x16x32_bf16 v[160:163], v[56:59], a[48:51], v[160:163]
    ds_read_b64_tr_b16 v[84:85], v36 offset:50304
    v_mfma_f32_16x16x32_bf16 v[164:167], v[56:59], a[52:55], v[164:167]
    ds_read_b64_tr_b16 v[86:87], v36 offset:53888
    v_mfma_f32_16x16x32_bf16 v[168:171], v[60:63], a[48:51], v[168:171]
    ds_read_b64_tr_b16 v[88:89], v36 offset:50336
    v_mfma_f32_16x16x32_bf16 v[172:175], v[60:63], a[52:55], v[172:175]
    ds_read_b64_tr_b16 v[90:91], v36 offset:53920
    v_mfma_f32_16x16x32_bf16 v[176:179], v[64:67], a[48:51], v[176:179]
    ds_read_b64_tr_b16 v[92:93], v36 offset:50368
    v_mfma_f32_16x16x32_bf16 v[180:183], v[64:67], a[52:55], v[180:183]
    ds_read_b64_tr_b16 v[94:95], v36 offset:53952
    s_waitcnt vmcnt(10)
    s_waitcnt lgkmcnt(10)
    v_mfma_f32_16x16x32_bf16 v[128:131], v[68:71], a[56:59], v[128:131]
    ds_read_b64_tr_b16 v[40:41], v37 offset:0
    v_mfma_f32_16x16x32_bf16 v[132:135], v[68:71], a[60:63], v[132:135]
    ds_read_b64_tr_b16 v[42:43], v37 offset:3584
    buffer_load_dwordx4 a[40:43], v39, s[48:51], s72 offen offset:1024 sc1
    v_mfma_f32_16x16x32_bf16 v[136:139], v[72:75], a[56:59], v[136:139]
    ds_read_b64_tr_b16 v[44:45], v37 offset:32
    v_mfma_f32_16x16x32_bf16 v[140:143], v[72:75], a[60:63], v[140:143]
    ds_read_b64_tr_b16 v[46:47], v37 offset:3616
    buffer_load_dwordx4 a[44:47], v39, s[48:51], s73 offen offset:1024 sc1
    s_waitcnt lgkmcnt(4)
    v_mfma_f32_16x16x32_bf16 v[144:147], v[76:79], a[56:59], v[144:147]
    ds_read_b64_tr_b16 v[48:49], v37 offset:64
    v_mfma_f32_16x16x32_bf16 v[148:151], v[76:79], a[60:63], v[148:151]
    ds_read_b64_tr_b16 v[50:51], v37 offset:3648
    v_mul_f32 v12, 0x3acccccd, v12
    v_mul_f32 v13, 0x3acccccd, v13
    v_fma_f32 v13, -v12, v12, v13
    v_mfma_f32_16x16x32_bf16 v[152:155], v[80:83], a[56:59], v[152:155]
    ds_read_b64_tr_b16 v[52:53], v37 offset:96
    v_mfma_f32_16x16x32_bf16 v[156:159], v[80:83], a[60:63], v[156:159]
    ds_read_b64_tr_b16 v[54:55], v37 offset:3680
    v_max_f32 v13, 0, v13
    v_add_f32 v13, 0x3727c5ac, v13
    v_rsq_f32 v20, v13
    v_mfma_f32_16x16x32_bf16 v[160:163], v[84:87], a[56:59], v[160:163]
    ds_read_b64_tr_b16 v[56:57], v37 offset:128
    v_mfma_f32_16x16x32_bf16 v[164:167], v[84:87], a[60:63], v[164:167]
    ds_read_b64_tr_b16 v[58:59], v37 offset:3712
    v_mfma_f32_16x16x32_bf16 v[168:171], v[88:91], a[56:59], v[168:171]
    ds_read_b64_tr_b16 v[60:61], v37 offset:160
    v_mfma_f32_16x16x32_bf16 v[172:175], v[88:91], a[60:63], v[172:175]
    ds_read_b64_tr_b16 v[62:63], v37 offset:3744
    v_mfma_f32_16x16x32_bf16 v[176:179], v[92:95], a[56:59], v[176:179]
    ds_read_b64_tr_b16 v[64:65], v37 offset:192
    v_mfma_f32_16x16x32_bf16 v[180:183], v[92:95], a[60:63], v[180:183]
    ds_read_b64_tr_b16 v[66:67], v37 offset:3776
    s_waitcnt vmcnt(10)
    s_waitcnt lgkmcnt(10)
    v_mfma_f32_16x16x32_bf16 v[128:131], v[40:43], a[0:3], v[128:131]
    ds_read_b64_tr_b16 v[68:69], v37 offset:7168
    v_mfma_f32_16x16x32_bf16 v[132:135], v[40:43], a[4:7], v[132:135]
    ds_read_b64_tr_b16 v[70:71], v37 offset:10752
    buffer_load_dwordx4 a[48:51], v39, s[48:51], s72 offen offset:2048 sc1
    v_mfma_f32_16x16x32_bf16 v[136:139], v[44:47], a[0:3], v[136:139]
    ds_read_b64_tr_b16 v[72:73], v37 offset:7200
    v_mfma_f32_16x16x32_bf16 v[140:143], v[44:47], a[4:7], v[140:143]
    ds_read_b64_tr_b16 v[74:75], v37 offset:10784
    buffer_load_dwordx4 a[52:55], v39, s[48:51], s73 offen offset:2048 sc1
    s_waitcnt lgkmcnt(4)
    v_mfma_f32_16x16x32_bf16 v[144:147], v[48:51], a[0:3], v[144:147]
    ds_read_b64_tr_b16 v[76:77], v37 offset:7232
    v_mfma_f32_16x16x32_bf16 v[148:151], v[48:51], a[4:7], v[148:151]
    ds_read_b64_tr_b16 v[78:79], v37 offset:10816
    v_mul_f32 v22, v12, v20
    v_sub_f32 v22, 0, v22
    v_mov_b32 v21, v20
    v_mov_b32 v23, v22
    v_mfma_f32_16x16x32_bf16 v[152:155], v[52:55], a[0:3], v[152:155]
    ds_read_b64_tr_b16 v[80:81], v37 offset:7264
    v_mfma_f32_16x16x32_bf16 v[156:159], v[52:55], a[4:7], v[156:159]
    ds_read_b64_tr_b16 v[82:83], v37 offset:10848
    s_cmp_eq_u32 s67, 1
    s_cselect_b32 s75, 2147418112, 0
    v_or_b32 v32, s75, v39
    v_mfma_f32_16x16x32_bf16 v[160:163], v[56:59], a[0:3], v[160:163]
    ds_read_b64_tr_b16 v[84:85], v37 offset:7296
    v_mfma_f32_16x16x32_bf16 v[164:167], v[56:59], a[4:7], v[164:167]
    ds_read_b64_tr_b16 v[86:87], v37 offset:10880
    s_add_u32 s87, s62, 14
    s_min_u32 s87, s87, 26
    s_mul_i32 s87, s87, 5120
    s_add_u32 s87, s87, s89
    buffer_load_dwordx4 a[128:131], v39, s[48:51], s87 offen offset:0 sc1
    v_mfma_f32_16x16x32_bf16 v[168:171], v[60:63], a[0:3], v[168:171]
    ds_read_b64_tr_b16 v[88:89], v37 offset:7328
    v_mfma_f32_16x16x32_bf16 v[172:175], v[60:63], a[4:7], v[172:175]
    ds_read_b64_tr_b16 v[90:91], v37 offset:10912
    v_mfma_f32_16x16x32_bf16 v[176:179], v[64:67], a[0:3], v[176:179]
    ds_read_b64_tr_b16 v[92:93], v37 offset:7360
    v_mfma_f32_16x16x32_bf16 v[180:183], v[64:67], a[4:7], v[180:183]
    ds_read_b64_tr_b16 v[94:95], v37 offset:10944
    s_waitcnt vmcnt(11)
    s_waitcnt lgkmcnt(10)
    v_mfma_f32_16x16x32_bf16 v[128:131], v[68:71], a[8:11], v[128:131]
    ds_read_b64_tr_b16 v[40:41], v37 offset:14336
    v_mfma_f32_16x16x32_bf16 v[132:135], v[68:71], a[12:15], v[132:135]
    ds_read_b64_tr_b16 v[42:43], v37 offset:17920
    buffer_load_dwordx4 a[56:59], v39, s[48:51], s72 offen offset:3072 sc1
    v_mfma_f32_16x16x32_bf16 v[136:139], v[72:75], a[8:11], v[136:139]
    ds_read_b64_tr_b16 v[44:45], v37 offset:14368
    v_mfma_f32_16x16x32_bf16 v[140:143], v[72:75], a[12:15], v[140:143]
    ds_read_b64_tr_b16 v[46:47], v37 offset:17952
    buffer_load_dwordx4 a[60:63], v39, s[48:51], s73 offen offset:3072 sc1
    s_add_u32 s72, s72, 4096
    s_add_u32 s73, s73, 4096
    s_waitcnt lgkmcnt(4)
    v_mfma_f32_16x16x32_bf16 v[144:147], v[76:79], a[8:11], v[144:147]
    ds_read_b64_tr_b16 v[48:49], v37 offset:14400
    v_mfma_f32_16x16x32_bf16 v[148:151], v[76:79], a[12:15], v[148:151]
    ds_read_b64_tr_b16 v[50:51], v37 offset:17984
    buffer_load_dwordx4 a[132:135], v39, s[48:51], s87 offen offset:1024 sc1
    v_mfma_f32_16x16x32_bf16 v[152:155], v[80:83], a[8:11], v[152:155]
    ds_read_b64_tr_b16 v[52:53], v37 offset:14432
    v_mfma_f32_16x16x32_bf16 v[156:159], v[80:83], a[12:15], v[156:159]
    ds_read_b64_tr_b16 v[54:55], v37 offset:18016
    v_mfma_f32_16x16x32_bf16 v[160:163], v[84:87], a[8:11], v[160:163]
    ds_read_b64_tr_b16 v[56:57], v37 offset:14464
    v_mfma_f32_16x16x32_bf16 v[164:167], v[84:87], a[12:15], v[164:167]
    ds_read_b64_tr_b16 v[58:59], v37 offset:18048
    v_mfma_f32_16x16x32_bf16 v[168:171], v[88:91], a[8:11], v[168:171]
    ds_read_b64_tr_b16 v[60:61], v37 offset:14496
    v_mfma_f32_16x16x32_bf16 v[172:175], v[88:91], a[12:15], v[172:175]
    ds_read_b64_tr_b16 v[62:63], v37 offset:18080
    v_mfma_f32_16x16x32_bf16 v[176:179], v[92:95], a[8:11], v[176:179]
    ds_read_b64_tr_b16 v[64:65], v37 offset:14528
    s_branch L_PSK9
L_PAD9:
    s_setpc_b64 s[100:101]
L_PSK9:
    v_mfma_f32_16x16x32_bf16 v[180:183], v[92:95], a[12:15], v[180:183]
    ds_read_b64_tr_b16 v[66:67], v37 offset:18112
    s_waitcnt vmcnt(12)
    s_waitcnt lgkmcnt(10)
    v_mfma_f32_16x16x32_bf16 v[128:131], v[40:43], a[16:19], v[128:131]
    ds_read_b64_tr_b16 v[68:69], v37 offset:21504
    v_mfma_f32_16x16x32_bf16 v[132:135], v[40:43], a[20:23], v[132:135]
    ds_read_b64_tr_b16 v[70:71], v37 offset:25088
    buffer_load_dwordx4 a[0:3], v39, s[48:51], s72 offen offset:0 sc1
    v_mfma_f32_16x16x32_bf16 v[136:139], v[44:47], a[16:19], v[136:139]
    ds_read_b64_tr_b16 v[72:73], v37 offset:21536
    v_mfma_f32_16x16x32_bf16 v[140:143], v[44:47], a[20:23], v[140:143]
    ds_read_b64_tr_b16 v[74:75], v37 offset:25120
    buffer_load_dwordx4 a[4:7], v39, s[48:51], s73 offen offset:0 sc1
    s_waitcnt lgkmcnt(4)
    v_mfma_f32_16x16x32_bf16 v[144:147], v[48:51], a[16:19], v[144:147]
    ds_read_b64_tr_b16 v[76:77], v37 offset:21568
    v_mfma_f32_16x16x32_bf16 v[148:151], v[48:51], a[20:23], v[148:151]
    ds_read_b64_tr_b16 v[78:79], v37 offset:25152
    buffer_load_dwordx4 a[136:139], v39, s[48:51], s87 offen offset:2048 sc1
    v_mfma_f32_16x16x32_bf16 v[152:155], v[52:55], a[16:19], v[152:155]
    ds_read_b64_tr_b16 v[80:81], v37 offset:21600
    v_mfma_f32_16x16x32_bf16 v[156:159], v[52:55], a[20:23], v[156:159]
    ds_read_b64_tr_b16 v[82:83], v37 offset:25184
    v_mfma_f32_16x16x32_bf16 v[160:163], v[56:59], a[16:19], v[160:163]
    ds_read_b64_tr_b16 v[84:85], v37 offset:21632
    v_mfma_f32_16x16x32_bf16 v[164:167], v[56:59], a[20:23], v[164:167]
    ds_read_b64_tr_b16 v[86:87], v37 offset:25216
    v_mfma_f32_16x16x32_bf16 v[168:171], v[60:63], a[16:19], v[168:171]
    ds_read_b64_tr_b16 v[88:89], v37 offset:21664
    v_mfma_f32_16x16x32_bf16 v[172:175], v[60:63], a[20:23], v[172:175]
    ds_read_b64_tr_b16 v[90:91], v37 offset:25248
    v_mfma_f32_16x16x32_bf16 v[176:179], v[64:67], a[16:19], v[176:179]
    ds_read_b64_tr_b16 v[92:93], v37 offset:21696
    v_mfma_f32_16x16x32_bf16 v[180:183], v[64:67], a[20:23], v[180:183]
    ds_read_b64_tr_b16 v[94:95], v37 offset:25280
    s_waitcnt vmcnt(13)
    s_waitcnt lgkmcnt(10)
    v_mfma_f32_16x16x32_bf16 v[128:131], v[68:71], a[24:27], v[128:131]
    ds_read_b64_tr_b16 v[40:41], v37 offset:28672
    v_mfma_f32_16x16x32_bf16 v[132:135], v[68:71], a[28:31], v[132:135]
    ds_read_b64_tr_b16 v[42:43], v37 offset:32256
    buffer_load_dwordx4 a[8:11], v39, s[48:51], s72 offen offset:1024 sc1
    v_mfma_f32_16x16x32_bf16 v[136:139], v[72:75], a[24:27], v[136:139]
    ds_read_b64_tr_b16 v[44:45], v37 offset:28704
    v_mfma_f32_16x16x32_bf16 v[140:143], v[72:75], a[28:31], v[140:143]
    ds_read_b64_tr_b16 v[46:47], v37 offset:32288
    buffer_load_dwordx4 a[12:15], v39, s[48:51], s73 offen offset:1024 sc1
    s_waitcnt lgkmcnt(4)
    v_mfma_f32_16x16x32_bf16 v[144:147], v[76:79], a[24:27], v[144:147]
    ds_read_b64_tr_b16 v[48:49], v37 offset:28736
    v_mfma_f32_16x16x32_bf16 v[148:151], v[76:79], a[28:31], v[148:151]
    ds_read_b64_tr_b16 v[50:51], v37 offset:32320
    s_add_u32 s87, s62, 16
    s_min_u32 s87, s87, 26
    s_mul_i32 s87, s87, 5120
    s_add_u32 s87, s87, s89
    buffer_load_dwordx4 a[140:143], v39, s[48:51], s87 offen offset:0 sc1
    v_mfma_f32_16x16x32_bf16 v[152:155], v[80:83], a[24:27], v[152:155]
    ds_read_b64_tr_b16 v[52:53], v37 offset:28768
    v_mfma_f32_16x16x32_bf16 v[156:159], v[80:83], a[28:31], v[156:159]
    ds_read_b64_tr_b16 v[54:55], v37 offset:32352
    v_mfma_f32_16x16x32_bf16 v[160:163], v[84:87], a[24:27], v[160:163]
    ds_read_b64_tr_b16 v[56:57], v37 offset:28800
    v_mfma_f32_16x16x32_bf16 v[164:167], v[84:87], a[28:31], v[164:167]
    ds_read_b64_tr_b16 v[58:59], v37 offset:32384
    v_mfma_f32_16x16x32_bf16 v[168:171], v[88:91], a[24:27], v[168:171]
    ds_read_b64_tr_b16 v[60:61], v37 offset:28832
    v_mfma_f32_16x16x32_bf16 v[172:175], v[88:91], a[28:31], v[172:175]
    ds_read_b64_tr_b16 v[62:63], v37 offset:32416
    v_mfma_f32_16x16x32_bf16 v[176:179], v[92:95], a[24:27], v[176:179]
    ds_read_b64_tr_b16 v[64:65], v37 offset:28864
    v_mfma_f32_16x16x32_bf16 v[180:183], v[92:95], a[28:31], v[180:183]
    ds_read_b64_tr_b16 v[66:67], v37 offset:32448
    s_waitcnt vmcnt(14)
    s_waitcnt lgkmcnt(10)
    v_mfma_f32_16x16x32_bf16 v[128:131], v[40:43], a[32:35], v[128:131]
    ds_read_b64_tr_b16 v[68:69], v37 offset:35840
    v_mfma_f32_16x16x32_bf16 v[132:135], v[40:43], a[36:39], v[132:135]
    ds_read_b64_tr_b16 v[70:71], v37 offset:39424
    buffer_load_dwordx4 a[16:19], v39, s[48:51], s72 offen offset:2048 sc1
    v_mfma_f32_16x16x32_bf16 v[136:139], v[44:47], a[32:35], v[136:139]
    ds_read_b64_tr_b16 v[72:73], v37 offset:35872
    v_mfma_f32_16x16x32_bf16 v[140:143], v[44:47], a[36:39], v[140:143]
    ds_read_b64_tr_b16 v[74:75], v37 offset:39456
    buffer_load_dwordx4 a[20:23], v39, s[48:51], s73 offen offset:2048 sc1
    s_waitcnt lgkmcnt(4)
    v_mfma_f32_16x16x32_bf16 v[144:147], v[48:51], a[32:35], v[144:147]
    ds_read_b64_tr_b16 v[76:77], v37 offset:35904
    v_mfma_f32_16x16x32_bf16 v[148:151], v[48:51], a[36:39], v[148:151]
    ds_read_b64_tr_b16 v[78:79], v37 offset:39488
    buffer_load_dwordx4 a[144:147], v39, s[48:51], s87 offen offset:1024 sc1
    v_mfma_f32_16x16x32_bf16 v[152:155], v[52:55], a[32:35], v[152:155]
    ds_read_b64_tr_b16 v[80:81], v37 offset:35936
    v_mfma_f32_16x16x32_bf16 v[156:159], v[52:55], a[36:39], v[156:159]
    ds_read_b64_tr_b16 v[82:83], v37 offset:39520
    v_mfma_f32_16x16x32_bf16 v[160:163], v[56:59], a[32:35], v[160:163]
    ds_read_b64_tr_b16 v[84:85], v37 offset:35968
    v_mfma_f32_16x16x32_bf16 v[164:167], v[56:59], a[36:39], v[164:167]
    ds_read_b64_tr_b16 v[86:87], v37 offset:39552
    v_mfma_f32_16x16x32_bf16 v[168:171], v[60:63], a[32:35], v[168:171]
    ds_read_b64_tr_b16 v[88:89], v37 offset:36000
    v_mfma_f32_16x16x32_bf16 v[172:175], v[60:63], a[36:39], v[172:175]
    ds_read_b64_tr_b16 v[90:91], v37 offset:39584
    v_mfma_f32_16x16x32_bf16 v[176:179], v[64:67], a[32:35], v[176:179]
    ds_read_b64_tr_b16 v[92:93], v37 offset:36032
    v_mfma_f32_16x16x32_bf16 v[180:183], v[64:67], a[36:39], v[180:183]
    ds_read_b64_tr_b16 v[94:95], v37 offset:39616
    s_waitcnt vmcnt(15)
    s_waitcnt lgkmcnt(10)
    v_mfma_f32_16x16x32_bf16 v[128:131], v[68:71], a[40:43], v[128:131]
    ds_read_b64_tr_b16 v[40:41], v37 offset:43008
    v_mfma_f32_16x16x32_bf16 v[132:135], v[68:71], a[44:47], v[132:135]
    ds_read_b64_tr_b16 v[42:43], v37 offset:46592
    buffer_load_dwordx4 a[24:27], v39, s[48:51], s72 offen offset:3072 sc1
    v_mfma_f32_16x16x32_bf16 v[136:139], v[72:75], a[40:43], v[136:139]
    ds_read_b64_tr_b16 v[44:45], v37 offset:43040
    v_mfma_f32_16x16x32_bf16 v[140:143], v[72:75], a[44:47], v[140:143]
    ds_read_b64_tr_b16 v[46:47], v37 offset:46624
    buffer_load_dwordx4 a[28:31], v39, s[48:51], s73 offen offset:3072 sc1
    s_add_u32 s72, s72, 4096
    s_add_u32 s73, s73, 4096
    s_waitcnt lgkmcnt(4)
    v_mfma_f32_16x16x32_bf16 v[144:147], v[76:79], a[40:43], v[144:147]
    ds_read_b64_tr_b16 v[48:49], v37 offset:43072
    v_mfma_f32_16x16x32_bf16 v[148:151], v[76:79], a[44:47], v[148:151]
    ds_read_b64_tr_b16 v[50:51], v37 offset:46656
    buffer_load_dwordx4 a[148:151], v39, s[48:51], s87 offen offset:2048 sc1
    v_mfma_f32_16x16x32_bf16 v[152:155], v[80:83], a[40:43], v[152:155]
    ds_read_b64_tr_b16 v[52:53], v37 offset:43104
    v_mfma_f32_16x16x32_bf16 v[156:159], v[80:83], a[44:47], v[156:159]
    ds_read_b64_tr_b16 v[54:55], v37 offset:46688
    v_mfma_f32_16x16x32_bf16 v[160:163], v[84:87], a[40:43], v[160:163]
    ds_read_b64_tr_b16 v[56:57], v37 offset:43136
    v_mfma_f32_16x16x32_bf16 v[164:167], v[84:87], a[44:47], v[164:167]
    ds_read_b64_tr_b16 v[58:59], v37 offset:46720
    v_mfma_f32_16x16x32_bf16 v[168:171], v[88:91], a[40:43], v[168:171]
    ds_read_b64_tr_b16 v[60:61], v37 offset:43168
    v_mfma_f32_16x16x32_bf16 v[172:175], v[88:91], a[44:47], v[172:175]
    ds_read_b64_tr_b16 v[62:63], v37 offset:46752
    v_mfma_f32_16x16x32_bf16 v[176:179], v[92:95], a[40:43], v[176:179]
    ds_read_b64_tr_b16 v[64:65], v37 offset:43200
    v_mfma_f32_16x16x32_bf16 v[180:183], v[92:95], a[44:47], v[180:183]
    ds_read_b64_tr_b16 v[66:67], v37 offset:46784
    s_waitcnt vmcnt(16)
    s_waitcnt lgkmcnt(10)
    v_mfma_f32_16x16x32_bf16 v[128:131], v[40:43], a[48:51], v[128:131]
    ds_read_b64_tr_b16 v[68:69], v37 offset:50176
    v_mfma_f32_16x16x32_bf16 v[132:135], v[40:43], a[52:55], v[132:135]
    ds_read_b64_tr_b16 v[70:71], v37 offset:53760
    s_add_u32 s87, s62, 18
    s_min_u32 s87, s87, 26
    s_mul_i32 s87, s87, 5120
    s_add_u32 s87, s87, s89
    buffer_load_dwordx4 a[152:155], v39, s[48:51], s87 offen offset:0 sc1
    v_mfma_f32_16x16x32_bf16 v[136:139], v[44:47], a[48:51], v[136:139]
    ds_read_b64_tr_b16 v[72:73], v37 offset:50208
    v_mfma_f32_16x16x32_bf16 v[140:143], v[44:47], a[52:55], v[140:143]
    ds_read_b64_tr_b16 v[74:75], v37 offset:53792
    buffer_load_dwordx4 a[156:159], v39, s[48:51], s87 offen offset:1024 sc1
    s_waitcnt lgkmcnt(4)
    v_mfma_f32_16x16x32_bf16 v[144:147], v[48:51], a[48:51], v[144:147]
    ds_read_b64_tr_b16 v[76:77], v37 offset:50240
    v_mfma_f32_16x16x32_bf16 v[148:151], v[48:51], a[52:55], v[148:151]
    ds_read_b64_tr_b16 v[78:79], v37 offset:53824
    buffer_load_dwordx4 a[160:163], v39, s[48:51], s87 offen offset:2048 sc1
    v_mfma_f32_16x16x32_bf16 v[152:155], v[52:55], a[48:51], v[152:155]
    ds_read_b64_tr_b16 v[80:81], v37 offset:50272
    v_mfma_f32_16x16x32_bf16 v[156:159], v[52:55], a[52:55], v[156:159]
    ds_read_b64_tr_b16 v[82:83], v37 offset:53856
    v_mfma_f32_16x16x32_bf16 v[160:163], v[56:59], a[48:51], v[160:163]
    ds_read_b64_tr_b16 v[84:85], v37 offset:50304
    v_mfma_f32_16x16x32_bf16 v[164:167], v[56:59], a[52:55], v[164:167]
    ds_read_b64_tr_b16 v[86:87], v37 offset:53888
    v_mfma_f32_16x16x32_bf16 v[168:171], v[60:63], a[48:51], v[168:171]
    ds_read_b64_tr_b16 v[88:89], v37 offset:50336
    v_mfma_f32_16x16x32_bf16 v[172:175], v[60:63], a[52:55], v[172:175]
    ds_read_b64_tr_b16 v[90:91], v37 offset:53920
    v_mfma_f32_16x16x32_bf16 v[176:179], v[64:67], a[48:51], v[176:179]
    ds_read_b64_tr_b16 v[92:93], v37 offset:50368
    v_mfma_f32_16x16x32_bf16 v[180:183], v[64:67], a[52:55], v[180:183]
    ds_read_b64_tr_b16 v[94:95], v37 offset:53952
    s_waitcnt vmcnt(16)
    s_waitcnt lgkmcnt(10)
    v_mfma_f32_16x16x32_bf16 v[128:131], v[68:71], a[56:59], v[128:131]
    ds_read_b64_tr_b16 v[40:41], v38 offset:0
    v_mfma_f32_16x16x32_bf16 v[132:135], v[68:71], a[60:63], v[132:135]
    ds_read_b64_tr_b16 v[42:43], v38 offset:3584
    s_add_u32 s87, s62, 20
    s_min_u32 s87, s87, 26
    s_mul_i32 s87, s87, 5120
    s_add_u32 s87, s87, s89
    buffer_load_dwordx4 a[164:167], v39, s[48:51], s87 offen offset:0 sc1
    v_mfma_f32_16x16x32_bf16 v[136:139], v[72:75], a[56:59], v[136:139]
    ds_read_b64_tr_b16 v[44:45], v38 offset:32
    v_mfma_f32_16x16x32_bf16 v[140:143], v[72:75], a[60:63], v[140:143]
    ds_read_b64_tr_b16 v[46:47], v38 offset:3616
    buffer_load_dwordx4 a[168:171], v39, s[48:51], s87 offen offset:1024 sc1
    s_waitcnt lgkmcnt(4)
    v_mfma_f32_16x16x32_bf16 v[144:147], v[76:79], a[56:59], v[144:147]
    ds_read_b64_tr_b16 v[48:49], v38 offset:64
    v_mfma_f32_16x16x32_bf16 v[148:151], v[76:79], a[60:63], v[148:151]
    ds_read_b64_tr_b16 v[50:51], v38 offset:3648
    buffer_load_dwordx4 a[172:175], v39, s[48:51], s87 offen offset:2048 sc1
    v_mfma_f32_16x16x32_bf16 v[152:155], v[80:83], a[56:59], v[152:155]
    ds_read_b64_tr_b16 v[52:53], v38 offset:96
    v_mfma_f32_16x16x32_bf16 v[156:159], v[80:83], a[60:63], v[156:159]
    ds_read_b64_tr_b16 v[54:55], v38 offset:3680
    v_mfma_f32_16x16x32_bf16 v[160:163], v[84:87], a[56:59], v[160:163]
    ds_read_b64_tr_b16 v[56:57], v38 offset:128
    v_mfma_f32_16x16x32_bf16 v[164:167], v[84:87], a[60:63], v[164:167]
    ds_read_b64_tr_b16 v[58:59], v38 offset:3712
    v_mfma_f32_16x16x32_bf16 v[168:171], v[88:91], a[56:59], v[168:171]
    ds_read_b64_tr_b16 v[60:61], v38 offset:160
    v_mfma_f32_16x16x32_bf16 v[172:175], v[88:91], a[60:63], v[172:175]
    ds_read_b64_tr_b16 v[62:63], v38 offset:3744
    v_mfma_f32_16x16x32_bf16 v[176:179], v[92:95], a[56:59], v[176:179]
    ds_read_b64_tr_b16 v[64:65], v38 offset:192
    v_mfma_f32_16x16x32_bf16 v[180:183], v[92:95], a[60:63], v[180:183]
    ds_read_b64_tr_b16 v[66:67], v38 offset:3776
    s_waitcnt vmcnt(16)
    s_waitcnt lgkmcnt(10)
    v_mfma_f32_16x16x32_bf16 v[128:131], v[40:43], a[0:3], v[128:131]
    ds_read_b64_tr_b16 v[68:69], v38 offset:7168
    v_mfma_f32_16x16x32_bf16 v[132:135], v[40:43], a[4:7], v[132:135]
    ds_read_b64_tr_b16 v[70:71], v38 offset:10752
    s_add_u32 s87, s62, 22
    s_min_u32 s87, s87, 26
    s_mul_i32 s87, s87, 5120
    s_add_u32 s87, s87, s89
    buffer_load_dwordx4 a[176:179], v39, s[48:51], s87 offen offset:0 sc1
    v_mfma_f32_16x16x32_bf16 v[136:139], v[44:47], a[0:3], v[136:139]
    ds_read_b64_tr_b16 v[72:73], v38 offset:7200
    v_mfma_f32_16x16x32_bf16 v[140:143], v[44:47], a[4:7], v[140:143]
    ds_read_b64_tr_b16 v[74:75], v38 offset:10784
    buffer_load_dwordx4 a[180:183], v39, s[48:51], s87 offen offset:1024 sc1
    s_waitcnt lgkmcnt(4)
    v_mfma_f32_16x16x32_bf16 v[144:147], v[48:51], a[0:3], v[144:147]
    ds_read_b64_tr_b16 v[76:77], v38 offset:7232
    v_mfma_f32_16x16x32_bf16 v[148:151], v[48:51], a[4:7], v[148:151]
    ds_read_b64_tr_b16 v[78:79], v38 offset:10816
    buffer_load_dwordx4 a[184:187], v39, s[48:51], s87 offen offset:2048 sc1
    v_mfma_f32_16x16x32_bf16 v[152:155], v[52:55], a[0:3], v[152:155]
    ds_read_b64_tr_b16 v[80:81], v38 offset:7264
    v_mfma_f32_16x16x32_bf16 v[156:159], v[52:55], a[4:7], v[156:159]
    ds_read_b64_tr_b16 v[82:83], v38 offset:10848
    v_mfma_f32_16x16x32_bf16 v[160:163], v[56:59], a[0:3], v[160:163]
    ds_read_b64_tr_b16 v[84:85], v38 offset:7296
    v_mfma_f32_16x16x32_bf16 v[164:167], v[56:59], a[4:7], v[164:167]
    ds_read_b64_tr_b16 v[86:87], v38 offset:10880
    v_mfma_f32_16x16x32_bf16 v[168:171], v[60:63], a[0:3], v[168:171]
    ds_read_b64_tr_b16 v[88:89], v38 offset:7328
    v_mfma_f32_16x16x32_bf16 v[172:175], v[60:63], a[4:7], v[172:175]
    ds_read_b64_tr_b16 v[90:91], v38 offset:10912
    v_mfma_f32_16x16x32_bf16 v[176:179], v[64:67], a[0:3], v[176:179]
    ds_read_b64_tr_b16 v[92:93], v38 offset:7360
    v_mfma_f32_16x16x32_bf16 v[180:183], v[64:67], a[4:7], v[180:183]
    ds_read_b64_tr_b16 v[94:95], v38 offset:10944
    s_waitcnt vmcnt(16)
    s_waitcnt lgkmcnt(10)
    v_mfma_f32_16x16x32_bf16 v[128:131], v[68:71], a[8:11], v[128:131]
    ds_read_b64_tr_b16 v[40:41], v38 offset:14336
    v_mfma_f32_16x16x32_bf16 v[132:135], v[68:71], a[12:15], v[132:135]
    ds_read_b64_tr_b16 v[42:43], v38 offset:17920
    s_add_u32 s87, s62, 24
    s_min_u32 s87, s87, 26
    s_mul_i32 s87, s87, 5120
    s_add_u32 s87, s87, s89
    buffer_load_dwordx4 a[188:191], v39, s[48:51], s87 offen offset:0 sc1
    v_mfma_f32_16x16x32_bf16 v[136:139], v[72:75], a[8:11], v[136:139]
    ds_read_b64_tr_b16 v[44:45], v38 offset:14368
    v_mfma_f32_16x16x32_bf16 v[140:143], v[72:75], a[12:15], v[140:143]
    ds_read_b64_tr_b16 v[46:47], v38 offset:17952
    buffer_load_dwordx4 a[192:195], v39, s[48:51], s87 offen offset:1024 sc1
    s_waitcnt lgkmcnt(4)
    v_mfma_f32_16x16x32_bf16 v[144:147], v[76:79], a[8:11], v[144:147]
    ds_read_b64_tr_b16 v[48:49], v38 offset:14400
    v_mfma_f32_16x16x32_bf16 v[148:151], v[76:79], a[12:15], v[148:151]
    ds_read_b64_tr_b16 v[50:51], v38 offset:17984
    buffer_load_dwordx4 a[196:199], v39, s[48:51], s87 offen offset:2048 sc1
    v_mfma_f32_16x16x32_bf16 v[152:155], v[80:83], a[8:11], v[152:155]
    ds_read_b64_tr_b16 v[52:53], v38 offset:14432
    v_mfma_f32_16x16x32_bf16 v[156:159], v[80:83], a[12:15], v[156:159]
    ds_read_b64_tr_b16 v[54:55], v38 offset:18016
    v_mfma_f32_16x16x32_bf16 v[160:163], v[84:87], a[8:11], v[160:163]
    ds_read_b64_tr_b16 v[56:57], v38 offset:14464
    v_mfma_f32_16x16x32_bf16 v[164:167], v[84:87], a[12:15], v[164:167]
    ds_read_b64_tr_b16 v[58:59], v38 offset:18048
    v_mfma_f32_16x16x32_bf16 v[168:171], v[88:91], a[8:11], v[168:171]
    ds_read_b64_tr_b16 v[60:61], v38 offset:14496
    v_mfma_f32_16x16x32_bf16 v[172:175], v[88:91], a[12:15], v[172:175]
    ds_read_b64_tr_b16 v[62:63], v38 offset:18080
    v_mfma_f32_16x16x32_bf16 v[176:179], v[92:95], a[8:11], v[176:179]
    ds_read_b64_tr_b16 v[64:65], v38 offset:14528
    v_mfma_f32_16x16x32_bf16 v[180:183], v[92:95], a[12:15], v[180:183]
    ds_read_b64_tr_b16 v[66:67], v38 offset:18112
    s_waitcnt vmcnt(16)
    s_waitcnt lgkmcnt(10)
    v_mfma_f32_16x16x32_bf16 v[128:131], v[40:43], a[16:19], v[128:131]
    ds_read_b64_tr_b16 v[68:69], v38 offset:21504
    v_mfma_f32_16x16x32_bf16 v[132:135], v[40:43], a[20:23], v[132:135]
    ds_read_b64_tr_b16 v[70:71], v38 offset:25088
    s_add_u32 s87, s62, 26
    s_min_u32 s87, s87, 26
    s_mul_i32 s87, s87, 5120
    s_add_u32 s87, s87, s89
    buffer_load_dwordx4 a[200:203], v39, s[48:51], s87 offen offset:0 sc1
    v_mfma_f32_16x16x32_bf16 v[136:139], v[44:47], a[16:19], v[136:139]
    ds_read_b64_tr_b16 v[72:73], v38 offset:21536
    v_mfma_f32_16x16x32_bf16 v[140:143], v[44:47], a[20:23], v[140:143]
    ds_read_b64_tr_b16 v[74:75], v38 offset:25120
    buffer_load_dwordx4 a[204:207], v39, s[48:51], s87 offen offset:1024 sc1
    s_waitcnt lgkmcnt(4)
    v_mfma_f32_16x16x32_bf16 v[144:147], v[48:51], a[16:19], v[144:147]
    ds_read_b64_tr_b16 v[76:77], v38 offset:21568
    v_mfma_f32_16x16x32_bf16 v[148:151], v[48:51], a[20:23], v[148:151]
    ds_read_b64_tr_b16 v[78:79], v38 offset:25152
    buffer_load_dwordx4 a[208:211], v39, s[48:51], s87 offen offset:2048 sc1
    v_mfma_f32_16x16x32_bf16 v[152:155], v[52:55], a[16:19], v[152:155]
    ds_read_b64_tr_b16 v[80:81], v38 offset:21600
    v_mfma_f32_16x16x32_bf16 v[156:159], v[52:55], a[20:23], v[156:159]
    ds_read_b64_tr_b16 v[82:83], v38 offset:25184
    v_mfma_f32_16x16x32_bf16 v[160:163], v[56:59], a[16:19], v[160:163]
    ds_read_b64_tr_b16 v[84:85], v38 offset:21632
    v_mfma_f32_16x16x32_bf16 v[164:167], v[56:59], a[20:23], v[164:167]
    ds_read_b64_tr_b16 v[86:87], v38 offset:25216
    v_mfma_f32_16x16x32_bf16 v[168:171], v[60:63], a[16:19], v[168:171]
    ds_read_b64_tr_b16 v[88:89], v38 offset:21664
    v_mfma_f32_16x16x32_bf16 v[172:175], v[60:63], a[20:23], v[172:175]
    ds_read_b64_tr_b16 v[90:91], v38 offset:25248
    v_mfma_f32_16x16x32_bf16 v[176:179], v[64:67], a[16:19], v[176:179]
    ds_read_b64_tr_b16 v[92:93], v38 offset:21696
    v_mfma_f32_16x16x32_bf16 v[180:183], v[64:67], a[20:23], v[180:183]
    ds_read_b64_tr_b16 v[94:95], v38 offset:25280
    s_waitcnt vmcnt(16)
    s_waitcnt lgkmcnt(10)
    v_mfma_f32_16x16x32_bf16 v[128:131], v[68:71], a[24:27], v[128:131]
    v_mfma_f32_16x16x32_bf16 v[132:135], v[68:71], a[28:31], v[132:135]
    v_mfma_f32_16x16x32_bf16 v[136:139], v[72:75], a[24:27], v[136:139]
    v_mfma_f32_16x16x32_bf16 v[140:143], v[72:75], a[28:31], v[140:143]
    s_waitcnt lgkmcnt(0)
    v_mfma_f32_16x16x32_bf16 v[144:147], v[76:79], a[24:27], v[144:147]
    v_mfma_f32_16x16x32_bf16 v[148:151], v[76:79], a[28:31], v[148:151]
    v_mfma_f32_16x16x32_bf16 v[152:155], v[80:83], a[24:27], v[152:155]
    v_mfma_f32_16x16x32_bf16 v[156:159], v[80:83], a[28:31], v[156:159]
    v_mfma_f32_16x16x32_bf16 v[160:163], v[84:87], a[24:27], v[160:163]
    v_mfma_f32_16x16x32_bf16 v[164:167], v[84:87], a[28:31], v[164:167]
    v_mfma_f32_16x16x32_bf16 v[168:171], v[88:91], a[24:27], v[168:171]
    v_mfma_f32_16x16x32_bf16 v[172:175], v[88:91], a[28:31], v[172:175]
    v_mfma_f32_16x16x32_bf16 v[176:179], v[92:95], a[24:27], v[176:179]
    v_mfma_f32_16x16x32_bf16 v[180:183], v[92:95], a[28:31], v[180:183]
    s_barrier
    v_pk_fma_f32 v[24:25], v[96:97], v[18:19], v[188:189]
    v_pk_fma_f32 v[26:27], v[98:99], v[18:19], v[190:191]
    v_pk_fma_f32 v[128:129], v[128:129], v[16:17], v[24:25]
    v_pk_fma_f32 v[130:131], v[130:131], v[16:17], v[26:27]
    v_max_f32 v128, 0, v128
    v_max_f32 v129, 0, v129
    v_max_f32 v130, 0, v130
    v_max_f32 v131, 0, v131
    v_pk_mul_f32 v[128:129], v[128:129], v[128:129]
    v_pk_mul_f32 v[130:131], v[130:131], v[130:131]
    v_cvt_pk_bf16_f32 v40, v128, v129
    v_cvt_pk_bf16_f32 v41, v130, v131
    v_pk_fma_f32 v[24:25], v[100:101], v[18:19], v[192:193]
    v_pk_fma_f32 v[26:27], v[102:103], v[18:19], v[194:195]
    v_pk_fma_f32 v[136:137], v[136:137], v[16:17], v[24:25]
    v_pk_fma_f32 v[138:139], v[138:139], v[16:17], v[26:27]
    v_max_f32 v136, 0, v136
    v_max_f32 v137, 0, v137
    v_max_f32 v138, 0, v138
    v_max_f32 v139, 0, v139
    v_pk_mul_f32 v[136:137], v[136:137], v[136:137]
    v_pk_mul_f32 v[138:139], v[138:139], v[138:139]
    v_cvt_pk_bf16_f32 v42, v136, v137
    v_cvt_pk_bf16_f32 v43, v138, v139
    v_pk_fma_f32 v[24:25], v[104:105], v[18:19], v[196:197]
    v_pk_fma_f32 v[26:27], v[106:107], v[18:19], v[198:199]
    v_pk_fma_f32 v[144:145], v[144:145], v[16:17], v[24:25]
    v_pk_fma_f32 v[146:147], v[146:147], v[16:17], v[26:27]
    v_max_f32 v144, 0, v144
    v_max_f32 v145, 0, v145
    v_max_f32 v146, 0, v146
    v_max_f32 v147, 0, v147
    v_pk_mul_f32 v[144:145], v[144:145], v[144:145]
    v_pk_mul_f32 v[146:147], v[146:147], v[146:147]
    v_cvt_pk_bf16_f32 v44, v144, v145
    v_cvt_pk_bf16_f32 v45, v146, v147
    v_pk_fma_f32 v[24:25], v[108:109], v[18:19], v[200:201]
    v_pk_fma_f32 v[26:27], v[110:111], v[18:19], v[202:203]
    v_pk_fma_f32 v[152:153], v[152:153], v[16:17], v[24:25]
    v_pk_fma_f32 v[154:155], v[154:155], v[16:17], v[26:27]
    v_max_f32 v152, 0, v152
    v_max_f32 v153, 0, v153
    v_max_f32 v154, 0, v154
    v_max_f32 v155, 0, v155
    v_pk_mul_f32 v[152:153], v[152:153], v[152:153]
    v_pk_mul_f32 v[154:155], v[154:155], v[154:155]
    v_cvt_pk_bf16_f32 v46, v152, v153
    v_cvt_pk_bf16_f32 v47, v154, v155
    v_pk_fma_f32 v[24:25], v[112:113], v[18:19], v[204:205]
    v_pk_fma_f32 v[26:27], v[114:115], v[18:19], v[206:207]
    v_pk_fma_f32 v[160:161], v[160:161], v[16:17], v[24:25]
    v_pk_fma_f32 v[162:163], v[162:163], v[16:17], v[26:27]
    v_max_f32 v160, 0, v160
    v_max_f32 v161, 0, v161
    v_max_f32 v162, 0, v162
    v_max_f32 v163, 0, v163
    v_pk_mul_f32 v[160:161], v[160:161], v[160:161]
    v_pk_mul_f32 v[162:163], v[162:163], v[162:163]
    v_cvt_pk_bf16_f32 v48, v160, v161
    v_cvt_pk_bf16_f32 v49, v162, v163
    v_pk_fma_f32 v[24:25], v[116:117], v[18:19], v[208:209]
    v_pk_fma_f32 v[26:27], v[118:119], v[18:19], v[210:211]
    v_pk_fma_f32 v[168:169], v[168:169], v[16:17], v[24:25]
    v_pk_fma_f32 v[170:171], v[170:171], v[16:17], v[26:27]
    v_max_f32 v168, 0, v168
    v_max_f32 v169, 0, v169
    v_max_f32 v170, 0, v170
    v_max_f32 v171, 0, v171
    v_pk_mul_f32 v[168:169], v[168:169], v[168:169]
    v_pk_mul_f32 v[170:171], v[170:171], v[170:171]
    v_cvt_pk_bf16_f32 v50, v168, v169
    v_cvt_pk_bf16_f32 v51, v170, v171
    v_pk_fma_f32 v[24:25], v[120:121], v[18:19], v[212:213]
    v_pk_fma_f32 v[26:27], v[122:123], v[18:19], v[214:215]
    v_pk_fma_f32 v[176:177], v[176:177], v[16:17], v[24:25]
    v_pk_fma_f32 v[178:179], v[178:179], v[16:17], v[26:27]
    v_max_f32 v176, 0, v176
    v_max_f32 v177, 0, v177
    v_max_f32 v178, 0, v178
    v_max_f32 v179, 0, v179
    v_pk_mul_f32 v[176:177], v[176:177], v[176:177]
    v_pk_mul_f32 v[178:179], v[178:179], v[178:179]
    v_cvt_pk_bf16_f32 v52, v176, v177
    v_cvt_pk_bf16_f32 v53, v178, v179
    s_and_b32 s71, s66, 1
    s_cmp_eq_u32 s71, 0
    s_cbranch_scc0 L_DO6115
    buffer_store_dwordx4 v[40:43], v39, s[48:51], s85 offen sc1
    buffer_store_dwordx4 v[44:47], v39, s[48:51], s85 offen offset:1024 sc1
    buffer_store_dwordx4 v[48:51], v39, s[48:51], s85 offen offset:2048 sc1
    buffer_store_dwordx2 v[52:53], v32, s[48:51], s85 offen offset:3072 sc1
    s_branch L_DE6115
L_DO6115:
    buffer_store_dwordx2 v[40:41], v39, s[48:51], s85 offen offset:8 sc1
    buffer_store_dwordx4 v[42:45], v39, s[48:51], s85 offen offset:1024 sc1
    buffer_store_dwordx4 v[46:49], v39, s[48:51], s85 offen offset:2048 sc1
    s_cmp_eq_u32 s67, 1
    s_cbranch_scc1 L_D66115
    buffer_store_dwordx4 v[50:53], v39, s[48:51], s85 offen offset:3072 sc1
    s_branch L_DE6115
L_D66115:
    buffer_store_dwordx2 v[50:51], v39, s[48:51], s85 offen offset:3072 sc1
L_DE6115:
    v_pk_fma_f32 v[24:25], v[96:97], v[22:23], v[188:189]
    v_pk_fma_f32 v[26:27], v[98:99], v[22:23], v[190:191]
    v_pk_fma_f32 v[132:133], v[132:133], v[20:21], v[24:25]
    v_pk_fma_f32 v[134:135], v[134:135], v[20:21], v[26:27]
    v_max_f32 v132, 0, v132
    v_max_f32 v133, 0, v133
    v_max_f32 v134, 0, v134
    v_max_f32 v135, 0, v135
    v_pk_mul_f32 v[132:133], v[132:133], v[132:133]
    v_pk_mul_f32 v[134:135], v[134:135], v[134:135]
    v_cvt_pk_bf16_f32 v54, v132, v133
    v_cvt_pk_bf16_f32 v55, v134, v135
    v_pk_fma_f32 v[24:25], v[100:101], v[22:23], v[192:193]
    v_pk_fma_f32 v[26:27], v[102:103], v[22:23], v[194:195]
    v_pk_fma_f32 v[140:141], v[140:141], v[20:21], v[24:25]
    v_pk_fma_f32 v[142:143], v[142:143], v[20:21], v[26:27]
    v_max_f32 v140, 0, v140
    v_max_f32 v141, 0, v141
    v_max_f32 v142, 0, v142
    v_max_f32 v143, 0, v143
    v_pk_mul_f32 v[140:141], v[140:141], v[140:141]
    v_pk_mul_f32 v[142:143], v[142:143], v[142:143]
    v_cvt_pk_bf16_f32 v56, v140, v141
    v_cvt_pk_bf16_f32 v57, v142, v143
    v_pk_fma_f32 v[24:25], v[104:105], v[22:23], v[196:197]
    v_pk_fma_f32 v[26:27], v[106:107], v[22:23], v[198:199]
    v_pk_fma_f32 v[148:149], v[148:149], v[20:21], v[24:25]
    v_pk_fma_f32 v[150:151], v[150:151], v[20:21], v[26:27]
    v_max_f32 v148, 0, v148
    v_max_f32 v149, 0, v149
    v_max_f32 v150, 0, v150
    v_max_f32 v151, 0, v151
    v_pk_mul_f32 v[148:149], v[148:149], v[148:149]
    v_pk_mul_f32 v[150:151], v[150:151], v[150:151]
    v_cvt_pk_bf16_f32 v58, v148, v149
    v_cvt_pk_bf16_f32 v59, v150, v151
    v_pk_fma_f32 v[24:25], v[108:109], v[22:23], v[200:201]
    v_pk_fma_f32 v[26:27], v[110:111], v[22:23], v[202:203]
    v_pk_fma_f32 v[156:157], v[156:157], v[20:21], v[24:25]
    v_pk_fma_f32 v[158:159], v[158:159], v[20:21], v[26:27]
    v_max_f32 v156, 0, v156
    v_max_f32 v157, 0, v157
    v_max_f32 v158, 0, v158
    v_max_f32 v159, 0, v159
    v_pk_mul_f32 v[156:157], v[156:157], v[156:157]
    v_pk_mul_f32 v[158:159], v[158:159], v[158:159]
    v_cvt_pk_bf16_f32 v60, v156, v157
    v_cvt_pk_bf16_f32 v61, v158, v159
    v_pk_fma_f32 v[24:25], v[112:113], v[22:23], v[204:205]
    v_pk_fma_f32 v[26:27], v[114:115], v[22:23], v[206:207]
    v_pk_fma_f32 v[164:165], v[164:165], v[20:21], v[24:25]
    v_pk_fma_f32 v[166:167], v[166:167], v[20:21], v[26:27]
    v_max_f32 v164, 0, v164
    v_max_f32 v165, 0, v165
    v_max_f32 v166, 0, v166
    v_max_f32 v167, 0, v167
    v_pk_mul_f32 v[164:165], v[164:165], v[164:165]
    v_pk_mul_f32 v[166:167], v[166:167], v[166:167]
    v_cvt_pk_bf16_f32 v62, v164, v165
    v_cvt_pk_bf16_f32 v63, v166, v167
    v_pk_fma_f32 v[24:25], v[116:117], v[22:23], v[208:209]
    v_pk_fma_f32 v[26:27], v[118:119], v[22:23], v[210:211]
    v_pk_fma_f32 v[172:173], v[172:173], v[20:21], v[24:25]
    v_pk_fma_f32 v[174:175], v[174:175], v[20:21], v[26:27]
    v_max_f32 v172, 0, v172
    v_max_f32 v173, 0, v173
    v_max_f32 v174, 0, v174
    v_max_f32 v175, 0, v175
    v_pk_mul_f32 v[172:173], v[172:173], v[172:173]
    v_pk_mul_f32 v[174:175], v[174:175], v[174:175]
    v_cvt_pk_bf16_f32 v64, v172, v173
    v_cvt_pk_bf16_f32 v65, v174, v175
    v_pk_fma_f32 v[24:25], v[120:121], v[22:23], v[212:213]
    v_pk_fma_f32 v[26:27], v[122:123], v[22:23], v[214:215]
    v_pk_fma_f32 v[180:181], v[180:181], v[20:21], v[24:25]
    v_pk_fma_f32 v[182:183], v[182:183], v[20:21], v[26:27]
    v_max_f32 v180, 0, v180
    v_max_f32 v181, 0, v181
    v_max_f32 v182, 0, v182
    v_max_f32 v183, 0, v183
    v_pk_mul_f32 v[180:181], v[180:181], v[180:181]
    v_pk_mul_f32 v[182:183], v[182:183], v[182:183]
    v_cvt_pk_bf16_f32 v66, v180, v181
    v_cvt_pk_bf16_f32 v67, v182, v183
    s_and_b32 s71, s66, 1
    s_cmp_eq_u32 s71, 0
    s_cbranch_scc0 L_DO6218
    buffer_store_dwordx4 v[54:57], v39, s[48:51], s86 offen sc1
    buffer_store_dwordx4 v[58:61], v39, s[48:51], s86 offen offset:1024 sc1
    buffer_store_dwordx4 v[62:65], v39, s[48:51], s86 offen offset:2048 sc1
    buffer_store_dwordx2 v[66:67], v32, s[48:51], s86 offen offset:3072 sc1
    s_branch L_DE6218
L_DO6218:
    buffer_store_dwordx2 v[54:55], v39, s[48:51], s86 offen offset:8 sc1
    buffer_store_dwordx4 v[56:59], v39, s[48:51], s86 offen offset:1024 sc1
    buffer_store_dwordx4 v[60:63], v39, s[48:51], s86 offen offset:2048 sc1
    s_cmp_eq_u32 s67, 1
    s_cbranch_scc1 L_D66218
    buffer_store_dwordx4 v[64:67], v39, s[48:51], s86 offen offset:3072 sc1
    s_branch L_DE6218
L_D66218:
    buffer_store_dwordx2 v[64:65], v39, s[48:51], s86 offen offset:3072 sc1
L_DE6218:
    s_add_u32 s79, s59, 0
    s_lshr_b32 s78, s79, 1
    s_and_b32 s79, s79, 1
    s_mul_i32 s77, s79, 27
    s_add_u32 s77, s77, s78
    s_mul_i32 s79, s79, 14
    s_add_u32 s78, s78, s79
    s_mul_i32 s77, s77, 5120
    s_mul_i32 s76, s64, 276480
    s_add_u32 s77, s77, s76
    s_add_u32 s77, s77, 18833408
    s_mul_i32 s78, s78, 5120
    s_mov_b32 m0, s78
    s_nop 0
    buffer_load_dwordx4 v39, s[48:51], s77 offen offset:0 sc1 lds
    buffer_load_dwordx4 v39, s[48:51], s77 offen offset:1024 sc1 lds
    buffer_load_dwordx4 v39, s[48:51], s77 offen offset:2048 sc1 lds
    buffer_load_dwordx4 v39, s[48:51], s77 offen offset:3072 sc1 lds
    s_add_u32 m0, s78, 4096
    s_add_u32 s77, s77, 4096
    buffer_load_dwordx4 v39, s[48:51], s77 offen sc1 lds
    s_add_u32 s79, s59, 4
    s_lshr_b32 s78, s79, 1
    s_and_b32 s79, s79, 1
    s_mul_i32 s77, s79, 27
    s_branch L_PSK10
L_PAD10:
    s_setpc_b64 s[100:101]
L_PSK10:
    s_add_u32 s77, s77, s78
    s_mul_i32 s79, s79, 14
    s_add_u32 s78, s78, s79
    s_mul_i32 s77, s77, 5120
    s_mul_i32 s76, s64, 276480
    s_add_u32 s77, s77, s76
    s_add_u32 s77, s77, 18833408
    s_mul_i32 s78, s78, 5120
    s_mov_b32 m0, s78
    s_nop 0
    buffer_load_dwordx4 v39, s[48:51], s77 offen offset:0 sc1 lds
    buffer_load_dwordx4 v39, s[48:51], s77 offen offset:1024 sc1 lds
    buffer_load_dwordx4 v39, s[48:51], s77 offen offset:2048 sc1 lds
    buffer_load_dwordx4 v39, s[48:51], s77 offen offset:3072 sc1 lds
    s_add_u32 m0, s78, 4096
    s_add_u32 s77, s77, 4096
    buffer_load_dwordx4 v39, s[48:51], s77 offen sc1 lds
    s_waitcnt vmcnt(10)
    s_barrier
    s_cmp_lg_u32 s59, 0
    s_cbranch_scc1 L_SF6281
    s_lshl_b32 s70, s57, 7
    s_lshl_b32 s71, s58, 2
    s_add_u32 s70, s70, s71
    s_add_u32 s70, s70, 8192
    v_mov_b32 v248, s56
    v_mov_b32 v249, 0
    s_mov_b64 exec, 1
    buffer_store_dword v248, v249, s[48:51], s70 offen sc1
    s_mov_b64 exec, -1
L_SF6281:
    s_cmp_eq_u32 s59, 0
    s_cbranch_scc1 L_W26293
    s_add_u32 s79, s59, 7
    s_min_u32 s79, s79, 27
    s_lshr_b32 s78, s79, 1
    s_and_b32 s79, s79, 1
    s_mul_i32 s77, s79, 27
    s_add_u32 s77, s77, s78
    s_mul_i32 s79, s79, 14
    s_add_u32 s78, s78, s79
    s_mul_i32 s77, s77, 5120
    s_mul_i32 s76, s64, 276480
    s_add_u32 s77, s77, s76
    s_add_u32 s77, s77, 18833408
    s_mul_i32 s78, s78, 5120
    s_mov_b32 m0, s78
    s_nop 0
    buffer_load_dwordx4 v39, s[48:51], s77 offen offset:0 sc1 lds
    buffer_load_dwordx4 v39, s[48:51], s77 offen offset:1024 sc1 lds
    buffer_load_dwordx4 v39, s[48:51], s77 offen offset:2048 sc1 lds
    buffer_load_dwordx4 v39, s[48:51], s77 offen offset:3072 sc1 lds
    s_add_u32 m0, s78, 4096
    s_add_u32 s77, s77, 4096
    buffer_load_dwordx4 v39, s[48:51], s77 offen sc1 lds
    s_add_u32 s79, s59, 10
    s_min_u32 s79, s79, 27
    s_lshr_b32 s78, s79, 1
    s_and_b32 s79, s79, 1
    s_mul_i32 s77, s79, 27
    s_add_u32 s77, s77, s78
    s_mul_i32 s79, s79, 14
    s_add_u32 s78, s78, s79
    s_mul_i32 s77, s77, 5120
    s_mul_i32 s76, s64, 276480
    s_add_u32 s77, s77, s76
    s_add_u32 s77, s77, 18833408
    s_mul_i32 s78, s78, 5120
    s_mov_b32 m0, s78
    s_nop 0
    buffer_load_dwordx4 v39, s[48:51], s77 offen offset:0 sc1 lds
    buffer_load_dwordx4 v39, s[48:51], s77 offen offset:1024 sc1 lds
    buffer_load_dwordx4 v39, s[48:51], s77 offen offset:2048 sc1 lds
    buffer_load_dwordx4 v39, s[48:51], s77 offen offset:3072 sc1 lds
    s_add_u32 m0, s78, 4096
    s_add_u32 s77, s77, 4096
    buffer_load_dwordx4 v39, s[48:51], s77 offen sc1 lds
    s_add_u32 s79, s59, 13
    s_min_u32 s79, s79, 27
    s_lshr_b32 s78, s79, 1
    s_and_b32 s79, s79, 1
    s_mul_i32 s77, s79, 27
    s_add_u32 s77, s77, s78
    s_mul_i32 s79, s79, 14
    s_add_u32 s78, s78, s79
    s_mul_i32 s77, s77, 5120
    s_mul_i32 s76, s64, 276480
    s_add_u32 s77, s77, s76
    s_add_u32 s77, s77, 18833408
    s_mul_i32 s78, s78, 5120
    s_mov_b32 m0, s78
    s_nop 0
    buffer_load_dwordx4 v39, s[48:51], s77 offen offset:0 sc1 lds
    buffer_load_dwordx4 v39, s[48:51], s77 offen offset:1024 sc1 lds
    buffer_load_dwordx4 v39, s[48:51], s77 offen offset:2048 sc1 lds
    buffer_load_dwordx4 v39, s[48:51], s77 offen offset:3072 sc1 lds
    s_add_u32 m0, s78, 4096
    s_add_u32 s77, s77, 4096
    buffer_load_dwordx4 v39, s[48:51], s77 offen sc1 lds
    s_add_u32 s79, s59, 16
    s_min_u32 s79, s79, 27
    s_lshr_b32 s78, s79, 1
    s_and_b32 s79, s79, 1
    s_mul_i32 s77, s79, 27
    s_add_u32 s77, s77, s78
    s_mul_i32 s79, s79, 14
    s_add_u32 s78, s78, s79
    s_mul_i32 s77, s77, 5120
    s_mul_i32 s76, s64, 276480
    s_add_u32 s77, s77, s76
    s_add_u32 s77, s77, 18833408
    s_mul_i32 s78, s78, 5120
    s_mov_b32 m0, s78
    s_nop 0
    buffer_load_dwordx4 v39, s[48:51], s77 offen offset:0 sc1 lds
    buffer_load_dwordx4 v39, s[48:51], s77 offen offset:1024 sc1 lds
    buffer_load_dwordx4 v39, s[48:51], s77 offen offset:2048 sc1 lds
    buffer_load_dwordx4 v39, s[48:51], s77 offen offset:3072 sc1 lds
    s_add_u32 m0, s78, 4096
    s_add_u32 s77, s77, 4096
    buffer_load_dwordx4 v39, s[48:51], s77 offen sc1 lds
    s_add_u32 s79, s59, 19
    s_min_u32 s79, s79, 27
    s_lshr_b32 s78, s79, 1
    s_and_b32 s79, s79, 1
    s_mul_i32 s77, s79, 27
    s_add_u32 s77, s77, s78
    s_mul_i32 s79, s79, 14
    s_add_u32 s78, s78, s79
    s_mul_i32 s77, s77, 5120
    s_mul_i32 s76, s64, 276480
    s_add_u32 s77, s77, s76
    s_add_u32 s77, s77, 18833408
    s_mul_i32 s78, s78, 5120
    s_mov_b32 m0, s78
    s_nop 0
    buffer_load_dwordx4 v39, s[48:51], s77 offen offset:0 sc1 lds
    buffer_load_dwordx4 v39, s[48:51], s77 offen offset:1024 sc1 lds
    buffer_load_dwordx4 v39, s[48:51], s77 offen offset:2048 sc1 lds
    buffer_load_dwordx4 v39, s[48:51], s77 offen offset:3072 sc1 lds
    s_add_u32 m0, s78, 4096
    s_add_u32 s77, s77, 4096
    buffer_load_dwordx4 v39, s[48:51], s77 offen sc1 lds
    s_add_u32 s79, s59, 22
    s_min_u32 s79, s79, 27
    s_lshr_b32 s78, s79, 1
    s_and_b32 s79, s79, 1
    s_mul_i32 s77, s79, 27
    s_add_u32 s77, s77, s78
    s_mul_i32 s79, s79, 14
    s_add_u32 s78, s78, s79
    s_mul_i32 s77, s77, 5120
    s_mul_i32 s76, s64, 276480
    s_add_u32 s77, s77, s76
    s_add_u32 s77, s77, 18833408
    s_mul_i32 s78, s78, 5120
    s_mov_b32 m0, s78
    s_nop 0
    buffer_load_dwordx4 v39, s[48:51], s77 offen offset:0 sc1 lds
    buffer_load_dwordx4 v39, s[48:51], s77 offen offset:1024 sc1 lds
    buffer_load_dwordx4 v39, s[48:51], s77 offen offset:2048 sc1 lds
    buffer_load_dwordx4 v39, s[48:51], s77 offen offset:3072 sc1 lds
    s_add_u32 m0, s78, 4096
    s_add_u32 s77, s77, 4096
    buffer_load_dwordx4 v39, s[48:51], s77 offen sc1 lds
    s_add_u32 s79, s59, 25
    s_min_u32 s79, s79, 27
    s_lshr_b32 s78, s79, 1
    s_and_b32 s79, s79, 1
    s_mul_i32 s77, s79, 27
    s_add_u32 s77, s77, s78
    s_mul_i32 s79, s79, 14
    s_add_u32 s78, s78, s79
    s_mul_i32 s77, s77, 5120
    s_mul_i32 s76, s64, 276480
    s_add_u32 s77, s77, s76
    s_add_u32 s77, s77, 18833408
    s_mul_i32 s78, s78, 5120
    s_mov_b32 m0, s78
    s_nop 0
    buffer_load_dwordx4 v39, s[48:51], s77 offen offset:0 sc1 lds
    buffer_load_dwordx4 v39, s[48:51], s77 offen offset:1024 sc1 lds
    buffer_load_dwordx4 v39, s[48:51], s77 offen offset:2048 sc1 lds
    buffer_load_dwordx4 v39, s[48:51], s77 offen offset:3072 sc1 lds
    s_add_u32 m0, s78, 4096
    s_add_u32 s77, s77, 4096
    buffer_load_dwordx4 v39, s[48:51], s77 offen sc1 lds
L_W26293:
    v_lshrrev_b32 v2, 4, v1
    v_bfe_u32 v3, v1, 2, 2
    v_lshl_add_u32 v2, v2, 2, v3
    v_mul_u32_u24 v2, 160, v2
    v_and_b32 v3, 3, v1
    v_lshl_add_u32 v36, v3, 3, v2
    s_mul_i32 s70, s63, 71680
    v_add_u32 v36, s70, v36
    v_add_u32 v35, 35840, v36
    s_mul_i32 s71, s62, 5120
    s_add_u32 s70, s70, s71
    v_add_u32 v32, s70, v39
    s_mul_i32 s76, s63, 71680
    s_add_u32 s70, s76, 61440
    v_add_u32 v31, s70, v39
    s_mul_i32 s75, s63, 138240
    s_mul_i32 s71, s64, 276480
    s_add_u32 s75, s75, s71
    s_add_u32 s75, s75, 18833408
    v_lshrrev_b32 v3, 4, v1
    v_lshlrev_b32 v4, 3, v3
    s_mul_i32 s71, s64, 160
    v_add_u32 v33, s71, v4
    v_lshlrev_b32 v3, 4, v3
    s_mul_i32 s71, s64, 320
    v_add_u32 v37, s71, v3
    s_mul_i32 s70, s63, 27648
    s_add_u32 s70, s70, 11755520
    s_mul_i32 s72, s65, 55296
    s_add_u32 s72, s72, s70
    s_xor_b32 s73, s65, 1
    s_mul_i32 s73, s73, 55296
    s_add_u32 s73, s73, s70
    s_mov_b32 s74, 37376
    v_and_b32 v2, 15, v1
    s_lshl_b32 s70, s65, 4
    v_add_u32 v2, s70, v2
    v_mul_u32_u24 v2, 1280, v2
    v_lshrrev_b32 v3, 4, v1
    s_mul_i32 s71, s64, 160
    v_lshl_add_u32 v2, v3, 3, v2
    v_add_u32 v34, s71, v2
    s_cmp_lg_u32 s59, 0
    s_cbranch_scc1 L_PD6492
    s_lshl_b32 s70, s57, 7
    s_add_u32 s70, s70, 8192
    s_mov_b32 s71, 1048576
    v_min_u32 v248, 15, v1
    v_lshlrev_b32 v248, 2, v248
L_PL6492:
    buffer_load_dword v250, v248, s[48:51], s70 offen sc1
    s_waitcnt vmcnt(0)
    v_cmp_ne_u32 vcc, s56, v250
    s_sub_u32 s71, s71, 1
    s_cmp_eq_u32 s71, 0
    s_cbranch_scc1 L_PT6492
    s_cbranch_vccnz L_PL6492
    s_branch L_PD6492
L_PT6492:
    v_mov_b32 v250, 224
    v_mov_b32 v251, 0
    buffer_store_dword v250, v251, s[52:55], 0 offen
    s_waitcnt vmcnt(0)
L_PD6492:
    s_barrier
    buffer_load_dwordx4 a[0:3], v39, s[48:51], s72 offen offset:0 sc1
    buffer_load_dwordx4 a[4:7], v39, s[48:51], s73 offen offset:0 sc1
    buffer_load_dwordx4 a[8:11], v39, s[48:51], s72 offen offset:1024 sc1
    buffer_load_dwordx4 a[12:15], v39, s[48:51], s73 offen offset:1024 sc1
    buffer_load_dwordx4 a[16:19], v39, s[48:51], s72 offen offset:2048 sc1
    buffer_load_dwordx4 a[20:23], v39, s[48:51], s73 offen offset:2048 sc1
    buffer_load_dwordx4 a[24:27], v39, s[48:51], s72 offen offset:3072 sc1
    buffer_load_dwordx4 a[28:31], v39, s[48:51], s73 offen offset:3072 sc1
    s_add_u32 s72, s72, 4096
    s_add_u32 s73, s73, 4096
    buffer_load_dwordx4 a[32:35], v39, s[48:51], s72 offen offset:0 sc1
    buffer_load_dwordx4 a[36:39], v39, s[48:51], s73 offen offset:0 sc1
    buffer_load_dwordx4 a[40:43], v39, s[48:51], s72 offen offset:1024 sc1
    buffer_load_dwordx4 a[44:47], v39, s[48:51], s73 offen offset:1024 sc1
    buffer_load_dwordx4 a[48:51], v39, s[48:51], s72 offen offset:2048 sc1
    buffer_load_dwordx4 a[52:55], v39, s[48:51], s73 offen offset:2048 sc1
    buffer_load_dwordx4 a[56:59], v39, s[48:51], s72 offen offset:3072 sc1
    buffer_load_dwordx4 a[60:63], v39, s[48:51], s73 offen offset:3072 sc1
    s_add_u32 s72, s72, 4096
    s_add_u32 s73, s73, 4096
    s_waitcnt vmcnt(16)
    s_barrier
    ds_read_b64_tr_b16 v[40:41], v36 offset:0
    ds_read_b64_tr_b16 v[42:43], v36 offset:2560
    ds_read_b64_tr_b16 v[44:45], v36 offset:32
    ds_read_b64_tr_b16 v[46:47], v36 offset:2592
    ds_read_b64_tr_b16 v[48:49], v36 offset:64
    ds_read_b64_tr_b16 v[50:51], v36 offset:2624
    ds_read_b64_tr_b16 v[52:53], v36 offset:96
    ds_read_b64_tr_b16 v[54:55], v36 offset:2656
    ds_read_b64_tr_b16 v[56:57], v36 offset:128
    ds_read_b64_tr_b16 v[58:59], v36 offset:2688
    s_waitcnt vmcnt(14)
    s_waitcnt lgkmcnt(6)
    v_mfma_f32_16x16x32_bf16 v[128:131], v[40:43], a[0:3], 0
    ds_read_b64_tr_b16 v[60:61], v36 offset:5120
    v_mfma_f32_16x16x32_bf16 v[132:135], v[40:43], a[4:7], 0
    ds_read_b64_tr_b16 v[62:63], v36 offset:7680
    buffer_load_dwordx4 a[64:67], v39, s[48:51], s72 offen offset:0 sc1
    v_mfma_f32_16x16x32_bf16 v[136:139], v[44:47], a[0:3], 0
    ds_read_b64_tr_b16 v[64:65], v36 offset:5152
    v_mfma_f32_16x16x32_bf16 v[140:143], v[44:47], a[4:7], 0
    ds_read_b64_tr_b16 v[66:67], v36 offset:7712
    buffer_load_dwordx4 a[68:71], v39, s[48:51], s73 offen offset:0 sc1
    s_waitcnt lgkmcnt(4)
    v_mfma_f32_16x16x32_bf16 v[144:147], v[48:51], a[0:3], 0
    ds_read_b64_tr_b16 v[68:69], v36 offset:5184
    v_mfma_f32_16x16x32_bf16 v[148:151], v[48:51], a[4:7], 0
    ds_read_b64_tr_b16 v[70:71], v36 offset:7744
    v_mfma_f32_16x16x32_bf16 v[152:155], v[52:55], a[0:3], 0
    ds_read_b64_tr_b16 v[72:73], v36 offset:5216
    v_mfma_f32_16x16x32_bf16 v[156:159], v[52:55], a[4:7], 0
    ds_read_b64_tr_b16 v[74:75], v36 offset:7776
    v_mfma_f32_16x16x32_bf16 v[160:163], v[56:59], a[0:3], 0
    ds_read_b64_tr_b16 v[76:77], v36 offset:5248
    v_mfma_f32_16x16x32_bf16 v[164:167], v[56:59], a[4:7], 0
    ds_read_b64_tr_b16 v[78:79], v36 offset:7808
    s_waitcnt vmcnt(14)
    s_waitcnt lgkmcnt(6)
    v_mfma_f32_16x16x32_bf16 v[128:131], v[60:63], a[8:11], v[128:131]
    ds_read_b64_tr_b16 v[40:41], v36 offset:10240
    v_mfma_f32_16x16x32_bf16 v[132:135], v[60:63], a[12:15], v[132:135]
    ds_read_b64_tr_b16 v[42:43], v36 offset:12800
    buffer_load_dwordx4 a[72:75], v39, s[48:51], s72 offen offset:1024 sc1
    v_mfma_f32_16x16x32_bf16 v[136:139], v[64:67], a[8:11], v[136:139]
    ds_read_b64_tr_b16 v[44:45], v36 offset:10272
    v_mfma_f32_16x16x32_bf16 v[140:143], v[64:67], a[12:15], v[140:143]
    ds_read_b64_tr_b16 v[46:47], v36 offset:12832
    buffer_load_dwordx4 a[76:79], v39, s[48:51], s73 offen offset:1024 sc1
    s_waitcnt lgkmcnt(4)
    v_mfma_f32_16x16x32_bf16 v[144:147], v[68:71], a[8:11], v[144:147]
    ds_read_b64_tr_b16 v[48:49], v36 offset:10304
    v_mfma_f32_16x16x32_bf16 v[148:151], v[68:71], a[12:15], v[148:151]
    ds_read_b64_tr_b16 v[50:51], v36 offset:12864
    v_mfma_f32_16x16x32_bf16 v[152:155], v[72:75], a[8:11], v[152:155]
    ds_read_b64_tr_b16 v[52:53], v36 offset:10336
    v_mfma_f32_16x16x32_bf16 v[156:159], v[72:75], a[12:15], v[156:159]
    ds_read_b64_tr_b16 v[54:55], v36 offset:12896
    v_mfma_f32_16x16x32_bf16 v[160:163], v[76:79], a[8:11], v[160:163]
    ds_read_b64_tr_b16 v[56:57], v36 offset:10368
    v_mfma_f32_16x16x32_bf16 v[164:167], v[76:79], a[12:15], v[164:167]
    ds_read_b64_tr_b16 v[58:59], v36 offset:12928
    s_waitcnt vmcnt(14)
    s_waitcnt lgkmcnt(6)
    v_mfma_f32_16x16x32_bf16 v[128:131], v[40:43], a[16:19], v[128:131]
    ds_read_b64_tr_b16 v[60:61], v36 offset:15360
    v_mfma_f32_16x16x32_bf16 v[132:135], v[40:43], a[20:23], v[132:135]
    ds_read_b64_tr_b16 v[62:63], v36 offset:17920
    buffer_load_dwordx4 a[80:83], v39, s[48:51], s72 offen offset:2048 sc1
    v_mfma_f32_16x16x32_bf16 v[136:139], v[44:47], a[16:19], v[136:139]
    ds_read_b64_tr_b16 v[64:65], v36 offset:15392
    v_mfma_f32_16x16x32_bf16 v[140:143], v[44:47], a[20:23], v[140:143]
    ds_read_b64_tr_b16 v[66:67], v36 offset:17952
    buffer_load_dwordx4 a[84:87], v39, s[48:51], s73 offen offset:2048 sc1
    s_waitcnt lgkmcnt(4)
    v_mfma_f32_16x16x32_bf16 v[144:147], v[48:51], a[16:19], v[144:147]
    ds_read_b64_tr_b16 v[68:69], v36 offset:15424
    v_mfma_f32_16x16x32_bf16 v[148:151], v[48:51], a[20:23], v[148:151]
    ds_read_b64_tr_b16 v[70:71], v36 offset:17984
    v_mfma_f32_16x16x32_bf16 v[152:155], v[52:55], a[16:19], v[152:155]
    ds_read_b64_tr_b16 v[72:73], v36 offset:15456
    v_mfma_f32_16x16x32_bf16 v[156:159], v[52:55], a[20:23], v[156:159]
    ds_read_b64_tr_b16 v[74:75], v36 offset:18016
    v_mfma_f32_16x16x32_bf16 v[160:163], v[56:59], a[16:19], v[160:163]
    ds_read_b64_tr_b16 v[76:77], v36 offset:15488
    v_mfma_f32_16x16x32_bf16 v[164:167], v[56:59], a[20:23], v[164:167]
    ds_read_b64_tr_b16 v[78:79], v36 offset:18048
    s_waitcnt vmcnt(14)
    s_barrier
    s_waitcnt lgkmcnt(6)
    v_mfma_f32_16x16x32_bf16 v[128:131], v[60:63], a[24:27], v[128:131]
    ds_read_b64_tr_b16 v[40:41], v36 offset:20480
    v_mfma_f32_16x16x32_bf16 v[132:135], v[60:63], a[28:31], v[132:135]
    ds_read_b64_tr_b16 v[42:43], v36 offset:23040
    buffer_load_dwordx4 a[88:91], v39, s[48:51], s72 offen offset:3072 sc1
    v_mfma_f32_16x16x32_bf16 v[136:139], v[64:67], a[24:27], v[136:139]
    ds_read_b64_tr_b16 v[44:45], v36 offset:20512
    v_mfma_f32_16x16x32_bf16 v[140:143], v[64:67], a[28:31], v[140:143]
    ds_read_b64_tr_b16 v[46:47], v36 offset:23072
    buffer_load_dwordx4 a[92:95], v39, s[48:51], s73 offen offset:3072 sc1
    s_add_u32 s72, s72, 4096
    s_add_u32 s73, s73, 4096
    s_waitcnt lgkmcnt(4)
    v_mfma_f32_16x16x32_bf16 v[144:147], v[68:71], a[24:27], v[144:147]
    ds_read_b64_tr_b16 v[48:49], v36 offset:20544
    v_mfma_f32_16x16x32_bf16 v[148:151], v[68:71], a[28:31], v[148:151]
    ds_read_b64_tr_b16 v[50:51], v36 offset:23104
    s_add_u32 s79, s62, 14
    s_min_u32 s79, s79, 26
    s_mul_i32 s77, s79, 5120
    s_add_u32 s77, s77, s75
    s_sub_u32 s78, s79, 14
    s_mul_i32 s78, s78, 5120
    s_add_u32 s78, s78, s76
    s_mov_b32 m0, s78
    s_add_u32 s79, s77, 4096
    buffer_load_dwordx4 v39, s[48:51], s77 offen offset:3072 sc1 lds
    v_mfma_f32_16x16x32_bf16 v[152:155], v[72:75], a[24:27], v[152:155]
    ds_read_b64_tr_b16 v[52:53], v36 offset:20576
    v_mfma_f32_16x16x32_bf16 v[156:159], v[72:75], a[28:31], v[156:159]
    ds_read_b64_tr_b16 v[54:55], v36 offset:23136
    s_add_u32 m0, s78, 4096
    s_nop 0
    buffer_load_dwordx4 v39, s[48:51], s79 offen sc1 lds
    v_mfma_f32_16x16x32_bf16 v[160:163], v[76:79], a[24:27], v[160:163]
    ds_read_b64_tr_b16 v[56:57], v36 offset:20608
    v_mfma_f32_16x16x32_bf16 v[164:167], v[76:79], a[28:31], v[164:167]
    ds_read_b64_tr_b16 v[58:59], v36 offset:23168
    ds_write_b128 v32, a[128:131] offset:0
    ds_write_b128 v32, a[132:135] offset:1024
    ds_write_b128 v32, a[136:139] offset:2048
    s_waitcnt vmcnt(16)
    s_waitcnt lgkmcnt(9)
    v_mfma_f32_16x16x32_bf16 v[128:131], v[40:43], a[32:35], v[128:131]
    ds_read_b64_tr_b16 v[60:61], v36 offset:25600
    v_mfma_f32_16x16x32_bf16 v[132:135], v[40:43], a[36:39], v[132:135]
    ds_read_b64_tr_b16 v[62:63], v36 offset:28160
    buffer_load_dwordx4 a[96:99], v39, s[48:51], s72 offen offset:0 sc1
    v_mfma_f32_16x16x32_bf16 v[136:139], v[44:47], a[32:35], v[136:139]
    ds_read_b64_tr_b16 v[64:65], v36 offset:25632
    v_mfma_f32_16x16x32_bf16 v[140:143], v[44:47], a[36:39], v[140:143]
    ds_read_b64_tr_b16 v[66:67], v36 offset:28192
    buffer_load_dwordx4 a[100:103], v39, s[48:51], s73 offen offset:0 sc1
    s_waitcnt lgkmcnt(7)
    v_mfma_f32_16x16x32_bf16 v[144:147], v[48:51], a[32:35], v[144:147]
    ds_read_b64_tr_b16 v[68:69], v36 offset:25664
    v_mfma_f32_16x16x32_bf16 v[148:151], v[48:51], a[36:39], v[148:151]
    ds_read_b64_tr_b16 v[70:71], v36 offset:28224
    v_mfma_f32_16x16x32_bf16 v[152:155], v[52:55], a[32:35], v[152:155]
    ds_read_b64_tr_b16 v[72:73], v36 offset:25696
    v_mfma_f32_16x16x32_bf16 v[156:159], v[52:55], a[36:39], v[156:159]
    ds_read_b64_tr_b16 v[74:75], v36 offset:28256
    v_mfma_f32_16x16x32_bf16 v[160:163], v[56:59], a[32:35], v[160:163]
    ds_read_b64_tr_b16 v[76:77], v36 offset:25728
    v_mfma_f32_16x16x32_bf16 v[164:167], v[56:59], a[36:39], v[164:167]
    ds_read_b64_tr_b16 v[78:79], v36 offset:28288
    s_waitcnt vmcnt(16)
    s_barrier
    s_waitcnt lgkmcnt(6)
    v_mfma_f32_16x16x32_bf16 v[128:131], v[60:63], a[40:43], v[128:131]
    ds_read_b64_tr_b16 v[40:41], v36 offset:30720
    v_mfma_f32_16x16x32_bf16 v[132:135], v[60:63], a[44:47], v[132:135]
    ds_read_b64_tr_b16 v[42:43], v36 offset:33280
    buffer_load_dwordx4 a[104:107], v39, s[48:51], s72 offen offset:1024 sc1
    v_mfma_f32_16x16x32_bf16 v[136:139], v[64:67], a[40:43], v[136:139]
    ds_read_b64_tr_b16 v[44:45], v36 offset:30752
    v_mfma_f32_16x16x32_bf16 v[140:143], v[64:67], a[44:47], v[140:143]
    ds_read_b64_tr_b16 v[46:47], v36 offset:33312
    buffer_load_dwordx4 a[108:111], v39, s[48:51], s73 offen offset:1024 sc1
    s_waitcnt lgkmcnt(4)
    v_mfma_f32_16x16x32_bf16 v[144:147], v[68:71], a[40:43], v[144:147]
    ds_read_b64_tr_b16 v[48:49], v36 offset:30784
    v_mfma_f32_16x16x32_bf16 v[148:151], v[68:71], a[44:47], v[148:151]
    ds_read_b64_tr_b16 v[50:51], v36 offset:33344
    s_add_u32 s79, s62, 16
    s_min_u32 s79, s79, 26
    s_mul_i32 s77, s79, 5120
    s_add_u32 s77, s77, s75
    s_sub_u32 s78, s79, 14
    s_mul_i32 s78, s78, 5120
    s_add_u32 s78, s78, s76
    s_mov_b32 m0, s78
    s_add_u32 s79, s77, 4096
    buffer_load_dwordx4 v39, s[48:51], s77 offen offset:3072 sc1 lds
    v_mfma_f32_16x16x32_bf16 v[152:155], v[72:75], a[40:43], v[152:155]
    ds_read_b64_tr_b16 v[52:53], v36 offset:30816
    v_mfma_f32_16x16x32_bf16 v[156:159], v[72:75], a[44:47], v[156:159]
    ds_read_b64_tr_b16 v[54:55], v36 offset:33376
    s_add_u32 m0, s78, 4096
    s_nop 0
    buffer_load_dwordx4 v39, s[48:51], s79 offen sc1 lds
    v_mfma_f32_16x16x32_bf16 v[160:163], v[76:79], a[40:43], v[160:163]
    ds_read_b64_tr_b16 v[56:57], v36 offset:30848
    v_mfma_f32_16x16x32_bf16 v[164:167], v[76:79], a[44:47], v[164:167]
    ds_read_b64_tr_b16 v[58:59], v36 offset:33408
    ds_write_b128 v32, a[140:143] offset:10240
    ds_write_b128 v32, a[144:147] offset:11264
    ds_write_b128 v32, a[148:151] offset:12288
    s_waitcnt vmcnt(18)
    s_waitcnt lgkmcnt(9)
    v_mfma_f32_16x16x32_bf16 v[128:131], v[40:43], a[48:51], v[128:131]
    ds_read_b64_tr_b16 v[60:61], v35 offset:0
    v_mfma_f32_16x16x32_bf16 v[132:135], v[40:43], a[52:55], v[132:135]
    ds_read_b64_tr_b16 v[62:63], v35 offset:2560
    buffer_load_dwordx4 a[112:115], v39, s[48:51], s72 offen offset:2048 sc1
    v_mfma_f32_16x16x32_bf16 v[136:139], v[44:47], a[48:51], v[136:139]
    ds_read_b64_tr_b16 v[64:65], v35 offset:32
    v_mfma_f32_16x16x32_bf16 v[140:143], v[44:47], a[52:55], v[140:143]
    ds_read_b64_tr_b16 v[66:67], v35 offset:2592
    buffer_load_dwordx4 a[116:119], v39, s[48:51], s73 offen offset:2048 sc1
    s_waitcnt lgkmcnt(7)
    v_mfma_f32_16x16x32_bf16 v[144:147], v[48:51], a[48:51], v[144:147]
    ds_read_b64_tr_b16 v[68:69], v35 offset:64
    v_mfma_f32_16x16x32_bf16 v[148:151], v[48:51], a[52:55], v[148:151]
    ds_read_b64_tr_b16 v[70:71], v35 offset:2624
    v_mfma_f32_16x16x32_bf16 v[152:155], v[52:55], a[48:51], v[152:155]
    ds_read_b64_tr_b16 v[72:73], v35 offset:96
    v_mfma_f32_16x16x32_bf16 v[156:159], v[52:55], a[52:55], v[156:159]
    ds_read_b64_tr_b16 v[74:75], v35 offset:2656
    v_mfma_f32_16x16x32_bf16 v[160:163], v[56:59], a[48:51], v[160:163]
    ds_read_b64_tr_b16 v[76:77], v35 offset:128
    v_mfma_f32_16x16x32_bf16 v[164:167], v[56:59], a[52:55], v[164:167]
    ds_read_b64_tr_b16 v[78:79], v35 offset:2688
    s_waitcnt vmcnt(18)
    s_barrier
    s_waitcnt lgkmcnt(6)
    v_mfma_f32_16x16x32_bf16 v[128:131], v[60:63], a[56:59], v[128:131]
    ds_read_b64_tr_b16 v[40:41], v35 offset:5120
    v_mfma_f32_16x16x32_bf16 v[132:135], v[60:63], a[60:63], v[132:135]
    ds_read_b64_tr_b16 v[42:43], v35 offset:7680
    buffer_load_dwordx4 a[120:123], v39, s[48:51], s72 offen offset:3072 sc1
    v_mfma_f32_16x16x32_bf16 v[136:139], v[64:67], a[56:59], v[136:139]
    ds_read_b64_tr_b16 v[44:45], v35 offset:5152
    v_mfma_f32_16x16x32_bf16 v[140:143], v[64:67], a[60:63], v[140:143]
    ds_read_b64_tr_b16 v[46:47], v35 offset:7712
    buffer_load_dwordx4 a[124:127], v39, s[48:51], s73 offen offset:3072 sc1
    s_add_u32 s72, s72, 4096
    s_add_u32 s73, s73, 4096
    s_waitcnt lgkmcnt(4)
    v_mfma_f32_16x16x32_bf16 v[144:147], v[68:71], a[56:59], v[144:147]
    ds_read_b64_tr_b16 v[48:49], v35 offset:5184
    v_mfma_f32_16x16x32_bf16 v[148:151], v[68:71], a[60:63], v[148:151]
    ds_read_b64_tr_b16 v[50:51], v35 offset:7744
    s_add_u32 s79, s62, 18
    s_min_u32 s79, s79, 26
    s_mul_i32 s77, s79, 5120
    s_add_u32 s77, s77, s75
    s_sub_u32 s78, s79, 14
    s_mul_i32 s78, s78, 5120
    s_add_u32 s78, s78, s76
    s_mov_b32 m0, s78
    s_add_u32 s79, s77, 4096
    buffer_load_dwordx4 v39, s[48:51], s77 offen offset:3072 sc1 lds
    v_mfma_f32_16x16x32_bf16 v[152:155], v[72:75], a[56:59], v[152:155]
    ds_read_b64_tr_b16 v[52:53], v35 offset:5216
    v_mfma_f32_16x16x32_bf16 v[156:159], v[72:75], a[60:63], v[156:159]
    ds_read_b64_tr_b16 v[54:55], v35 offset:7776
    s_add_u32 m0, s78, 4096
    s_nop 0
    buffer_load_dwordx4 v39, s[48:51], s79 offen sc1 lds
    v_mfma_f32_16x16x32_bf16 v[160:163], v[76:79], a[56:59], v[160:163]
    ds_read_b64_tr_b16 v[56:57], v35 offset:5248
    v_mfma_f32_16x16x32_bf16 v[164:167], v[76:79], a[60:63], v[164:167]
    ds_read_b64_tr_b16 v[58:59], v35 offset:7808
    ds_write_b128 v32, a[152:155] offset:20480
    ds_write_b128 v32, a[156:159] offset:21504
    ds_write_b128 v32, a[160:163] offset:22528
    s_waitcnt vmcnt(20)
    s_waitcnt lgkmcnt(9)
    v_mfma_f32_16x16x32_bf16 v[128:131], v[40:43], a[64:67], v[128:131]
    ds_read_b64_tr_b16 v[60:61], v35 offset:10240
    v_mfma_f32_16x16x32_bf16 v[132:135], v[40:43], a[68:71], v[132:135]
    ds_read_b64_tr_b16 v[62:63], v35 offset:12800
    buffer_load_dwordx4 a[0:3], v39, s[48:51], s72 offen offset:0 sc1
    v_mfma_f32_16x16x32_bf16 v[136:139], v[44:47], a[64:67], v[136:139]
    ds_read_b64_tr_b16 v[64:65], v35 offset:10272
    v_mfma_f32_16x16x32_bf16 v[140:143], v[44:47], a[68:71], v[140:143]
    ds_read_b64_tr_b16 v[66:67], v35 offset:12832
    buffer_load_dwordx4 a[4:7], v39, s[48:51], s73 offen offset:0 sc1
    s_waitcnt lgkmcnt(7)
    v_mfma_f32_16x16x32_bf16 v[144:147], v[48:51], a[64:67], v[144:147]
    ds_read_b64_tr_b16 v[68:69], v35 offset:10304
    v_mfma_f32_16x16x32_bf16 v[148:151], v[48:51], a[68:71], v[148:151]
    ds_read_b64_tr_b16 v[70:71], v35 offset:12864
    v_mfma_f32_16x16x32_bf16 v[152:155], v[52:55], a[64:67], v[152:155]
    ds_read_b64_tr_b16 v[72:73], v35 offset:10336
    v_mfma_f32_16x16x32_bf16 v[156:159], v[52:55], a[68:71], v[156:159]
    ds_read_b64_tr_b16 v[74:75], v35 offset:12896
    v_mfma_f32_16x16x32_bf16 v[160:163], v[56:59], a[64:67], v[160:163]
    ds_read_b64_tr_b16 v[76:77], v35 offset:10368
    v_mfma_f32_16x16x32_bf16 v[164:167], v[56:59], a[68:71], v[164:167]
    ds_read_b64_tr_b16 v[78:79], v35 offset:12928
    s_waitcnt vmcnt(20)
    s_barrier
    s_waitcnt lgkmcnt(6)
    v_mfma_f32_16x16x32_bf16 v[128:131], v[60:63], a[72:75], v[128:131]
    ds_read_b64_tr_b16 v[40:41], v35 offset:15360
    v_mfma_f32_16x16x32_bf16 v[132:135], v[60:63], a[76:79], v[132:135]
    ds_read_b64_tr_b16 v[42:43], v35 offset:17920
    buffer_load_dwordx4 a[8:11], v39, s[48:51], s72 offen offset:1024 sc1
    v_mfma_f32_16x16x32_bf16 v[136:139], v[64:67], a[72:75], v[136:139]
    ds_read_b64_tr_b16 v[44:45], v35 offset:15392
    v_mfma_f32_16x16x32_bf16 v[140:143], v[64:67], a[76:79], v[140:143]
    ds_read_b64_tr_b16 v[46:47], v35 offset:17952
    buffer_load_dwordx4 a[12:15], v39, s[48:51], s73 offen offset:1024 sc1
    s_waitcnt lgkmcnt(4)
    v_mfma_f32_16x16x32_bf16 v[144:147], v[68:71], a[72:75], v[144:147]
    ds_read_b64_tr_b16 v[48:49], v35 offset:15424
    v_mfma_f32_16x16x32_bf16 v[148:151], v[68:71], a[76:79], v[148:151]
    ds_read_b64_tr_b16 v[50:51], v35 offset:17984
    s_add_u32 s79, s62, 20
    s_min_u32 s79, s79, 26
    s_mul_i32 s77, s79, 5120
    s_add_u32 s77, s77, s75
    s_sub_u32 s78, s79, 14
    s_mul_i32 s78, s78, 5120
    s_add_u32 s78, s78, s76
    s_mov_b32 m0, s78
    s_add_u32 s79, s77, 4096
    buffer_load_dwordx4 v39, s[48:51], s77 offen offset:3072 sc1 lds
    v_mfma_f32_16x16x32_bf16 v[152:155], v[72:75], a[72:75], v[152:155]
    ds_read_b64_tr_b16 v[52:53], v35 offset:15456
    v_mfma_f32_16x16x32_bf16 v[156:159], v[72:75], a[76:79], v[156:159]
    ds_read_b64_tr_b16 v[54:55], v35 offset:18016
    s_add_u32 m0, s78, 4096
    s_nop 0
    buffer_load_dwordx4 v39, s[48:51], s79 offen sc1 lds
    v_mfma_f32_16x16x32_bf16 v[160:163], v[76:79], a[72:75], v[160:163]
    ds_read_b64_tr_b16 v[56:57], v35 offset:15488
    v_mfma_f32_16x16x32_bf16 v[164:167], v[76:79], a[76:79], v[164:167]
    ds_read_b64_tr_b16 v[58:59], v35 offset:18048
    ds_write_b128 v32, a[164:167] offset:30720
    ds_write_b128 v32, a[168:171] offset:31744
    ds_write_b128 v32, a[172:175] offset:32768
    s_waitcnt vmcnt(22)
    s_waitcnt lgkmcnt(9)
    v_mfma_f32_16x16x32_bf16 v[128:131], v[40:43], a[80:83], v[128:131]
    ds_read_b64_tr_b16 v[60:61], v35 offset:20480
    v_mfma_f32_16x16x32_bf16 v[132:135], v[40:43], a[84:87], v[132:135]
    ds_read_b64_tr_b16 v[62:63], v35 offset:23040
    buffer_load_dwordx4 a[16:19], v39, s[48:51], s72 offen offset:2048 sc1
    v_mfma_f32_16x16x32_bf16 v[136:139], v[44:47], a[80:83], v[136:139]
    s_branch L_PSK11
L_PAD11:
    s_setpc_b64 s[100:101]
L_PSK11:
    ds_read_b64_tr_b16 v[64:65], v35 offset:20512
    v_mfma_f32_16x16x32_bf16 v[140:143], v[44:47], a[84:87], v[140:143]
    ds_read_b64_tr_b16 v[66:67], v35 offset:23072
    buffer_load_dwordx4 a[20:23], v39, s[48:51], s73 offen offset:2048 sc1
    s_waitcnt lgkmcnt(7)
    v_mfma_f32_16x16x32_bf16 v[144:147], v[48:51], a[80:83], v[144:147]
    ds_read_b64_tr_b16 v[68:69], v35 offset:20544
    v_mfma_f32_16x16x32_bf16 v[148:151], v[48:51], a[84:87], v[148:151]
    ds_read_b64_tr_b16 v[70:71], v35 offset:23104
    v_mfma_f32_16x16x32_bf16 v[152:155], v[52:55], a[80:83], v[152:155]
    ds_read_b64_tr_b16 v[72:73], v35 offset:20576
    v_mfma_f32_16x16x32_bf16 v[156:159], v[52:55], a[84:87], v[156:159]
    ds_read_b64_tr_b16 v[74:75], v35 offset:23136
    v_mfma_f32_16x16x32_bf16 v[160:163], v[56:59], a[80:83], v[160:163]
    ds_read_b64_tr_b16 v[76:77], v35 offset:20608
    v_mfma_f32_16x16x32_bf16 v[164:167], v[56:59], a[84:87], v[164:167]
    ds_read_b64_tr_b16 v[78:79], v35 offset:23168
    s_waitcnt vmcnt(22)
    s_barrier
    s_waitcnt lgkmcnt(6)
    v_mfma_f32_16x16x32_bf16 v[128:131], v[60:63], a[88:91], v[128:131]
    ds_read_b64_tr_b16 v[40:41], v35 offset:25600
    v_mfma_f32_16x16x32_bf16 v[132:135], v[60:63], a[92:95], v[132:135]
    ds_read_b64_tr_b16 v[42:43], v35 offset:28160
    buffer_load_dwordx4 a[24:27], v39, s[48:51], s72 offen offset:3072 sc1
    v_mfma_f32_16x16x32_bf16 v[136:139], v[64:67], a[88:91], v[136:139]
    ds_read_b64_tr_b16 v[44:45], v35 offset:25632
    v_mfma_f32_16x16x32_bf16 v[140:143], v[64:67], a[92:95], v[140:143]
    ds_read_b64_tr_b16 v[46:47], v35 offset:28192
    buffer_load_dwordx4 a[28:31], v39, s[48:51], s73 offen offset:3072 sc1
    s_add_u32 s72, s72, 4096
    s_add_u32 s73, s73, 4096
    s_waitcnt lgkmcnt(4)
    v_mfma_f32_16x16x32_bf16 v[144:147], v[68:71], a[88:91], v[144:147]
    ds_read_b64_tr_b16 v[48:49], v35 offset:25664
    v_mfma_f32_16x16x32_bf16 v[148:151], v[68:71], a[92:95], v[148:151]
    ds_read_b64_tr_b16 v[50:51], v35 offset:28224
    s_add_u32 s79, s62, 22
    s_min_u32 s79, s79, 26
    s_mul_i32 s77, s79, 5120
    s_add_u32 s77, s77, s75
    s_sub_u32 s78, s79, 14
    s_mul_i32 s78, s78, 5120
    s_add_u32 s78, s78, s76
    s_mov_b32 m0, s78
    s_add_u32 s79, s77, 4096
    buffer_load_dwordx4 v39, s[48:51], s77 offen offset:3072 sc1 lds
    v_mfma_f32_16x16x32_bf16 v[152:155], v[72:75], a[88:91], v[152:155]
    ds_read_b64_tr_b16 v[52:53], v35 offset:25696
    v_mfma_f32_16x16x32_bf16 v[156:159], v[72:75], a[92:95], v[156:159]
    ds_read_b64_tr_b16 v[54:55], v35 offset:28256
    s_add_u32 m0, s78, 4096
    s_nop 0
    buffer_load_dwordx4 v39, s[48:51], s79 offen sc1 lds
    v_mfma_f32_16x16x32_bf16 v[160:163], v[76:79], a[88:91], v[160:163]
    ds_read_b64_tr_b16 v[56:57], v35 offset:25728
    v_mfma_f32_16x16x32_bf16 v[164:167], v[76:79], a[92:95], v[164:167]
    ds_read_b64_tr_b16 v[58:59], v35 offset:28288
    ds_write_b128 v32, a[176:179] offset:40960
    ds_write_b128 v32, a[180:183] offset:41984
    ds_write_b128 v32, a[184:187] offset:43008
    s_waitcnt vmcnt(22)
    s_waitcnt lgkmcnt(9)
    v_mfma_f32_16x16x32_bf16 v[128:131], v[40:43], a[96:99], v[128:131]
    ds_read_b64_tr_b16 v[60:61], v35 offset:30720
    v_mfma_f32_16x16x32_bf16 v[132:135], v[40:43], a[100:103], v[132:135]
    ds_read_b64_tr_b16 v[62:63], v35 offset:33280
    buffer_load_dwordx4 a[32:35], v39, s[48:51], s72 offen offset:0 sc1
    v_mfma_f32_16x16x32_bf16 v[136:139], v[44:47], a[96:99], v[136:139]
    ds_read_b64_tr_b16 v[64:65], v35 offset:30752
    v_mfma_f32_16x16x32_bf16 v[140:143], v[44:47], a[100:103], v[140:143]
    ds_read_b64_tr_b16 v[66:67], v35 offset:33312
    buffer_load_dwordx4 a[36:39], v39, s[48:51], s73 offen offset:0 sc1
    s_waitcnt lgkmcnt(7)
    v_mfma_f32_16x16x32_bf16 v[144:147], v[48:51], a[96:99], v[144:147]
    ds_read_b64_tr_b16 v[68:69], v35 offset:30784
    v_mfma_f32_16x16x32_bf16 v[148:151], v[48:51], a[100:103], v[148:151]
    ds_read_b64_tr_b16 v[70:71], v35 offset:33344
    v_mfma_f32_16x16x32_bf16 v[152:155], v[52:55], a[96:99], v[152:155]
    ds_read_b64_tr_b16 v[72:73], v35 offset:30816
    v_mfma_f32_16x16x32_bf16 v[156:159], v[52:55], a[100:103], v[156:159]
    ds_read_b64_tr_b16 v[74:75], v35 offset:33376
    v_mfma_f32_16x16x32_bf16 v[160:163], v[56:59], a[96:99], v[160:163]
    ds_read_b64_tr_b16 v[76:77], v35 offset:30848
    v_mfma_f32_16x16x32_bf16 v[164:167], v[56:59], a[100:103], v[164:167]
    ds_read_b64_tr_b16 v[78:79], v35 offset:33408
    s_waitcnt vmcnt(22)
    s_barrier
    s_waitcnt lgkmcnt(6)
    v_mfma_f32_16x16x32_bf16 v[128:131], v[60:63], a[104:107], v[128:131]
    ds_read_b64_tr_b16 v[40:41], v36 offset:0
    v_mfma_f32_16x16x32_bf16 v[132:135], v[60:63], a[108:111], v[132:135]
    ds_read_b64_tr_b16 v[42:43], v36 offset:2560
    buffer_load_dwordx4 a[40:43], v39, s[48:51], s72 offen offset:1024 sc1
    v_mfma_f32_16x16x32_bf16 v[136:139], v[64:67], a[104:107], v[136:139]
    ds_read_b64_tr_b16 v[44:45], v36 offset:32
    v_mfma_f32_16x16x32_bf16 v[140:143], v[64:67], a[108:111], v[140:143]
    ds_read_b64_tr_b16 v[46:47], v36 offset:2592
    buffer_load_dwordx4 a[44:47], v39, s[48:51], s73 offen offset:1024 sc1
    s_waitcnt lgkmcnt(4)
    v_mfma_f32_16x16x32_bf16 v[144:147], v[68:71], a[104:107], v[144:147]
    ds_read_b64_tr_b16 v[48:49], v36 offset:64
    v_mfma_f32_16x16x32_bf16 v[148:151], v[68:71], a[108:111], v[148:151]
    ds_read_b64_tr_b16 v[50:51], v36 offset:2624
    s_add_u32 s79, s62, 24
    s_min_u32 s79, s79, 26
    s_mul_i32 s77, s79, 5120
    s_add_u32 s77, s77, s75
    s_sub_u32 s78, s79, 14
    s_mul_i32 s78, s78, 5120
    s_add_u32 s78, s78, s76
    s_mov_b32 m0, s78
    s_add_u32 s79, s77, 4096
    buffer_load_dwordx4 v39, s[48:51], s77 offen offset:3072 sc1 lds
    v_mfma_f32_16x16x32_bf16 v[152:155], v[72:75], a[104:107], v[152:155]
    ds_read_b64_tr_b16 v[52:53], v36 offset:96
    v_mfma_f32_16x16x32_bf16 v[156:159], v[72:75], a[108:111], v[156:159]
    ds_read_b64_tr_b16 v[54:55], v36 offset:2656
    s_add_u32 m0, s78, 4096
    s_nop 0
    buffer_load_dwordx4 v39, s[48:51], s79 offen sc1 lds
    v_mfma_f32_16x16x32_bf16 v[160:163], v[76:79], a[104:107], v[160:163]
    ds_read_b64_tr_b16 v[56:57], v36 offset:128
    v_mfma_f32_16x16x32_bf16 v[164:167], v[76:79], a[108:111], v[164:167]
    ds_read_b64_tr_b16 v[58:59], v36 offset:2688
    ds_write_b128 v32, a[188:191] offset:51200
    ds_write_b128 v32, a[192:195] offset:52224
    ds_write_b128 v32, a[196:199] offset:53248
    s_waitcnt vmcnt(22)
    s_waitcnt lgkmcnt(9)
    v_mfma_f32_16x16x32_bf16 v[128:131], v[40:43], a[112:115], v[128:131]
    ds_read_b64_tr_b16 v[60:61], v36 offset:5120
    v_mfma_f32_16x16x32_bf16 v[132:135], v[40:43], a[116:119], v[132:135]
    ds_read_b64_tr_b16 v[62:63], v36 offset:7680
    buffer_load_dwordx4 a[48:51], v39, s[48:51], s72 offen offset:2048 sc1
    v_mfma_f32_16x16x32_bf16 v[136:139], v[44:47], a[112:115], v[136:139]
    ds_read_b64_tr_b16 v[64:65], v36 offset:5152
    v_mfma_f32_16x16x32_bf16 v[140:143], v[44:47], a[116:119], v[140:143]
    ds_read_b64_tr_b16 v[66:67], v36 offset:7712
    buffer_load_dwordx4 a[52:55], v39, s[48:51], s73 offen offset:2048 sc1
    s_waitcnt lgkmcnt(7)
    v_mfma_f32_16x16x32_bf16 v[144:147], v[48:51], a[112:115], v[144:147]
    ds_read_b64_tr_b16 v[68:69], v36 offset:5184
    v_mfma_f32_16x16x32_bf16 v[148:151], v[48:51], a[116:119], v[148:151]
    ds_read_b64_tr_b16 v[70:71], v36 offset:7744
    v_mfma_f32_16x16x32_bf16 v[152:155], v[52:55], a[112:115], v[152:155]
    ds_read_b64_tr_b16 v[72:73], v36 offset:5216
    v_mfma_f32_16x16x32_bf16 v[156:159], v[52:55], a[116:119], v[156:159]
    ds_read_b64_tr_b16 v[74:75], v36 offset:7776
    v_mfma_f32_16x16x32_bf16 v[160:163], v[56:59], a[112:115], v[160:163]
    ds_read_b64_tr_b16 v[76:77], v36 offset:5248
    v_mfma_f32_16x16x32_bf16 v[164:167], v[56:59], a[116:119], v[164:167]
    ds_read_b64_tr_b16 v[78:79], v36 offset:7808
    s_waitcnt vmcnt(22)
    s_barrier
    s_waitcnt lgkmcnt(6)
    v_mfma_f32_16x16x32_bf16 v[128:131], v[60:63], a[120:123], v[128:131]
    ds_read_b64_tr_b16 v[40:41], v36 offset:10240
    v_mfma_f32_16x16x32_bf16 v[132:135], v[60:63], a[124:127], v[132:135]
    ds_read_b64_tr_b16 v[42:43], v36 offset:12800
    buffer_load_dwordx4 a[56:59], v39, s[48:51], s72 offen offset:3072 sc1
    v_mfma_f32_16x16x32_bf16 v[136:139], v[64:67], a[120:123], v[136:139]
    ds_read_b64_tr_b16 v[44:45], v36 offset:10272
    v_mfma_f32_16x16x32_bf16 v[140:143], v[64:67], a[124:127], v[140:143]
    ds_read_b64_tr_b16 v[46:47], v36 offset:12832
    buffer_load_dwordx4 a[60:63], v39, s[48:51], s73 offen offset:3072 sc1
    s_add_u32 s72, s72, 4096
    s_add_u32 s73, s73, 4096
    s_waitcnt lgkmcnt(4)
    v_mfma_f32_16x16x32_bf16 v[144:147], v[68:71], a[120:123], v[144:147]
    ds_read_b64_tr_b16 v[48:49], v36 offset:10304
    v_mfma_f32_16x16x32_bf16 v[148:151], v[68:71], a[124:127], v[148:151]
    ds_read_b64_tr_b16 v[50:51], v36 offset:12864
    s_add_u32 s79, s62, 26
    s_min_u32 s79, s79, 26
    s_mul_i32 s77, s79, 5120
    s_add_u32 s77, s77, s75
    s_sub_u32 s78, s79, 14
    s_mul_i32 s78, s78, 5120
    s_add_u32 s78, s78, s76
    s_mov_b32 m0, s78
    s_add_u32 s79, s77, 4096
    buffer_load_dwordx4 v39, s[48:51], s77 offen offset:3072 sc1 lds
    v_mfma_f32_16x16x32_bf16 v[152:155], v[72:75], a[120:123], v[152:155]
    ds_read_b64_tr_b16 v[52:53], v36 offset:10336
    v_mfma_f32_16x16x32_bf16 v[156:159], v[72:75], a[124:127], v[156:159]
    ds_read_b64_tr_b16 v[54:55], v36 offset:12896
    s_add_u32 m0, s78, 4096
    s_nop 0
    buffer_load_dwordx4 v39, s[48:51], s79 offen sc1 lds
    v_mfma_f32_16x16x32_bf16 v[160:163], v[76:79], a[120:123], v[160:163]
    ds_read_b64_tr_b16 v[56:57], v36 offset:10368
    v_mfma_f32_16x16x32_bf16 v[164:167], v[76:79], a[124:127], v[164:167]
    ds_read_b64_tr_b16 v[58:59], v36 offset:12928
    ds_write_b128 v31, a[200:203] offset:0
    ds_write_b128 v31, a[204:207] offset:1024
    ds_write_b128 v31, a[208:211] offset:2048
    s_waitcnt vmcnt(22)
    s_waitcnt lgkmcnt(9)
    v_mfma_f32_16x16x32_bf16 v[128:131], v[40:43], a[0:3], v[128:131]
    ds_read_b64_tr_b16 v[60:61], v36 offset:15360
    v_mfma_f32_16x16x32_bf16 v[132:135], v[40:43], a[4:7], v[132:135]
    ds_read_b64_tr_b16 v[62:63], v36 offset:17920
    buffer_load_dwordx4 a[64:67], v39, s[48:51], s72 offen offset:0 sc1
    v_mfma_f32_16x16x32_bf16 v[136:139], v[44:47], a[0:3], v[136:139]
    ds_read_b64_tr_b16 v[64:65], v36 offset:15392
    v_mfma_f32_16x16x32_bf16 v[140:143], v[44:47], a[4:7], v[140:143]
    ds_read_b64_tr_b16 v[66:67], v36 offset:17952
    buffer_load_dwordx4 a[68:71], v39, s[48:51], s73 offen offset:0 sc1
    s_waitcnt lgkmcnt(7)
    v_mfma_f32_16x16x32_bf16 v[144:147], v[48:51], a[0:3], v[144:147]
    ds_read_b64_tr_b16 v[68:69], v36 offset:15424
    v_mfma_f32_16x16x32_bf16 v[148:151], v[48:51], a[4:7], v[148:151]
    ds_read_b64_tr_b16 v[70:71], v36 offset:17984
    v_mfma_f32_16x16x32_bf16 v[152:155], v[52:55], a[0:3], v[152:155]
    ds_read_b64_tr_b16 v[72:73], v36 offset:15456
    v_mfma_f32_16x16x32_bf16 v[156:159], v[52:55], a[4:7], v[156:159]
    ds_read_b64_tr_b16 v[74:75], v36 offset:18016
    v_mfma_f32_16x16x32_bf16 v[160:163], v[56:59], a[0:3], v[160:163]
    ds_read_b64_tr_b16 v[76:77], v36 offset:15488
    v_mfma_f32_16x16x32_bf16 v[164:167], v[56:59], a[4:7], v[164:167]
    ds_read_b64_tr_b16 v[78:79], v36 offset:18048
    s_waitcnt vmcnt(22)
    s_barrier
    s_waitcnt lgkmcnt(6)
    v_mfma_f32_16x16x32_bf16 v[128:131], v[60:63], a[8:11], v[128:131]
    ds_read_b64_tr_b16 v[40:41], v36 offset:20480
    v_mfma_f32_16x16x32_bf16 v[132:135], v[60:63], a[12:15], v[132:135]
    ds_read_b64_tr_b16 v[42:43], v36 offset:23040
    buffer_load_dwordx4 a[72:75], v39, s[48:51], s72 offen offset:1024 sc1
    v_mfma_f32_16x16x32_bf16 v[136:139], v[64:67], a[8:11], v[136:139]
    ds_read_b64_tr_b16 v[44:45], v36 offset:20512
    v_mfma_f32_16x16x32_bf16 v[140:143], v[64:67], a[12:15], v[140:143]
    ds_read_b64_tr_b16 v[46:47], v36 offset:23072
    buffer_load_dwordx4 a[76:79], v39, s[48:51], s73 offen offset:1024 sc1
    s_waitcnt lgkmcnt(4)
    v_mfma_f32_16x16x32_bf16 v[144:147], v[68:71], a[8:11], v[144:147]
    ds_read_b64_tr_b16 v[48:49], v36 offset:20544
    v_mfma_f32_16x16x32_bf16 v[148:151], v[68:71], a[12:15], v[148:151]
    ds_read_b64_tr_b16 v[50:51], v36 offset:23104
    v_mfma_f32_16x16x32_bf16 v[152:155], v[72:75], a[8:11], v[152:155]
    ds_read_b64_tr_b16 v[52:53], v36 offset:20576
    v_mfma_f32_16x16x32_bf16 v[156:159], v[72:75], a[12:15], v[156:159]
    ds_read_b64_tr_b16 v[54:55], v36 offset:23136
    v_mfma_f32_16x16x32_bf16 v[160:163], v[76:79], a[8:11], v[160:163]
    ds_read_b64_tr_b16 v[56:57], v36 offset:20608
    v_mfma_f32_16x16x32_bf16 v[164:167], v[76:79], a[12:15], v[164:167]
    ds_read_b64_tr_b16 v[58:59], v36 offset:23168
    s_waitcnt vmcnt(20)
    s_waitcnt lgkmcnt(6)
    v_mfma_f32_16x16x32_bf16 v[128:131], v[40:43], a[16:19], v[128:131]
    ds_read_b64_tr_b16 v[60:61], v36 offset:25600
    v_mfma_f32_16x16x32_bf16 v[132:135], v[40:43], a[20:23], v[132:135]
    ds_read_b64_tr_b16 v[62:63], v36 offset:28160
    buffer_load_dwordx4 a[80:83], v39, s[48:51], s72 offen offset:2048 sc1
    v_mfma_f32_16x16x32_bf16 v[136:139], v[44:47], a[16:19], v[136:139]
    ds_read_b64_tr_b16 v[64:65], v36 offset:25632
    v_mfma_f32_16x16x32_bf16 v[140:143], v[44:47], a[20:23], v[140:143]
    ds_read_b64_tr_b16 v[66:67], v36 offset:28192
    buffer_load_dwordx4 a[84:87], v39, s[48:51], s73 offen offset:2048 sc1
    s_waitcnt lgkmcnt(4)
    v_mfma_f32_16x16x32_bf16 v[144:147], v[48:51], a[16:19], v[144:147]
    ds_read_b64_tr_b16 v[68:69], v36 offset:25664
    v_mfma_f32_16x16x32_bf16 v[148:151], v[48:51], a[20:23], v[148:151]
    ds_read_b64_tr_b16 v[70:71], v36 offset:28224
    v_mfma_f32_16x16x32_bf16 v[152:155], v[52:55], a[16:19], v[152:155]
    ds_read_b64_tr_b16 v[72:73], v36 offset:25696
    v_mfma_f32_16x16x32_bf16 v[156:159], v[52:55], a[20:23], v[156:159]
    ds_read_b64_tr_b16 v[74:75], v36 offset:28256
    v_mfma_f32_16x16x32_bf16 v[160:163], v[56:59], a[16:19], v[160:163]
    ds_read_b64_tr_b16 v[76:77], v36 offset:25728
    v_mfma_f32_16x16x32_bf16 v[164:167], v[56:59], a[20:23], v[164:167]
    ds_read_b64_tr_b16 v[78:79], v36 offset:28288
    s_waitcnt vmcnt(20)
    s_barrier
    s_waitcnt lgkmcnt(6)
    v_mfma_f32_16x16x32_bf16 v[128:131], v[60:63], a[24:27], v[128:131]
    ds_read_b64_tr_b16 v[40:41], v36 offset:30720
    v_mfma_f32_16x16x32_bf16 v[132:135], v[60:63], a[28:31], v[132:135]
    ds_read_b64_tr_b16 v[42:43], v36 offset:33280
    v_mfma_f32_16x16x32_bf16 v[136:139], v[64:67], a[24:27], v[136:139]
    ds_read_b64_tr_b16 v[44:45], v36 offset:30752
    v_mfma_f32_16x16x32_bf16 v[140:143], v[64:67], a[28:31], v[140:143]
    ds_read_b64_tr_b16 v[46:47], v36 offset:33312
    s_waitcnt lgkmcnt(4)
    v_mfma_f32_16x16x32_bf16 v[144:147], v[68:71], a[24:27], v[144:147]
    ds_read_b64_tr_b16 v[48:49], v36 offset:30784
    v_mfma_f32_16x16x32_bf16 v[148:151], v[68:71], a[28:31], v[148:151]
    ds_read_b64_tr_b16 v[50:51], v36 offset:33344
    v_mfma_f32_16x16x32_bf16 v[152:155], v[72:75], a[24:27], v[152:155]
    ds_read_b64_tr_b16 v[52:53], v36 offset:30816
    v_mfma_f32_16x16x32_bf16 v[156:159], v[72:75], a[28:31], v[156:159]
    ds_read_b64_tr_b16 v[54:55], v36 offset:33376
    v_mfma_f32_16x16x32_bf16 v[160:163], v[76:79], a[24:27], v[160:163]
    ds_read_b64_tr_b16 v[56:57], v36 offset:30848
    v_mfma_f32_16x16x32_bf16 v[164:167], v[76:79], a[28:31], v[164:167]
    ds_read_b64_tr_b16 v[58:59], v36 offset:33408
    s_waitcnt vmcnt(16)
    s_waitcnt lgkmcnt(6)
    v_mfma_f32_16x16x32_bf16 v[128:131], v[40:43], a[32:35], v[128:131]
    ds_read_b64_tr_b16 v[60:61], v35 offset:0
    v_mfma_f32_16x16x32_bf16 v[132:135], v[40:43], a[36:39], v[132:135]
    ds_read_b64_tr_b16 v[62:63], v35 offset:2560
    buffer_load_dwordx4 v[80:83], v37, s[48:51], s74 offen offset:0 sc1
    v_mfma_f32_16x16x32_bf16 v[136:139], v[44:47], a[32:35], v[136:139]
    ds_read_b64_tr_b16 v[64:65], v35 offset:32
    v_mfma_f32_16x16x32_bf16 v[140:143], v[44:47], a[36:39], v[140:143]
    ds_read_b64_tr_b16 v[66:67], v35 offset:2592
    buffer_load_dwordx2 v[184:185], v33, s[32:35], 0 offen offset:0
    s_waitcnt lgkmcnt(4)
    v_mfma_f32_16x16x32_bf16 v[144:147], v[48:51], a[32:35], v[144:147]
    ds_read_b64_tr_b16 v[68:69], v35 offset:64
    v_mfma_f32_16x16x32_bf16 v[148:151], v[48:51], a[36:39], v[148:151]
    ds_read_b64_tr_b16 v[70:71], v35 offset:2624
    buffer_load_dwordx4 v[84:87], v37, s[48:51], s74 offen offset:64 sc1
    v_mfma_f32_16x16x32_bf16 v[152:155], v[52:55], a[32:35], v[152:155]
    ds_read_b64_tr_b16 v[72:73], v35 offset:96
    v_mfma_f32_16x16x32_bf16 v[156:159], v[52:55], a[36:39], v[156:159]
    ds_read_b64_tr_b16 v[74:75], v35 offset:2656
    buffer_load_dwordx2 v[186:187], v33, s[32:35], 0 offen offset:32
    v_mfma_f32_16x16x32_bf16 v[160:163], v[56:59], a[32:35], v[160:163]
    ds_read_b64_tr_b16 v[76:77], v35 offset:128
    v_mfma_f32_16x16x32_bf16 v[164:167], v[56:59], a[36:39], v[164:167]
    ds_read_b64_tr_b16 v[78:79], v35 offset:2688
    buffer_load_dwordx4 v[88:91], v37, s[48:51], s74 offen offset:128 sc1
    buffer_load_dwordx2 v[188:189], v33, s[32:35], 0 offen offset:64
    buffer_load_dwordx4 v[92:95], v37, s[48:51], s74 offen offset:192 sc1
    buffer_load_dwordx2 v[190:191], v33, s[32:35], 0 offen offset:96
    buffer_load_dwordx4 v[96:99], v37, s[48:51], s74 offen offset:256 sc1
    buffer_load_dwordx2 v[192:193], v33, s[32:35], 0 offen offset:128
    s_waitcnt vmcnt(24)
    s_barrier
    s_waitcnt lgkmcnt(6)
    v_mfma_f32_16x16x32_bf16 v[128:131], v[60:63], a[40:43], v[128:131]
    ds_read_b64_tr_b16 v[40:41], v35 offset:5120
    v_mfma_f32_16x16x32_bf16 v[132:135], v[60:63], a[44:47], v[132:135]
    ds_read_b64_tr_b16 v[42:43], v35 offset:7680
    v_mfma_f32_16x16x32_bf16 v[136:139], v[64:67], a[40:43], v[136:139]
    ds_read_b64_tr_b16 v[44:45], v35 offset:5152
    v_mfma_f32_16x16x32_bf16 v[140:143], v[64:67], a[44:47], v[140:143]
    ds_read_b64_tr_b16 v[46:47], v35 offset:7712
    s_waitcnt lgkmcnt(4)
    v_mfma_f32_16x16x32_bf16 v[144:147], v[68:71], a[40:43], v[144:147]
    ds_read_b64_tr_b16 v[48:49], v35 offset:5184
    v_mfma_f32_16x16x32_bf16 v[148:151], v[68:71], a[44:47], v[148:151]
    ds_read_b64_tr_b16 v[50:51], v35 offset:7744
    v_mfma_f32_16x16x32_bf16 v[152:155], v[72:75], a[40:43], v[152:155]
    ds_read_b64_tr_b16 v[52:53], v35 offset:5216
    v_mfma_f32_16x16x32_bf16 v[156:159], v[72:75], a[44:47], v[156:159]
    ds_read_b64_tr_b16 v[54:55], v35 offset:7776
    v_mfma_f32_16x16x32_bf16 v[160:163], v[76:79], a[40:43], v[160:163]
    ds_read_b64_tr_b16 v[56:57], v35 offset:5248
    v_mfma_f32_16x16x32_bf16 v[164:167], v[76:79], a[44:47], v[164:167]
    ds_read_b64_tr_b16 v[58:59], v35 offset:7808
    s_waitcnt vmcnt(20)
    s_waitcnt lgkmcnt(6)
    v_mfma_f32_16x16x32_bf16 v[128:131], v[40:43], a[48:51], v[128:131]
    ds_read_b64_tr_b16 v[60:61], v35 offset:10240
    v_mfma_f32_16x16x32_bf16 v[132:135], v[40:43], a[52:55], v[132:135]
    ds_read_b64_tr_b16 v[62:63], v35 offset:12800
    v_mfma_f32_16x16x32_bf16 v[136:139], v[44:47], a[48:51], v[136:139]
    ds_read_b64_tr_b16 v[64:65], v35 offset:10272
    v_mfma_f32_16x16x32_bf16 v[140:143], v[44:47], a[52:55], v[140:143]
    ds_read_b64_tr_b16 v[66:67], v35 offset:12832
    s_waitcnt lgkmcnt(4)
    v_mfma_f32_16x16x32_bf16 v[144:147], v[48:51], a[48:51], v[144:147]
    ds_read_b64_tr_b16 v[68:69], v35 offset:10304
    v_mfma_f32_16x16x32_bf16 v[148:151], v[48:51], a[52:55], v[148:151]
    ds_read_b64_tr_b16 v[70:71], v35 offset:12864
    v_mfma_f32_16x16x32_bf16 v[152:155], v[52:55], a[48:51], v[152:155]
    ds_read_b64_tr_b16 v[72:73], v35 offset:10336
    v_mfma_f32_16x16x32_bf16 v[156:159], v[52:55], a[52:55], v[156:159]
    ds_read_b64_tr_b16 v[74:75], v35 offset:12896
    v_mfma_f32_16x16x32_bf16 v[160:163], v[56:59], a[48:51], v[160:163]
    ds_read_b64_tr_b16 v[76:77], v35 offset:10368
    v_mfma_f32_16x16x32_bf16 v[164:167], v[56:59], a[52:55], v[164:167]
    ds_read_b64_tr_b16 v[78:79], v35 offset:12928
    s_waitcnt vmcnt(18)
    s_barrier
    s_waitcnt lgkmcnt(6)
    v_mfma_f32_16x16x32_bf16 v[128:131], v[60:63], a[56:59], v[128:131]
    ds_read_b64_tr_b16 v[40:41], v35 offset:15360
    v_mfma_f32_16x16x32_bf16 v[132:135], v[60:63], a[60:63], v[132:135]
    ds_read_b64_tr_b16 v[42:43], v35 offset:17920
    v_mfma_f32_16x16x32_bf16 v[136:139], v[64:67], a[56:59], v[136:139]
    ds_read_b64_tr_b16 v[44:45], v35 offset:15392
    v_mfma_f32_16x16x32_bf16 v[140:143], v[64:67], a[60:63], v[140:143]
    ds_read_b64_tr_b16 v[46:47], v35 offset:17952
    s_waitcnt lgkmcnt(4)
    v_mfma_f32_16x16x32_bf16 v[144:147], v[68:71], a[56:59], v[144:147]
    ds_read_b64_tr_b16 v[48:49], v35 offset:15424
    v_mfma_f32_16x16x32_bf16 v[148:151], v[68:71], a[60:63], v[148:151]
    ds_read_b64_tr_b16 v[50:51], v35 offset:17984
    v_mfma_f32_16x16x32_bf16 v[152:155], v[72:75], a[56:59], v[152:155]
    ds_read_b64_tr_b16 v[52:53], v35 offset:15456
    v_mfma_f32_16x16x32_bf16 v[156:159], v[72:75], a[60:63], v[156:159]
    ds_read_b64_tr_b16 v[54:55], v35 offset:18016
    v_mfma_f32_16x16x32_bf16 v[160:163], v[76:79], a[56:59], v[160:163]
    ds_read_b64_tr_b16 v[56:57], v35 offset:15488
    v_mfma_f32_16x16x32_bf16 v[164:167], v[76:79], a[60:63], v[164:167]
    ds_read_b64_tr_b16 v[58:59], v35 offset:18048
    s_waitcnt vmcnt(14)
    s_waitcnt lgkmcnt(6)
    v_mfma_f32_16x16x32_bf16 v[128:131], v[40:43], a[64:67], v[128:131]
    ds_read_b64_tr_b16 v[60:61], v35 offset:20480
    v_mfma_f32_16x16x32_bf16 v[132:135], v[40:43], a[68:71], v[132:135]
    ds_read_b64_tr_b16 v[62:63], v35 offset:23040
    v_mfma_f32_16x16x32_bf16 v[136:139], v[44:47], a[64:67], v[136:139]
    ds_read_b64_tr_b16 v[64:65], v35 offset:20512
    v_mfma_f32_16x16x32_bf16 v[140:143], v[44:47], a[68:71], v[140:143]
    ds_read_b64_tr_b16 v[66:67], v35 offset:23072
    s_waitcnt lgkmcnt(4)
    v_mfma_f32_16x16x32_bf16 v[144:147], v[48:51], a[64:67], v[144:147]
    ds_read_b64_tr_b16 v[68:69], v35 offset:20544
    v_mfma_f32_16x16x32_bf16 v[148:151], v[48:51], a[68:71], v[148:151]
    ds_read_b64_tr_b16 v[70:71], v35 offset:23104
    v_mfma_f32_16x16x32_bf16 v[152:155], v[52:55], a[64:67], v[152:155]
    ds_read_b64_tr_b16 v[72:73], v35 offset:20576
    v_mfma_f32_16x16x32_bf16 v[156:159], v[52:55], a[68:71], v[156:159]
    ds_read_b64_tr_b16 v[74:75], v35 offset:23136
    v_mfma_f32_16x16x32_bf16 v[160:163], v[56:59], a[64:67], v[160:163]
    ds_read_b64_tr_b16 v[76:77], v35 offset:20608
    v_mfma_f32_16x16x32_bf16 v[164:167], v[56:59], a[68:71], v[164:167]
    ds_read_b64_tr_b16 v[78:79], v35 offset:23168
    s_waitcnt vmcnt(12)
    s_barrier
    s_waitcnt lgkmcnt(6)
    v_mfma_f32_16x16x32_bf16 v[128:131], v[60:63], a[72:75], v[128:131]
    ds_read_b64_tr_b16 v[40:41], v35 offset:25600
    v_mfma_f32_16x16x32_bf16 v[132:135], v[60:63], a[76:79], v[132:135]
    ds_read_b64_tr_b16 v[42:43], v35 offset:28160
    v_mfma_f32_16x16x32_bf16 v[136:139], v[64:67], a[72:75], v[136:139]
    ds_read_b64_tr_b16 v[44:45], v35 offset:25632
    v_mfma_f32_16x16x32_bf16 v[140:143], v[64:67], a[76:79], v[140:143]
    ds_read_b64_tr_b16 v[46:47], v35 offset:28192
    s_waitcnt lgkmcnt(4)
    v_mfma_f32_16x16x32_bf16 v[144:147], v[68:71], a[72:75], v[144:147]
    ds_read_b64_tr_b16 v[48:49], v35 offset:25664
    v_mfma_f32_16x16x32_bf16 v[148:151], v[68:71], a[76:79], v[148:151]
    ds_read_b64_tr_b16 v[50:51], v35 offset:28224
    v_mfma_f32_16x16x32_bf16 v[152:155], v[72:75], a[72:75], v[152:155]
    ds_read_b64_tr_b16 v[52:53], v35 offset:25696
    v_mfma_f32_16x16x32_bf16 v[156:159], v[72:75], a[76:79], v[156:159]
    ds_read_b64_tr_b16 v[54:55], v35 offset:28256
    v_mfma_f32_16x16x32_bf16 v[160:163], v[76:79], a[72:75], v[160:163]
    ds_read_b64_tr_b16 v[56:57], v35 offset:25728
    v_mfma_f32_16x16x32_bf16 v[164:167], v[76:79], a[76:79], v[164:167]
    ds_read_b64_tr_b16 v[58:59], v35 offset:28288
    s_waitcnt vmcnt(10)
    s_waitcnt lgkmcnt(6)
    v_mfma_f32_16x16x32_bf16 v[128:131], v[40:43], a[80:83], v[128:131]
    v_mfma_f32_16x16x32_bf16 v[132:135], v[40:43], a[84:87], v[132:135]
    v_mfma_f32_16x16x32_bf16 v[136:139], v[44:47], a[80:83], v[136:139]
    v_mfma_f32_16x16x32_bf16 v[140:143], v[44:47], a[84:87], v[140:143]
    s_waitcnt lgkmcnt(0)
    v_mfma_f32_16x16x32_bf16 v[144:147], v[48:51], a[80:83], v[144:147]
    v_mfma_f32_16x16x32_bf16 v[148:151], v[48:51], a[84:87], v[148:151]
    v_mfma_f32_16x16x32_bf16 v[152:155], v[52:55], a[80:83], v[152:155]
    v_mfma_f32_16x16x32_bf16 v[156:159], v[52:55], a[84:87], v[156:159]
    v_mfma_f32_16x16x32_bf16 v[160:163], v[56:59], a[80:83], v[160:163]
    v_mfma_f32_16x16x32_bf16 v[164:167], v[56:59], a[84:87], v[164:167]
    v_lshlrev_b32 v2, 4, v1
    s_mul_i32 s70, s59, 5120
    s_add_u32 s70, s70, 143360
    v_add_u32 v3, s70, v2
    s_xor_b32 s71, s59, 2
    s_mul_i32 s71, s71, 5120
    s_add_u32 s71, s71, 143360
    v_add_u32 v4, s71, v2
    ds_write_b128 v3, v[132:135] offset:0
    ds_write_b128 v3, v[140:143] offset:1024
    ds_write_b128 v3, v[148:151] offset:2048
    ds_write_b128 v3, v[156:159] offset:3072
    ds_write_b128 v3, v[164:167] offset:4096
    s_waitcnt lgkmcnt(0)
    s_barrier
    ds_read_b128 v[8:11], v4 offset:0
    ds_read_b128 v[12:15], v4 offset:1024
    ds_read_b128 v[16:19], v4 offset:2048
    ds_read_b128 v[20:23], v4 offset:3072
    ds_read_b128 v[24:27], v4 offset:4096
    s_waitcnt lgkmcnt(0)
    v_pk_add_f32 v[128:129], v[128:129], v[8:9]
    v_pk_add_f32 v[130:131], v[130:131], v[10:11]
    v_pk_add_f32 v[136:137], v[136:137], v[12:13]
    v_pk_add_f32 v[138:139], v[138:139], v[14:15]
    v_pk_add_f32 v[144:145], v[144:145], v[16:17]
    v_pk_add_f32 v[146:147], v[146:147], v[18:19]
    v_pk_add_f32 v[152:153], v[152:153], v[20:21]
    v_pk_add_f32 v[154:155], v[154:155], v[22:23]
    v_pk_add_f32 v[160:161], v[160:161], v[24:25]
    v_pk_add_f32 v[162:163], v[162:163], v[26:27]
    s_waitcnt vmcnt(0)
    v_lshlrev_b32 v8, 16, v184
    v_and_b32 v9, 0xffff0000, v184
    v_lshlrev_b32 v10, 16, v185
    v_and_b32 v11, 0xffff0000, v185
    v_pk_add_f32 v[128:129], v[128:129], v[8:9]
    v_pk_add_f32 v[130:131], v[130:131], v[10:11]
    v_pk_fma_f32 v[128:129], v[128:129], v[80:81], v[224:225]
    v_pk_fma_f32 v[130:131], v[130:131], v[82:83], v[226:227]
    v_cvt_pk_bf16_f32 v20, v128, v129
    v_cvt_pk_bf16_f32 v21, v130, v131
    buffer_store_dwordx2 v[20:21], v34, s[44:47], 0 offen offset:0
    v_lshlrev_b32 v8, 16, v186
    v_and_b32 v9, 0xffff0000, v186
    v_lshlrev_b32 v10, 16, v187
    v_and_b32 v11, 0xffff0000, v187
    v_pk_add_f32 v[136:137], v[136:137], v[8:9]
    v_pk_add_f32 v[138:139], v[138:139], v[10:11]
    v_pk_fma_f32 v[136:137], v[136:137], v[84:85], v[228:229]
    v_pk_fma_f32 v[138:139], v[138:139], v[86:87], v[230:231]
    v_cvt_pk_bf16_f32 v22, v136, v137
    v_cvt_pk_bf16_f32 v23, v138, v139
    buffer_store_dwordx2 v[22:23], v34, s[44:47], 0 offen offset:32
    v_lshlrev_b32 v8, 16, v188
    v_and_b32 v9, 0xffff0000, v188
    v_lshlrev_b32 v10, 16, v189
    v_and_b32 v11, 0xffff0000, v189
    v_pk_add_f32 v[144:145], v[144:145], v[8:9]
    v_pk_add_f32 v[146:147], v[146:147], v[10:11]
    v_pk_fma_f32 v[144:145], v[144:145], v[88:89], v[232:233]
    v_pk_fma_f32 v[146:147], v[146:147], v[90:91], v[234:235]
    v_cvt_pk_bf16_f32 v24, v144, v145
    v_cvt_pk_bf16_f32 v25, v146, v147
    buffer_store_dwordx2 v[24:25], v34, s[44:47], 0 offen offset:64
    v_lshlrev_b32 v8, 16, v190
    v_and_b32 v9, 0xffff0000, v190
    v_lshlrev_b32 v10, 16, v191
    v_and_b32 v11, 0xffff0000, v191
    v_pk_add_f32 v[152:153], v[152:153], v[8:9]
    v_pk_add_f32 v[154:155], v[154:155], v[10:11]
    v_pk_fma_f32 v[152:153], v[152:153], v[92:93], v[236:237]
    v_pk_fma_f32 v[154:155], v[154:155], v[94:95], v[238:239]
    v_cvt_pk_bf16_f32 v26, v152, v153
    v_cvt_pk_bf16_f32 v27, v154, v155
    buffer_store_dwordx2 v[26:27], v34, s[44:47], 0 offen offset:96
    v_lshlrev_b32 v8, 16, v192
    v_and_b32 v9, 0xffff0000, v192
    v_lshlrev_b32 v10, 16, v193
    v_and_b32 v11, 0xffff0000, v193
    v_pk_add_f32 v[160:161], v[160:161], v[8:9]
    v_pk_add_f32 v[162:163], v[162:163], v[10:11]
    v_pk_fma_f32 v[160:161], v[160:161], v[96:97], v[240:241]
    v_pk_fma_f32 v[162:163], v[162:163], v[98:99], v[242:243]
    v_cvt_pk_bf16_f32 v28, v160, v161
    v_cvt_pk_bf16_f32 v29, v162, v163
    buffer_store_dwordx2 v[28:29], v34, s[44:47], 0 offen offset:128
    s_cmp_lg_u32 s2, 0
    s_cbranch_scc1 L_NE7425
    s_cmp_lg_u32 s59, 0
    s_cbranch_scc1 L_NE7425
    v_mov_b32 v2, s56
    v_mov_b32 v3, 0
    s_mov_b32 s70, 0
    s_mov_b64 exec, 1
    buffer_store_dword v2, v3, s[48:51], s70 offen sc1
    s_mov_b64 exec, -1
L_NE7425:
L_END:
    s_endpgm
L_PAD12:
L_PAD13:
L_PAD14:
    s_setpc_b64 s[100:101]
.section .rodata,"a"
.p2align 6
.amdhsa_kernel adaLN_cond__linear_kernel_hedgehog__dense_activation_squared_relu__prompt_kernel
  .amdhsa_next_free_vgpr 512
  .amdhsa_next_free_sgpr 102
  .amdhsa_accum_offset 256
  .amdhsa_group_segment_fixed_size 0
  .amdhsa_kernarg_size 112
  .amdhsa_user_sgpr_count 2
  .amdhsa_user_sgpr_kernarg_segment_ptr 1
  .amdhsa_system_sgpr_workgroup_id_x 1
  .amdhsa_float_denorm_mode_32 3
.end_amdhsa_kernel
```
